```python
import torch

def _softmax(x, axis=-1):
    return torch.softmax(x, dim=axis)
def _gelu(x):
    return torch.nn.functional.gelu(x, approximate="tanh")
def _silu(x):
    return torch.nn.functional.silu(x)
def _sigmoid(x):
    return torch.sigmoid(x)
def _layernorm(x, axis=-1, eps=1e-5):
    m = x.mean(dim=axis, keepdim=True)
    v = x.var(dim=axis, keepdim=True, unbiased=False)
    return (x - m) / torch.sqrt(v + eps)
def _scatter_add(tgt, idx, src, axis=0):
    return tgt.clone().index_add_(axis, idx, src)
def _segment_sum(src, seg, n):
    out = torch.zeros((n,) + src.shape[1:], dtype=src.dtype)
    return out.index_add_(0, seg, src)
def _pad(x, pw):
    flat = tuple(v for pair in reversed(pw) for v in pair)
    return torch.nn.functional.pad(x, flat)

kernel_name = 'standalone__gqa_softmax__near_ridge'

def setup_inputs():

    _w = (lambda a: (lambda t: t.to(torch.bfloat16) if t.is_floating_point() else t)(torch.as_tensor(a)))
    B, Hq, Hkv, Sq, Sk, D = 16, 32, 32, 368, 512, 192
    return {
        "q": _w((lambda *s: torch.randn(*s, dtype=torch.bfloat16) * 0.8)(B, Hq, Sq, D)),
        "k": _w((lambda *s: torch.randn(*s, dtype=torch.bfloat16) * 0.8)(B, Hkv, Sk, D)),
        "v": _w((lambda *s: torch.randn(*s, dtype=torch.bfloat16) * 0.05)(B, Hkv, Sk, D)),
    }

def reference(q, k, v):
    B, Hq, Sq, D = q.shape
    Hkv = k.shape[1]
    rep = Hq // Hkv
    k = (lambda x, n, axis: torch.repeat_interleave(x, n, dim=axis))(k, rep, axis=1)
    v = (lambda x, n, axis: torch.repeat_interleave(x, n, dim=axis))(v, rep, axis=1)
    scale = D ** -0.5
    scores = torch.einsum("bhqd,bhkd->bhqk", q, k) * scale
    p = _softmax(scores, axis=-1)
    return torch.einsum("bhqk,bhkd->bhqd", p, v)
```

```asm
; @launch grid=(256,1,1) block=(256,1,1) lds=123904
.amdgcn_target "amdgcn-amd-amdhsa--gfx950"
.text
.globl standalone__gqa_softmax__near_ridge_kernel
.p2align 8
.type standalone__gqa_softmax__near_ridge_kernel,@function
standalone__gqa_softmax__near_ridge_kernel:

    s_cmp_ge_u32 s2, 256
    s_cbranch_scc1 L_exit
    s_load_dwordx4 s[60:63], s[0:1], 0
    s_load_dwordx4 s[64:67], s[0:1], 16
    s_getpc_b64 s[84:85]
    s_and_b32 s84, s84, 0xffffff00
    s_and_b32 s85, s85, 0xffff
    s_mov_b32 s86, 36864
    s_mov_b32 s87, 0x00020000
    v_lshlrev_b32 v231, 4, v0
    buffer_load_dwordx4 a[180:183], v231, s[84:87], 0 offen
    s_mov_b32 s88, 4096
    buffer_load_dwordx4 a[184:187], v231, s[84:87], s88 offen
    s_mov_b32 s88, 8192
    buffer_load_dwordx4 a[188:191], v231, s[84:87], s88 offen
    s_mov_b32 s88, 12288
    buffer_load_dwordx4 a[192:195], v231, s[84:87], s88 offen
    s_mov_b32 s88, 16384
    buffer_load_dwordx4 a[196:199], v231, s[84:87], s88 offen
    s_mov_b32 s88, 20480
    buffer_load_dwordx4 a[200:203], v231, s[84:87], s88 offen
    s_mov_b32 s88, 24576
    buffer_load_dwordx4 a[204:207], v231, s[84:87], s88 offen
    s_mov_b32 s88, 28672
    buffer_load_dwordx4 a[208:211], v231, s[84:87], s88 offen
    s_mov_b32 s88, 32768
    buffer_load_dwordx4 a[212:215], v231, s[84:87], s88 offen
    v_lshrrev_b32 v221, 6, v0
    v_and_b32 v220, 63, v0
    v_readfirstlane_b32 s55, v221
    v_lshrrev_b32 v222, 4, v220
    v_and_b32 v223, 15, v220
    v_mul_u32_u24 v224, 384, v223
    v_lshl_add_u32 v250, v222, 4, v224
    s_and_b32 s57, s2, 7
    s_lshr_b32 s58, s2, 3
    s_and_b32 s59, s58, 1
    s_lshr_b32 s58, s58, 1
    s_lshl_b32 s57, s57, 4
    s_add_u32 s57, s57, s58
    s_mul_i32 s22, s57, 196608
    s_mul_i32 s54, s57, 141312
    s_mul_i32 s58, s59, 73728
    s_add_u32 s54, s54, s58
    s_mul_i32 s58, s55, 18432
    s_add_u32 s54, s54, s58
    s_lshl_b32 s58, s59, 2
    s_add_u32 s58, s58, s55
    s_cmp_eq_u32 s58, 7
    s_cselect_b32 s53, 0x80000000, 0
    s_mov_b32 s50, s54
    s_add_u32 s51, s54, 6144
    s_add_u32 s52, s54, 12288
    s_or_b32 s52, s52, s53
    s_mul_i32 s21, s55, 3072
    s_and_b32 s56, s55, 1
    s_lshl_b32 s56, s56, 2
    s_mov_b32 s23, s22
    s_waitcnt lgkmcnt(0)
    s_mov_b32 s4, s60
    s_and_b32 s5, s61, 0xffff
    s_mov_b32 s6, 72351744
    s_mov_b32 s7, 0x00020000
    buffer_load_dwordx4 a[0:3], v250, s[4:7], s50 offen offset:0 nt
    buffer_load_dwordx4 a[4:7], v250, s[4:7], s50 offen offset:64 nt
    buffer_load_dwordx4 a[8:11], v250, s[4:7], s50 offen offset:128 nt
    buffer_load_dwordx4 a[12:15], v250, s[4:7], s50 offen offset:192 nt
    buffer_load_dwordx4 a[16:19], v250, s[4:7], s50 offen offset:256 nt
    buffer_load_dwordx4 a[20:23], v250, s[4:7], s50 offen offset:320 nt
    v_lshrrev_b32 v225, 3, v220
    v_and_b32 v226, 7, v220
    v_lshlrev_b32 v229, 7, v225
    v_add_u32 v229, s21, v229
    v_add_u32 v227, 0, v225
    v_mul_u32_u24 v227, 43, v227
    v_lshrrev_b32 v227, 7, v227
    v_lshrrev_b32 v228, 1, v227
    v_add_u32 v228, s56, v228
    v_xor_b32 v228, v228, v226
    v_lshl_add_u32 v244, v228, 4, v229
    v_bfe_u32 v228, v227, 1, 1
    v_lshlrev_b32 v228, 2, v228
    v_bfe_u32 v230, v227, 2, 1
    v_or_b32 v228, v228, v230
    v_xor_b32 v228, v228, v226
    v_lshl_add_u32 v247, v228, 4, v229
    v_add_u32 v227, 8, v225
    v_mul_u32_u24 v227, 43, v227
    v_lshrrev_b32 v227, 7, v227
    v_lshrrev_b32 v228, 1, v227
    v_add_u32 v228, s56, v228
    v_xor_b32 v228, v228, v226
    v_lshl_add_u32 v245, v228, 4, v229
    v_bfe_u32 v228, v227, 1, 1
    v_lshlrev_b32 v228, 2, v228
    v_bfe_u32 v230, v227, 2, 1
    v_or_b32 v228, v228, v230
    v_xor_b32 v228, v228, v226
    v_lshl_add_u32 v248, v228, 4, v229
    v_add_u32 v227, 16, v225
    v_mul_u32_u24 v227, 43, v227
    v_lshrrev_b32 v227, 7, v227
    v_lshrrev_b32 v228, 1, v227
    v_add_u32 v228, s56, v228
    v_xor_b32 v228, v228, v226
    v_lshl_add_u32 v246, v228, 4, v229
    v_bfe_u32 v228, v227, 1, 1
    v_lshlrev_b32 v228, 2, v228
    v_bfe_u32 v230, v227, 2, 1
    v_or_b32 v228, v228, v230
    v_xor_b32 v228, v228, v226
    v_lshl_add_u32 v249, v228, 4, v229
    s_mov_b32 s36, 0
    s_mov_b32 s37, 12288
    s_mov_b32 s38, 24576
    s_mov_b32 s39, 36864
    s_mov_b32 s42, 49152
    s_mov_b32 s43, 61440
    s_mov_b32 s44, 73728
    s_mov_b32 s45, 86016
    s_mov_b32 s8, s62
    s_and_b32 s9, s63, 0xffff
    s_mov_b32 s10, 100663296
    s_mov_b32 s11, 0x00020000
    s_mov_b32 s12, s64
    s_and_b32 s13, s65, 0xffff
    s_mov_b32 s14, 100663296
    s_mov_b32 s15, 0x00020000
    s_add_u32 m0, s21, 0
    s_add_u32 s31, s23, 0
    buffer_load_dwordx4 v244, s[8:11], s31 offen offset:0 nt lds
    buffer_load_dwordx4 v245, s[8:11], s31 offen offset:1024 nt lds
    buffer_load_dwordx4 v246, s[8:11], s31 offen offset:2048 nt lds
    buffer_load_dwordx4 a[24:27], v250, s[4:7], s51 offen offset:0 nt
    buffer_load_dwordx4 a[28:31], v250, s[4:7], s51 offen offset:64 nt
    buffer_load_dwordx4 a[32:35], v250, s[4:7], s51 offen offset:128 nt
    buffer_load_dwordx4 a[36:39], v250, s[4:7], s51 offen offset:192 nt
    buffer_load_dwordx4 a[40:43], v250, s[4:7], s51 offen offset:256 nt
    buffer_load_dwordx4 a[44:47], v250, s[4:7], s51 offen offset:320 nt
    buffer_load_dwordx4 a[48:51], v250, s[4:7], s52 offen offset:0 nt
    buffer_load_dwordx4 a[52:55], v250, s[4:7], s52 offen offset:64 nt
    buffer_load_dwordx4 a[56:59], v250, s[4:7], s52 offen offset:128 nt
    buffer_load_dwordx4 a[60:63], v250, s[4:7], s52 offen offset:192 nt
    buffer_load_dwordx4 a[64:67], v250, s[4:7], s52 offen offset:256 nt
    buffer_load_dwordx4 a[68:71], v250, s[4:7], s52 offen offset:320 nt
    s_add_u32 m0, s21, 12288
    s_add_u32 s31, s23, 12288
    buffer_load_dwordx4 v244, s[8:11], s31 offen offset:0 nt lds
    buffer_load_dwordx4 v245, s[8:11], s31 offen offset:1024 nt lds
    buffer_load_dwordx4 v246, s[8:11], s31 offen offset:2048 nt lds
    s_add_u32 m0, s21, 24576
    s_add_u32 s31, s23, 24576
    buffer_load_dwordx4 v244, s[8:11], s31 offen offset:0 nt lds
    buffer_load_dwordx4 v245, s[8:11], s31 offen offset:1024 nt lds
    buffer_load_dwordx4 v246, s[8:11], s31 offen offset:2048 nt lds
    s_add_u32 m0, s21, 49152
    s_add_u32 s32, s23, 0
    buffer_load_dwordx4 v247, s[12:15], s32 offen offset:0 lds
    buffer_load_dwordx4 v248, s[12:15], s32 offen offset:1024 lds
    buffer_load_dwordx4 v249, s[12:15], s32 offen offset:2048 lds
    s_mov_b32 s16, s66
    s_and_b32 s17, s67, 0xffff
    s_mov_b32 s18, 72351744
    s_mov_b32 s19, 0x00020000
    v_lshrrev_b32 v225, 1, v223
    v_xor_b32 v225, v225, v222
    v_lshl_add_u32 v234, v225, 4, v224
    v_xor_b32 v235, 64, v234
    v_bfe_u32 v225, v220, 2, 4
    v_mul_u32_u24 v225, 384, v225
    v_bfe_u32 v226, v220, 3, 1
    v_lshlrev_b32 v226, 2, v226
    v_bfe_u32 v227, v220, 4, 1
    v_or_b32 v226, v226, v227
    v_and_b32 v228, 3, v220
    v_xor_b32 v226, v226, v228
    v_lshl_add_u32 v225, v226, 4, v225
    v_and_b32 v228, 1, v220
    v_lshl_add_u32 v240, v228, 3, v225
    v_xor_b32 v241, 8, v240
    v_xor_b32 v242, 64, v240
    v_xor_b32 v243, 72, v240
    v_cmp_eq_u32 s[34:35], 1, v227
    v_mov_b32 v232, v234
    v_mov_b32 v233, v235
    v_add_u32 v236, 49152, v240
    v_add_u32 v237, 49152, v241
    v_add_u32 v238, 49152, v242
    v_add_u32 v239, 49152, v243
    s_mul_i32 s58, s55, 6400
    s_add_u32 s58, s58, 98304
    v_mul_u32_u24 v225, 400, v223
    v_lshl_add_u32 v225, v222, 4, v225
    v_lshl_add_u32 v225, v227, 3, v225
    v_add_u32 v234, s58, v225
    v_xor_b32 v235, 8, v234
    v_add_u32 v225, 0, v220
    v_mul_u32_u24 v226, 171, v225
    v_lshrrev_b32 v226, 12, v226
    v_add_u32 v225, v225, v226
    v_lshlrev_b32 v225, 4, v225
    v_add_u32 v240, s58, v225
    v_add_u32 v225, 64, v220
    v_mul_u32_u24 v226, 171, v225
    v_lshrrev_b32 v226, 12, v226
    v_add_u32 v225, v225, v226
    v_lshlrev_b32 v225, 4, v225
    v_add_u32 v241, s58, v225
    v_add_u32 v225, 128, v220
    v_mul_u32_u24 v226, 171, v225
    v_lshrrev_b32 v226, 12, v226
    v_add_u32 v225, v225, v226
    v_lshlrev_b32 v225, 4, v225
    v_add_u32 v242, s58, v225
    v_lshlrev_b32 v243, 4, v220
    s_mov_b32 s24, 0x80000000
    s_mov_b32 s25, 0x80000000
    s_mov_b32 s26, 0x80000000
    s_mov_b32 s30, 0
    s_mov_b64 vcc, 0
    s_mov_b32 s20, 0x3dd53b95
    v_mov_b32 v220, 0x3f803f80
    v_accvgpr_write_b32 a176, v220
    v_accvgpr_write_b32 a177, v220
    v_accvgpr_write_b32 a178, v220
    v_accvgpr_write_b32 a179, v220
    s_waitcnt vmcnt(9)
    s_barrier
    s_add_u32 m0, s21, 36864
    s_add_u32 s31, s23, 36864
    buffer_load_dwordx4 v244, s[8:11], s31 offen offset:0 nt lds
    buffer_load_dwordx4 v245, s[8:11], s31 offen offset:1024 nt lds
    buffer_load_dwordx4 v246, s[8:11], s31 offen offset:2048 nt lds
    s_add_u32 m0, s21, 61440
    s_add_u32 s32, s23, 12288
    buffer_load_dwordx4 v247, s[12:15], s32 offen offset:0 lds
    buffer_load_dwordx4 v248, s[12:15], s32 offen offset:1024 lds
    buffer_load_dwordx4 v249, s[12:15], s32 offen offset:2048 lds
    ds_read_b128 a[144:147], v232 offset:0
    ds_read_b128 a[148:151], v232 offset:6144
    ds_read_b128 a[152:155], v233 offset:0
    ds_read_b128 a[156:159], v233 offset:6144
    ds_read_b128 a[160:163], v232 offset:128
    ds_read_b128 a[164:167], v232 offset:6272
    ds_read_b128 a[168:171], v233 offset:128
    s_waitcnt lgkmcnt(3)
    v_mfma_f32_16x16x32_bf16 v[156:159], a[144:147], a[0:3], 0
    v_mfma_f32_16x16x32_bf16 v[160:163], a[144:147], a[24:27], 0
    ds_read_b128 a[172:175], v233 offset:6272
    v_mfma_f32_16x16x32_bf16 v[164:167], a[144:147], a[48:51], 0
    v_mfma_f32_16x16x32_bf16 v[168:171], a[148:151], a[0:3], 0
    v_mfma_f32_16x16x32_bf16 v[172:175], a[148:151], a[24:27], 0
    ds_read_b128 a[144:147], v232 offset:256
    v_mfma_f32_16x16x32_bf16 v[176:179], a[148:151], a[48:51], 0
    v_mfma_f32_16x16x32_bf16 v[156:159], a[152:155], a[4:7], v[156:159]
    v_mfma_f32_16x16x32_bf16 v[160:163], a[152:155], a[28:31], v[160:163]
    ds_read_b128 a[148:151], v232 offset:6400
    v_mfma_f32_16x16x32_bf16 v[164:167], a[152:155], a[52:55], v[164:167]
    v_mfma_f32_16x16x32_bf16 v[168:171], a[156:159], a[4:7], v[168:171]
    v_mfma_f32_16x16x32_bf16 v[172:175], a[156:159], a[28:31], v[172:175]
    ds_read_b128 a[152:155], v233 offset:256
    v_mfma_f32_16x16x32_bf16 v[176:179], a[156:159], a[52:55], v[176:179]
    s_waitcnt lgkmcnt(3)
    v_mfma_f32_16x16x32_bf16 v[156:159], a[160:163], a[8:11], v[156:159]
    v_mfma_f32_16x16x32_bf16 v[160:163], a[160:163], a[32:35], v[160:163]
    ds_read_b128 a[156:159], v233 offset:6400
    v_mfma_f32_16x16x32_bf16 v[164:167], a[160:163], a[56:59], v[164:167]
    v_mfma_f32_16x16x32_bf16 v[168:171], a[164:167], a[8:11], v[168:171]
    v_mfma_f32_16x16x32_bf16 v[172:175], a[164:167], a[32:35], v[172:175]
    v_mfma_f32_16x16x32_bf16 v[176:179], a[164:167], a[56:59], v[176:179]
    v_mfma_f32_16x16x32_bf16 v[156:159], a[168:171], a[12:15], v[156:159]
    v_mfma_f32_16x16x32_bf16 v[160:163], a[168:171], a[36:39], v[160:163]
    v_mfma_f32_16x16x32_bf16 v[164:167], a[168:171], a[60:63], v[164:167]
    v_mfma_f32_16x16x32_bf16 v[168:171], a[172:175], a[12:15], v[168:171]
    v_mfma_f32_16x16x32_bf16 v[172:175], a[172:175], a[36:39], v[172:175]
    v_mfma_f32_16x16x32_bf16 v[176:179], a[172:175], a[60:63], v[176:179]
    s_waitcnt lgkmcnt(0)
    v_mfma_f32_16x16x32_bf16 v[156:159], a[144:147], a[16:19], v[156:159]
    v_mfma_f32_16x16x32_bf16 v[160:163], a[144:147], a[40:43], v[160:163]
    v_mfma_f32_16x16x32_bf16 v[164:167], a[144:147], a[64:67], v[164:167]
    v_mfma_f32_16x16x32_bf16 v[168:171], a[148:151], a[16:19], v[168:171]
    v_mfma_f32_16x16x32_bf16 v[172:175], a[148:151], a[40:43], v[172:175]
    v_mfma_f32_16x16x32_bf16 v[176:179], a[148:151], a[64:67], v[176:179]
    v_mfma_f32_16x16x32_bf16 v[156:159], a[152:155], a[20:23], v[156:159]
    v_mfma_f32_16x16x32_bf16 v[160:163], a[152:155], a[44:47], v[160:163]
    v_mfma_f32_16x16x32_bf16 v[164:167], a[152:155], a[68:71], v[164:167]
    v_mfma_f32_16x16x32_bf16 v[168:171], a[156:159], a[20:23], v[168:171]
    v_mfma_f32_16x16x32_bf16 v[172:175], a[156:159], a[44:47], v[172:175]
    v_mfma_f32_16x16x32_bf16 v[176:179], a[156:159], a[68:71], v[176:179]
    s_nop 7
    v_max3_f32 v251, v156, v157, v158
    v_max3_f32 v253, v160, v161, v162
    v_max3_f32 v255, v164, v165, v166
    v_max3_f32 v251, v251, v159, v168
    v_max3_f32 v253, v253, v163, v172
    v_max3_f32 v255, v255, v167, v176
    v_max3_f32 v251, v251, v169, v170
    v_max3_f32 v253, v253, v173, v174
    v_max3_f32 v255, v255, v177, v178
    v_max_f32 v251, v251, v171
    v_max_f32 v253, v253, v175
    v_max_f32 v255, v255, v179
    v_mov_b32 v252, v251
    v_mov_b32 v254, v253
    v_mov_b32 v219, v255
    v_permlane32_swap_b32 v251, v252
    v_permlane32_swap_b32 v253, v254
    v_permlane32_swap_b32 v255, v219
    v_max_f32 v251, v251, v252
    v_max_f32 v253, v253, v254
    v_max_f32 v255, v255, v219
    v_mov_b32 v252, v251
    v_mov_b32 v254, v253
    v_mov_b32 v219, v255
    v_permlane16_swap_b32 v251, v252
    v_permlane16_swap_b32 v253, v254
    s_waitcnt vmcnt(6)
    s_barrier
    v_permlane16_swap_b32 v255, v219
    v_max_f32 v251, v251, v252
    s_add_u32 m0, s21, 73728
    s_add_u32 s32, s23, 24576
    buffer_load_dwordx4 v247, s[12:15], s32 offen offset:0 lds
    v_max_f32 v253, v253, v254
    v_max_f32 v255, v255, v219
    v_mul_f32 v216, s20, v251
    v_mul_f32 v217, s20, v253
    v_mul_f32 v218, s20, v255
    ds_read_b128 a[144:147], v232 offset:12288
    v_fma_f32 v156, v156, s20, -v216
    v_fma_f32 v157, v157, s20, -v216
    v_fma_f32 v158, v158, s20, -v216
    v_fma_f32 v159, v159, s20, -v216
    ds_read_b128 a[148:151], v232 offset:18432
    v_fma_f32 v160, v160, s20, -v217
    v_fma_f32 v161, v161, s20, -v217
    v_fma_f32 v162, v162, s20, -v217
    v_fma_f32 v163, v163, s20, -v217
    v_fma_f32 v164, v164, s20, -v218
    ds_read_b128 a[152:155], v233 offset:12288
    v_fma_f32 v165, v165, s20, -v218
    v_fma_f32 v166, v166, s20, -v218
    ds_read_b128 a[156:159], v233 offset:18432
    buffer_load_dwordx4 v248, s[12:15], s32 offen offset:1024 lds
    v_fma_f32 v167, v167, s20, -v218
    v_fma_f32 v168, v168, s20, -v216
    v_fma_f32 v169, v169, s20, -v216
    v_fma_f32 v170, v170, s20, -v216
    v_fma_f32 v171, v171, s20, -v216
    ds_read_b128 a[160:163], v232 offset:12416
    v_fma_f32 v172, v172, s20, -v217
    v_fma_f32 v173, v173, s20, -v217
    v_fma_f32 v174, v174, s20, -v217
    v_fma_f32 v175, v175, s20, -v217
    v_fma_f32 v176, v176, s20, -v218
    ds_read_b128 a[164:167], v232 offset:18560
    v_fma_f32 v177, v177, s20, -v218
    v_fma_f32 v178, v178, s20, -v218
    v_fma_f32 v179, v179, s20, -v218
    ds_read_b128 a[168:171], v233 offset:12416
    s_mov_b32 s22, s23
    s_add_u32 s54, s54, 18087936
    s_add_u32 s33, s22, 25165824
    s_cmp_lt_u32 s30, 3
    s_cselect_b32 s23, s33, 0x80000000
    s_cselect_b32 s27, s54, 0x80000000
    s_add_u32 s28, s27, 6144
    s_add_u32 s29, s27, 12288
    s_or_b32 s29, s29, s53
    s_waitcnt vmcnt(38)
    s_branch L_noepi
L_unit:
    v_rcp_f32 v228, v144
    v_rcp_f32 v230, v148
    v_rcp_f32 v252, v152
    s_nop 0
    v_pk_mul_f32 v[0:1], v[0:1], v[228:229] op_sel_hi:[1,0]
    v_pk_mul_f32 v[2:3], v[2:3], v[228:229] op_sel_hi:[1,0]
    v_pk_mul_f32 v[4:5], v[4:5], v[228:229] op_sel_hi:[1,0]
    v_pk_mul_f32 v[6:7], v[6:7], v[228:229] op_sel_hi:[1,0]
    v_cvt_pk_bf16_f32 v220, v0, v1
    v_cvt_pk_bf16_f32 v221, v2, v3
    v_cvt_pk_bf16_f32 v222, v4, v5
    v_cvt_pk_bf16_f32 v223, v6, v7
    ds_write_b64 v234, v[220:221] offset:0
    ds_write_b64 v235, v[222:223] offset:0
    v_pk_mul_f32 v[8:9], v[8:9], v[228:229] op_sel_hi:[1,0]
    v_pk_mul_f32 v[10:11], v[10:11], v[228:229] op_sel_hi:[1,0]
    v_pk_mul_f32 v[12:13], v[12:13], v[228:229] op_sel_hi:[1,0]
    v_pk_mul_f32 v[14:15], v[14:15], v[228:229] op_sel_hi:[1,0]
    v_cvt_pk_bf16_f32 v224, v8, v9
    v_cvt_pk_bf16_f32 v225, v10, v11
    v_cvt_pk_bf16_f32 v226, v12, v13
    v_cvt_pk_bf16_f32 v227, v14, v15
    ds_write_b64 v234, v[224:225] offset:64
    ds_write_b64 v235, v[226:227] offset:64
    v_pk_mul_f32 v[16:17], v[16:17], v[228:229] op_sel_hi:[1,0]
    v_pk_mul_f32 v[18:19], v[18:19], v[228:229] op_sel_hi:[1,0]
    v_pk_mul_f32 v[20:21], v[20:21], v[228:229] op_sel_hi:[1,0]
    v_pk_mul_f32 v[22:23], v[22:23], v[228:229] op_sel_hi:[1,0]
    v_cvt_pk_bf16_f32 v220, v16, v17
    v_cvt_pk_bf16_f32 v221, v18, v19
    v_cvt_pk_bf16_f32 v222, v20, v21
    v_cvt_pk_bf16_f32 v223, v22, v23
    ds_write_b64 v234, v[220:221] offset:128
    ds_write_b64 v235, v[222:223] offset:128
    v_pk_mul_f32 v[24:25], v[24:25], v[228:229] op_sel_hi:[1,0]
    v_pk_mul_f32 v[26:27], v[26:27], v[228:229] op_sel_hi:[1,0]
    v_pk_mul_f32 v[28:29], v[28:29], v[228:229] op_sel_hi:[1,0]
    v_pk_mul_f32 v[30:31], v[30:31], v[228:229] op_sel_hi:[1,0]
    v_cvt_pk_bf16_f32 v224, v24, v25
    v_cvt_pk_bf16_f32 v225, v26, v27
    v_cvt_pk_bf16_f32 v226, v28, v29
    v_cvt_pk_bf16_f32 v227, v30, v31
    ds_write_b64 v234, v[224:225] offset:192
    ds_write_b64 v235, v[226:227] offset:192
    v_pk_mul_f32 v[32:33], v[32:33], v[228:229] op_sel_hi:[1,0]
    v_pk_mul_f32 v[34:35], v[34:35], v[228:229] op_sel_hi:[1,0]
    v_pk_mul_f32 v[36:37], v[36:37], v[228:229] op_sel_hi:[1,0]
    v_pk_mul_f32 v[38:39], v[38:39], v[228:229] op_sel_hi:[1,0]
    v_cvt_pk_bf16_f32 v220, v32, v33
    v_cvt_pk_bf16_f32 v221, v34, v35
    v_cvt_pk_bf16_f32 v222, v36, v37
    v_cvt_pk_bf16_f32 v223, v38, v39
    ds_write_b64 v234, v[220:221] offset:256
    ds_write_b64 v235, v[222:223] offset:256
    v_pk_mul_f32 v[40:41], v[40:41], v[228:229] op_sel_hi:[1,0]
    v_pk_mul_f32 v[42:43], v[42:43], v[228:229] op_sel_hi:[1,0]
    v_pk_mul_f32 v[44:45], v[44:45], v[228:229] op_sel_hi:[1,0]
    v_pk_mul_f32 v[46:47], v[46:47], v[228:229] op_sel_hi:[1,0]
    v_cvt_pk_bf16_f32 v224, v40, v41
    v_cvt_pk_bf16_f32 v225, v42, v43
    v_cvt_pk_bf16_f32 v226, v44, v45
    v_cvt_pk_bf16_f32 v227, v46, v47
    ds_write_b64 v234, v[224:225] offset:320
    ds_write_b64 v235, v[226:227] offset:320
    ds_read_b128 a[180:183], v240 offset:0
    ds_read_b128 a[184:187], v241 offset:0
    ds_read_b128 a[188:191], v242 offset:0
    ds_read_b128 a[192:195], v240 offset:3200
    ds_read_b128 a[196:199], v241 offset:3200
    ds_read_b128 a[200:203], v242 offset:3200
    v_pk_mul_f32 v[48:49], v[48:49], v[230:231] op_sel_hi:[1,0]
    v_pk_mul_f32 v[50:51], v[50:51], v[230:231] op_sel_hi:[1,0]
    v_pk_mul_f32 v[52:53], v[52:53], v[230:231] op_sel_hi:[1,0]
    v_pk_mul_f32 v[54:55], v[54:55], v[230:231] op_sel_hi:[1,0]
    v_cvt_pk_bf16_f32 v220, v48, v49
    v_cvt_pk_bf16_f32 v221, v50, v51
    v_cvt_pk_bf16_f32 v222, v52, v53
    v_cvt_pk_bf16_f32 v223, v54, v55
    ds_write_b64 v234, v[220:221] offset:0
    ds_write_b64 v235, v[222:223] offset:0
    v_pk_mul_f32 v[56:57], v[56:57], v[230:231] op_sel_hi:[1,0]
    v_pk_mul_f32 v[58:59], v[58:59], v[230:231] op_sel_hi:[1,0]
    v_pk_mul_f32 v[60:61], v[60:61], v[230:231] op_sel_hi:[1,0]
    v_pk_mul_f32 v[62:63], v[62:63], v[230:231] op_sel_hi:[1,0]
    v_cvt_pk_bf16_f32 v224, v56, v57
    v_cvt_pk_bf16_f32 v225, v58, v59
    v_cvt_pk_bf16_f32 v226, v60, v61
    v_cvt_pk_bf16_f32 v227, v62, v63
    ds_write_b64 v234, v[224:225] offset:64
    ds_write_b64 v235, v[226:227] offset:64
    v_pk_mul_f32 v[64:65], v[64:65], v[230:231] op_sel_hi:[1,0]
    v_pk_mul_f32 v[66:67], v[66:67], v[230:231] op_sel_hi:[1,0]
    v_pk_mul_f32 v[68:69], v[68:69], v[230:231] op_sel_hi:[1,0]
    v_pk_mul_f32 v[70:71], v[70:71], v[230:231] op_sel_hi:[1,0]
    v_cvt_pk_bf16_f32 v220, v64, v65
    v_cvt_pk_bf16_f32 v221, v66, v67
    v_cvt_pk_bf16_f32 v222, v68, v69
    v_cvt_pk_bf16_f32 v223, v70, v71
    ds_write_b64 v234, v[220:221] offset:128
    ds_write_b64 v235, v[222:223] offset:128
    v_pk_mul_f32 v[72:73], v[72:73], v[230:231] op_sel_hi:[1,0]
    v_pk_mul_f32 v[74:75], v[74:75], v[230:231] op_sel_hi:[1,0]
    v_pk_mul_f32 v[76:77], v[76:77], v[230:231] op_sel_hi:[1,0]
    v_pk_mul_f32 v[78:79], v[78:79], v[230:231] op_sel_hi:[1,0]
    v_cvt_pk_bf16_f32 v224, v72, v73
    v_cvt_pk_bf16_f32 v225, v74, v75
    v_cvt_pk_bf16_f32 v226, v76, v77
    v_cvt_pk_bf16_f32 v227, v78, v79
    ds_write_b64 v234, v[224:225] offset:192
    ds_write_b64 v235, v[226:227] offset:192
    v_pk_mul_f32 v[80:81], v[80:81], v[230:231] op_sel_hi:[1,0]
    v_pk_mul_f32 v[82:83], v[82:83], v[230:231] op_sel_hi:[1,0]
    v_pk_mul_f32 v[84:85], v[84:85], v[230:231] op_sel_hi:[1,0]
    v_pk_mul_f32 v[86:87], v[86:87], v[230:231] op_sel_hi:[1,0]
    v_cvt_pk_bf16_f32 v220, v80, v81
    v_cvt_pk_bf16_f32 v221, v82, v83
    v_cvt_pk_bf16_f32 v222, v84, v85
    v_cvt_pk_bf16_f32 v223, v86, v87
    ds_write_b64 v234, v[220:221] offset:256
    ds_write_b64 v235, v[222:223] offset:256
    v_pk_mul_f32 v[88:89], v[88:89], v[230:231] op_sel_hi:[1,0]
    v_pk_mul_f32 v[90:91], v[90:91], v[230:231] op_sel_hi:[1,0]
    v_pk_mul_f32 v[92:93], v[92:93], v[230:231] op_sel_hi:[1,0]
    v_pk_mul_f32 v[94:95], v[94:95], v[230:231] op_sel_hi:[1,0]
    v_cvt_pk_bf16_f32 v224, v88, v89
    v_cvt_pk_bf16_f32 v225, v90, v91
    v_cvt_pk_bf16_f32 v226, v92, v93
    v_cvt_pk_bf16_f32 v227, v94, v95
    ds_write_b64 v234, v[224:225] offset:320
    ds_write_b64 v235, v[226:227] offset:320
    ds_read_b128 a[204:207], v240 offset:0
    ds_read_b128 a[208:211], v241 offset:0
    ds_read_b128 a[212:215], v242 offset:0
    ds_read_b128 a[216:219], v240 offset:3200
    ds_read_b128 a[220:223], v241 offset:3200
    ds_read_b128 a[224:227], v242 offset:3200
    v_pk_mul_f32 v[96:97], v[96:97], v[252:253] op_sel_hi:[1,0]
    v_pk_mul_f32 v[98:99], v[98:99], v[252:253] op_sel_hi:[1,0]
    v_pk_mul_f32 v[100:101], v[100:101], v[252:253] op_sel_hi:[1,0]
    v_pk_mul_f32 v[102:103], v[102:103], v[252:253] op_sel_hi:[1,0]
    v_cvt_pk_bf16_f32 v220, v96, v97
    v_cvt_pk_bf16_f32 v221, v98, v99
    v_cvt_pk_bf16_f32 v222, v100, v101
    v_cvt_pk_bf16_f32 v223, v102, v103
    ds_write_b64 v234, v[220:221] offset:0
    ds_write_b64 v235, v[222:223] offset:0
    v_pk_mul_f32 v[104:105], v[104:105], v[252:253] op_sel_hi:[1,0]
    v_pk_mul_f32 v[106:107], v[106:107], v[252:253] op_sel_hi:[1,0]
    v_pk_mul_f32 v[108:109], v[108:109], v[252:253] op_sel_hi:[1,0]
    v_pk_mul_f32 v[110:111], v[110:111], v[252:253] op_sel_hi:[1,0]
    v_cvt_pk_bf16_f32 v224, v104, v105
    v_cvt_pk_bf16_f32 v225, v106, v107
    v_cvt_pk_bf16_f32 v226, v108, v109
    v_cvt_pk_bf16_f32 v227, v110, v111
    ds_write_b64 v234, v[224:225] offset:64
    ds_write_b64 v235, v[226:227] offset:64
    v_pk_mul_f32 v[112:113], v[112:113], v[252:253] op_sel_hi:[1,0]
    v_pk_mul_f32 v[114:115], v[114:115], v[252:253] op_sel_hi:[1,0]
    v_pk_mul_f32 v[116:117], v[116:117], v[252:253] op_sel_hi:[1,0]
    v_pk_mul_f32 v[118:119], v[118:119], v[252:253] op_sel_hi:[1,0]
    v_cvt_pk_bf16_f32 v220, v112, v113
    v_cvt_pk_bf16_f32 v221, v114, v115
    v_cvt_pk_bf16_f32 v222, v116, v117
    v_cvt_pk_bf16_f32 v223, v118, v119
    ds_write_b64 v234, v[220:221] offset:128
    ds_write_b64 v235, v[222:223] offset:128
    v_pk_mul_f32 v[120:121], v[120:121], v[252:253] op_sel_hi:[1,0]
    v_pk_mul_f32 v[122:123], v[122:123], v[252:253] op_sel_hi:[1,0]
    v_pk_mul_f32 v[124:125], v[124:125], v[252:253] op_sel_hi:[1,0]
    v_pk_mul_f32 v[126:127], v[126:127], v[252:253] op_sel_hi:[1,0]
    v_cvt_pk_bf16_f32 v224, v120, v121
    v_cvt_pk_bf16_f32 v225, v122, v123
    v_cvt_pk_bf16_f32 v226, v124, v125
    v_cvt_pk_bf16_f32 v227, v126, v127
    ds_write_b64 v234, v[224:225] offset:192
    ds_write_b64 v235, v[226:227] offset:192
    v_pk_mul_f32 v[128:129], v[128:129], v[252:253] op_sel_hi:[1,0]
    v_pk_mul_f32 v[130:131], v[130:131], v[252:253] op_sel_hi:[1,0]
    v_pk_mul_f32 v[132:133], v[132:133], v[252:253] op_sel_hi:[1,0]
    v_pk_mul_f32 v[134:135], v[134:135], v[252:253] op_sel_hi:[1,0]
    v_cvt_pk_bf16_f32 v220, v128, v129
    v_cvt_pk_bf16_f32 v221, v130, v131
    v_cvt_pk_bf16_f32 v222, v132, v133
    v_cvt_pk_bf16_f32 v223, v134, v135
    ds_write_b64 v234, v[220:221] offset:256
    ds_write_b64 v235, v[222:223] offset:256
    v_pk_mul_f32 v[136:137], v[136:137], v[252:253] op_sel_hi:[1,0]
    v_pk_mul_f32 v[138:139], v[138:139], v[252:253] op_sel_hi:[1,0]
    v_pk_mul_f32 v[140:141], v[140:141], v[252:253] op_sel_hi:[1,0]
    v_pk_mul_f32 v[142:143], v[142:143], v[252:253] op_sel_hi:[1,0]
    v_cvt_pk_bf16_f32 v224, v136, v137
    v_cvt_pk_bf16_f32 v225, v138, v139
    v_cvt_pk_bf16_f32 v226, v140, v141
    v_cvt_pk_bf16_f32 v227, v142, v143
    ds_write_b64 v234, v[224:225] offset:320
    ds_write_b64 v235, v[226:227] offset:320
    ds_read_b128 a[228:231], v240 offset:0
    ds_read_b128 a[232:235], v241 offset:0
    ds_read_b128 a[236:239], v242 offset:0
    ds_read_b128 a[240:243], v240 offset:3200
    ds_read_b128 a[244:247], v241 offset:3200
    ds_read_b128 a[248:251], v242 offset:3200
L_noepi:
    s_waitcnt lgkmcnt(3)
    v_mfma_f32_16x16x32_bf16 v[180:183], a[144:147], a[0:3], 0
    v_exp_f32 v156, v156
    v_exp_f32 v157, v157
    v_mfma_f32_16x16x32_bf16 v[184:187], a[144:147], a[24:27], 0
    ds_read_b128 a[172:175], v233 offset:18560
    v_mfma_f32_16x16x32_bf16 v[188:191], a[144:147], a[48:51], 0
    buffer_load_dwordx4 v249, s[12:15], s32 offen offset:2048 lds
    v_mfma_f32_16x16x32_bf16 v[192:195], a[148:151], a[0:3], 0
    v_exp_f32 v158, v158
    v_exp_f32 v159, v159
    v_mfma_f32_16x16x32_bf16 v[196:199], a[148:151], a[24:27], 0
    v_cvt_pk_bf16_f32 v204, v156, v157
    v_exp_f32 v168, v168
    v_mfma_f32_16x16x32_bf16 v[200:203], a[148:151], a[48:51], 0
    v_exp_f32 v169, v169
    ds_read_b128 a[144:147], v232 offset:12544
    v_mfma_f32_16x16x32_bf16 v[180:183], a[152:155], a[4:7], v[180:183]
    v_cvt_pk_bf16_f32 v205, v158, v159
    v_exp_f32 v170, v170
    v_mfma_f32_16x16x32_bf16 v[184:187], a[152:155], a[28:31], v[184:187]
    v_exp_f32 v171, v171
    v_cvt_pk_bf16_f32 v206, v168, v169
    v_mfma_f32_16x16x32_bf16 v[188:191], a[152:155], a[52:55], v[188:191]
    v_exp_f32 v160, v160
    ds_read_b128 a[148:151], v232 offset:18688
    v_mfma_f32_16x16x32_bf16 v[192:195], a[156:159], a[4:7], v[192:195]
    v_exp_f32 v161, v161
    v_cvt_pk_bf16_f32 v207, v170, v171
    v_mfma_f32_16x16x32_bf16 v[196:199], a[156:159], a[28:31], v[196:199]
    v_exp_f32 v162, v162
    v_exp_f32 v163, v163
    v_mfma_f32_16x16x32_bf16 v[200:203], a[156:159], a[52:55], v[200:203]
    ds_read_b128 a[152:155], v233 offset:12544
    s_waitcnt lgkmcnt(3)
    v_mfma_f32_16x16x32_bf16 v[180:183], a[160:163], a[8:11], v[180:183]
    v_cvt_pk_bf16_f32 v208, v160, v161
    ds_read_b128 a[156:159], v233 offset:18688
    v_mfma_f32_16x16x32_bf16 v[184:187], a[160:163], a[32:35], v[184:187]
    s_add_u32 m0, s21, 0
    s_add_u32 s31, s22, 49152
    v_mfma_f32_16x16x32_bf16 v[188:191], a[160:163], a[56:59], v[188:191]
    buffer_load_dwordx4 v244, s[8:11], s31 offen offset:0 nt lds
    v_mfma_f32_16x16x32_bf16 v[192:195], a[164:167], a[8:11], v[192:195]
    v_exp_f32 v172, v172
    v_exp_f32 v173, v173
    v_mfma_f32_16x16x32_bf16 v[196:199], a[164:167], a[32:35], v[196:199]
    v_cvt_pk_bf16_f32 v209, v162, v163
    v_exp_f32 v174, v174
    v_mfma_f32_16x16x32_bf16 v[200:203], a[164:167], a[56:59], v[200:203]
    ds_read_b64_tr_b16 a[160:161], v236 offset:0
    ds_read_b64_tr_b16 a[162:163], v236 offset:6144
    v_mfma_f32_16x16x32_bf16 v[180:183], a[168:171], a[12:15], v[180:183]
    v_exp_f32 v175, v175
    v_cvt_pk_bf16_f32 v210, v172, v173
    v_mfma_f32_16x16x32_bf16 v[184:187], a[168:171], a[36:39], v[184:187]
    v_exp_f32 v164, v164
    ds_read_b64_tr_b16 a[164:165], v237 offset:0
    v_mfma_f32_16x16x32_bf16 v[188:191], a[168:171], a[60:63], v[188:191]
    ds_read_b64_tr_b16 a[166:167], v237 offset:6144
    v_mfma_f32_16x16x32_bf16 v[192:195], a[172:175], a[12:15], v[192:195]
    v_exp_f32 v165, v165
    v_cvt_pk_bf16_f32 v211, v174, v175
    v_mfma_f32_16x16x32_bf16 v[196:199], a[172:175], a[36:39], v[196:199]
    v_exp_f32 v166, v166
    ds_read_b64_tr_b16 a[168:169], v238 offset:0
    v_mfma_f32_16x16x32_bf16 v[200:203], a[172:175], a[60:63], v[200:203]
    ds_read_b64_tr_b16 a[170:171], v238 offset:6144
    s_waitcnt lgkmcnt(6)
    v_mfma_f32_16x16x32_bf16 v[180:183], a[144:147], a[16:19], v[180:183]
    ds_read_b64_tr_b16 a[172:173], v239 offset:0
    ds_read_b64_tr_b16 a[174:175], v239 offset:6144
    v_mfma_f32_16x16x32_bf16 v[184:187], a[144:147], a[40:43], v[184:187]
    buffer_load_dwordx4 v245, s[8:11], s31 offen offset:1024 nt lds
    v_mfma_f32_16x16x32_bf16 v[188:191], a[144:147], a[64:67], v[188:191]
    buffer_store_dwordx4 a[180:183], v243, s[16:19], s24 offen offset:0
    v_mfma_f32_16x16x32_bf16 v[192:195], a[148:151], a[16:19], v[192:195]
    v_exp_f32 v167, v167
    v_cvt_pk_bf16_f32 v212, v164, v165
    v_mfma_f32_16x16x32_bf16 v[196:199], a[148:151], a[40:43], v[196:199]
    ds_read_b64_tr_b16 a[144:145], v236 offset:128
    ds_read_b64_tr_b16 a[146:147], v236 offset:6272
    v_mfma_f32_16x16x32_bf16 v[200:203], a[148:151], a[64:67], v[200:203]
    buffer_store_dwordx4 a[184:187], v243, s[16:19], s24 offen offset:1024
    v_mfma_f32_16x16x32_bf16 v[180:183], a[152:155], a[20:23], v[180:183]
    v_exp_f32 v176, v176
    v_exp_f32 v177, v177
    v_mfma_f32_16x16x32_bf16 v[184:187], a[152:155], a[44:47], v[184:187]
    v_cvt_pk_bf16_f32 v213, v166, v167
    ds_read_b64_tr_b16 a[148:149], v237 offset:128
    v_mfma_f32_16x16x32_bf16 v[188:191], a[152:155], a[68:71], v[188:191]
    ds_read_b64_tr_b16 a[150:151], v237 offset:6272
    v_mfma_f32_16x16x32_bf16 v[192:195], a[156:159], a[20:23], v[192:195]
    v_exp_f32 v178, v178
    v_exp_f32 v179, v179
    v_mfma_f32_16x16x32_bf16 v[196:199], a[156:159], a[44:47], v[196:199]
    v_cvt_pk_bf16_f32 v214, v176, v177
    ds_read_b64_tr_b16 a[152:153], v238 offset:128
    v_mfma_f32_16x16x32_bf16 v[200:203], a[156:159], a[68:71], v[200:203]
    ds_read_b64_tr_b16 a[154:155], v238 offset:6272
    v_cvt_pk_bf16_f32 v215, v178, v179
    s_nop 0
    v_mfma_f32_16x16x32_bf16 v[144:147], a[176:179], v[204:207], 0
    v_fma_f32 v180, v180, s20, -v216
    v_fma_f32 v181, v181, s20, -v216
    v_mfma_f32_16x16x32_bf16 v[148:151], a[176:179], v[208:211], 0
    v_fma_f32 v182, v182, s20, -v216
    v_max3_f32 v251, v180, v181, v182
    v_mfma_f32_16x16x32_bf16 v[152:155], a[176:179], v[212:215], 0
    v_fma_f32 v183, v183, s20, -v216
    v_fma_f32 v184, v184, s20, -v217
    s_waitcnt lgkmcnt(6)
    v_mfma_f32_16x16x32_bf16 v[0:3], a[160:163], v[204:207], 0
    ds_read_b64_tr_b16 a[156:157], v239 offset:128
    v_mfma_f32_16x16x32_bf16 v[48:51], a[160:163], v[208:211], 0
    ds_read_b64_tr_b16 a[158:159], v239 offset:6272
    v_mfma_f32_16x16x32_bf16 v[96:99], a[160:163], v[212:215], 0
    buffer_load_dwordx4 v246, s[8:11], s31 offen offset:2048 nt lds
    v_mfma_f32_16x16x32_bf16 v[4:7], a[164:167], v[204:207], 0
    v_max3_f32 v251, v251, v183, v184
    v_fma_f32 v185, v185, s20, -v217
    v_mfma_f32_16x16x32_bf16 v[52:55], a[164:167], v[208:211], 0
    v_fma_f32 v186, v186, s20, -v217
    ds_read_b64_tr_b16 a[160:161], v236 offset:256
    v_mfma_f32_16x16x32_bf16 v[100:103], a[164:167], v[212:215], 0
    ds_read_b64_tr_b16 a[162:163], v236 offset:6400
    v_mfma_f32_16x16x32_bf16 v[8:11], a[168:171], v[204:207], 0
    v_max3_f32 v251, v251, v185, v186
    v_fma_f32 v187, v187, s20, -v217
    v_mfma_f32_16x16x32_bf16 v[56:59], a[168:171], v[208:211], 0
    v_fma_f32 v188, v188, s20, -v218
    ds_read_b64_tr_b16 a[164:165], v237 offset:256
    v_mfma_f32_16x16x32_bf16 v[104:107], a[168:171], v[212:215], 0
    ds_read_b64_tr_b16 a[166:167], v237 offset:6400
    v_mfma_f32_16x16x32_bf16 v[12:15], a[172:175], v[204:207], 0
    ds_read_b64_tr_b16 a[168:169], v238 offset:256
    v_mfma_f32_16x16x32_bf16 v[60:63], a[172:175], v[208:211], 0
    v_mfma_f32_16x16x32_bf16 v[108:111], a[172:175], v[212:215], 0
    ds_read_b64_tr_b16 a[170:171], v238 offset:6400
    s_waitcnt vmcnt(8)
    s_barrier
    s_waitcnt lgkmcnt(6)
    v_mfma_f32_16x16x32_bf16 v[16:19], a[144:147], v[204:207], 0
    ds_read_b64_tr_b16 a[172:173], v239 offset:256
    ds_read_b64_tr_b16 a[174:175], v239 offset:6400
    v_mfma_f32_16x16x32_bf16 v[64:67], a[144:147], v[208:211], 0
    s_add_u32 m0, s21, 86016
    s_add_u32 s32, s22, 36864
    v_mfma_f32_16x16x32_bf16 v[112:115], a[144:147], v[212:215], 0
    buffer_load_dwordx4 v247, s[12:15], s32 offen offset:0 lds
    v_mfma_f32_16x16x32_bf16 v[20:23], a[148:151], v[204:207], 0
    v_max3_f32 v251, v251, v187, v188
    v_fma_f32 v189, v189, s20, -v218
    v_mfma_f32_16x16x32_bf16 v[68:71], a[148:151], v[208:211], 0
    v_fma_f32 v190, v190, s20, -v218
    v_max3_f32 v251, v251, v189, v190
    v_mfma_f32_16x16x32_bf16 v[116:119], a[148:151], v[212:215], 0
    ds_read_b128 a[144:147], v232 offset:24576
    v_mfma_f32_16x16x32_bf16 v[24:27], a[152:155], v[204:207], 0
    v_fma_f32 v191, v191, s20, -v218
    v_fma_f32 v192, v192, s20, -v216
    v_mfma_f32_16x16x32_bf16 v[72:75], a[152:155], v[208:211], 0
    v_max3_f32 v251, v251, v191, v192
    v_fma_f32 v193, v193, s20, -v216
    v_fma_f32 v194, v194, s20, -v216
    v_mfma_f32_16x16x32_bf16 v[120:123], a[152:155], v[212:215], 0
    ds_read_b128 a[148:151], v232 offset:30720
    v_mfma_f32_16x16x32_bf16 v[28:31], a[156:159], v[204:207], 0
    v_max3_f32 v251, v251, v193, v194
    v_fma_f32 v195, v195, s20, -v216
    v_mfma_f32_16x16x32_bf16 v[76:79], a[156:159], v[208:211], 0
    v_fma_f32 v196, v196, s20, -v217
    v_max3_f32 v251, v251, v195, v196
    v_mfma_f32_16x16x32_bf16 v[124:127], a[156:159], v[212:215], 0
    ds_read_b128 a[152:155], v233 offset:24576
    s_waitcnt lgkmcnt(3)
    v_mfma_f32_16x16x32_bf16 v[32:35], a[160:163], v[204:207], 0
    v_fma_f32 v197, v197, s20, -v217
    v_fma_f32 v198, v198, s20, -v217
    v_mfma_f32_16x16x32_bf16 v[80:83], a[160:163], v[208:211], 0
    ds_read_b128 a[156:159], v233 offset:30720
    v_mfma_f32_16x16x32_bf16 v[128:131], a[160:163], v[212:215], 0
    buffer_load_dwordx4 v248, s[12:15], s32 offen offset:1024 lds
    v_mfma_f32_16x16x32_bf16 v[36:39], a[164:167], v[204:207], 0
    v_max3_f32 v251, v251, v197, v198
    v_fma_f32 v199, v199, s20, -v217
    v_mfma_f32_16x16x32_bf16 v[84:87], a[164:167], v[208:211], 0
    v_fma_f32 v200, v200, s20, -v218
    v_max3_f32 v251, v251, v199, v200
    v_fma_f32 v201, v201, s20, -v218
    v_mfma_f32_16x16x32_bf16 v[132:135], a[164:167], v[212:215], 0
    ds_read_b128 a[160:163], v232 offset:24704
    v_mfma_f32_16x16x32_bf16 v[40:43], a[168:171], v[204:207], 0
    v_fma_f32 v202, v202, s20, -v218
    v_max3_f32 v251, v251, v201, v202
    v_mfma_f32_16x16x32_bf16 v[88:91], a[168:171], v[208:211], 0
    v_fma_f32 v203, v203, s20, -v218
    v_max_f32 v251, v251, v203
    v_cmp_lt_f32 vcc, 0x41000000, v251
    v_mfma_f32_16x16x32_bf16 v[136:139], a[168:171], v[212:215], 0
    ds_read_b128 a[164:167], v232 offset:30848
    v_mfma_f32_16x16x32_bf16 v[44:47], a[172:175], v[204:207], 0
    v_mfma_f32_16x16x32_bf16 v[92:95], a[172:175], v[208:211], 0
    ds_read_b128 a[168:171], v233 offset:24704
    v_mfma_f32_16x16x32_bf16 v[140:143], a[172:175], v[212:215], 0
    s_cbranch_vccnz L_rare0
L_back0:
    s_waitcnt lgkmcnt(3)
    v_mfma_f32_16x16x32_bf16 v[156:159], a[144:147], a[0:3], 0
    v_exp_f32 v180, v180
    v_exp_f32 v181, v181
    v_mfma_f32_16x16x32_bf16 v[160:163], a[144:147], a[24:27], 0
    ds_read_b128 a[172:175], v233 offset:30848
    v_mfma_f32_16x16x32_bf16 v[164:167], a[144:147], a[48:51], 0
    buffer_load_dwordx4 v249, s[12:15], s32 offen offset:2048 lds
    v_mfma_f32_16x16x32_bf16 v[168:171], a[148:151], a[0:3], 0
    v_exp_f32 v182, v182
    v_exp_f32 v183, v183
    v_mfma_f32_16x16x32_bf16 v[172:175], a[148:151], a[24:27], 0
    v_cvt_pk_bf16_f32 v204, v180, v181
    v_exp_f32 v192, v192
    v_mfma_f32_16x16x32_bf16 v[176:179], a[148:151], a[48:51], 0
    ds_read_b128 a[144:147], v232 offset:24832
    v_mfma_f32_16x16x32_bf16 v[156:159], a[152:155], a[4:7], v[156:159]
    v_exp_f32 v193, v193
    v_cvt_pk_bf16_f32 v205, v182, v183
    v_mfma_f32_16x16x32_bf16 v[160:163], a[152:155], a[28:31], v[160:163]
    v_exp_f32 v194, v194
    v_exp_f32 v195, v195
    v_mfma_f32_16x16x32_bf16 v[164:167], a[152:155], a[52:55], v[164:167]
    v_cvt_pk_bf16_f32 v206, v192, v193
    ds_read_b128 a[148:151], v232 offset:30976
    v_mfma_f32_16x16x32_bf16 v[168:171], a[156:159], a[4:7], v[168:171]
    v_exp_f32 v184, v184
    v_exp_f32 v185, v185
    v_mfma_f32_16x16x32_bf16 v[172:175], a[156:159], a[28:31], v[172:175]
    v_cvt_pk_bf16_f32 v207, v194, v195
    v_exp_f32 v186, v186
    v_mfma_f32_16x16x32_bf16 v[176:179], a[156:159], a[52:55], v[176:179]
    ds_read_b128 a[152:155], v233 offset:24832
    s_waitcnt lgkmcnt(3)
    v_mfma_f32_16x16x32_bf16 v[156:159], a[160:163], a[8:11], v[156:159]
    v_exp_f32 v187, v187
    ds_read_b128 a[156:159], v233 offset:30976
    v_mfma_f32_16x16x32_bf16 v[160:163], a[160:163], a[32:35], v[160:163]
    s_add_u32 m0, s21, 12288
    s_add_u32 s31, s22, 61440
    v_mfma_f32_16x16x32_bf16 v[164:167], a[160:163], a[56:59], v[164:167]
    buffer_load_dwordx4 v244, s[8:11], s31 offen offset:0 nt lds
    buffer_load_dwordx4 a[72:75], v250, s[4:7], s27 offen offset:0 nt
    v_mfma_f32_16x16x32_bf16 v[168:171], a[164:167], a[8:11], v[168:171]
    v_cvt_pk_bf16_f32 v208, v184, v185
    v_exp_f32 v196, v196
    v_mfma_f32_16x16x32_bf16 v[172:175], a[164:167], a[32:35], v[172:175]
    ds_read_b64_tr_b16 a[160:161], v236 offset:12288
    v_mfma_f32_16x16x32_bf16 v[176:179], a[164:167], a[56:59], v[176:179]
    ds_read_b64_tr_b16 a[162:163], v236 offset:18432
    buffer_load_dwordx4 a[76:79], v250, s[4:7], s27 offen offset:64 nt
    v_mfma_f32_16x16x32_bf16 v[156:159], a[168:171], a[12:15], v[156:159]
    v_exp_f32 v197, v197
    v_cvt_pk_bf16_f32 v209, v186, v187
    v_mfma_f32_16x16x32_bf16 v[160:163], a[168:171], a[36:39], v[160:163]
    v_exp_f32 v198, v198
    ds_read_b64_tr_b16 a[164:165], v237 offset:12288
    v_mfma_f32_16x16x32_bf16 v[164:167], a[168:171], a[60:63], v[164:167]
    ds_read_b64_tr_b16 a[166:167], v237 offset:18432
    v_mfma_f32_16x16x32_bf16 v[168:171], a[172:175], a[12:15], v[168:171]
    v_exp_f32 v199, v199
    v_cvt_pk_bf16_f32 v210, v196, v197
    v_mfma_f32_16x16x32_bf16 v[172:175], a[172:175], a[36:39], v[172:175]
    v_exp_f32 v188, v188
    ds_read_b64_tr_b16 a[168:169], v238 offset:12288
    v_mfma_f32_16x16x32_bf16 v[176:179], a[172:175], a[60:63], v[176:179]
    ds_read_b64_tr_b16 a[170:171], v238 offset:18432
    s_waitcnt lgkmcnt(6)
    v_mfma_f32_16x16x32_bf16 v[156:159], a[144:147], a[16:19], v[156:159]
    v_exp_f32 v189, v189
    v_cvt_pk_bf16_f32 v211, v198, v199
    v_mfma_f32_16x16x32_bf16 v[160:163], a[144:147], a[40:43], v[160:163]
    ds_read_b64_tr_b16 a[172:173], v239 offset:12288
    ds_read_b64_tr_b16 a[174:175], v239 offset:18432
    v_mfma_f32_16x16x32_bf16 v[164:167], a[144:147], a[64:67], v[164:167]
    buffer_load_dwordx4 v245, s[8:11], s31 offen offset:1024 nt lds
    v_mfma_f32_16x16x32_bf16 v[168:171], a[148:151], a[16:19], v[168:171]
    v_exp_f32 v190, v190
    v_exp_f32 v191, v191
    v_mfma_f32_16x16x32_bf16 v[172:175], a[148:151], a[40:43], v[172:175]
    v_cvt_pk_bf16_f32 v212, v188, v189
    ds_read_b64_tr_b16 a[144:145], v236 offset:12416
    v_mfma_f32_16x16x32_bf16 v[176:179], a[148:151], a[64:67], v[176:179]
    ds_read_b64_tr_b16 a[146:147], v236 offset:18560
    v_mfma_f32_16x16x32_bf16 v[156:159], a[152:155], a[20:23], v[156:159]
    v_exp_f32 v200, v200
    v_exp_f32 v201, v201
    v_mfma_f32_16x16x32_bf16 v[160:163], a[152:155], a[44:47], v[160:163]
    v_cvt_pk_bf16_f32 v213, v190, v191
    ds_read_b64_tr_b16 a[148:149], v237 offset:12416
    v_mfma_f32_16x16x32_bf16 v[164:167], a[152:155], a[68:71], v[164:167]
    ds_read_b64_tr_b16 a[150:151], v237 offset:18560
    v_mfma_f32_16x16x32_bf16 v[168:171], a[156:159], a[20:23], v[168:171]
    v_exp_f32 v202, v202
    v_exp_f32 v203, v203
    v_mfma_f32_16x16x32_bf16 v[172:175], a[156:159], a[44:47], v[172:175]
    v_cvt_pk_bf16_f32 v214, v200, v201
    ds_read_b64_tr_b16 a[152:153], v238 offset:12416
    v_mfma_f32_16x16x32_bf16 v[176:179], a[156:159], a[68:71], v[176:179]
    ds_read_b64_tr_b16 a[154:155], v238 offset:18560
    v_cvt_pk_bf16_f32 v215, v202, v203
    s_nop 0
    v_mfma_f32_16x16x32_bf16 v[144:147], a[176:179], v[204:207], v[144:147]
    v_fma_f32 v156, v156, s20, -v216
    v_fma_f32 v157, v157, s20, -v216
    v_mfma_f32_16x16x32_bf16 v[148:151], a[176:179], v[208:211], v[148:151]
    v_fma_f32 v158, v158, s20, -v216
    v_max3_f32 v251, v156, v157, v158
    v_mfma_f32_16x16x32_bf16 v[152:155], a[176:179], v[212:215], v[152:155]
    v_fma_f32 v159, v159, s20, -v216
    v_fma_f32 v160, v160, s20, -v217
    s_waitcnt lgkmcnt(6)
    v_mfma_f32_16x16x32_bf16 v[0:3], a[160:163], v[204:207], v[0:3]
    ds_read_b64_tr_b16 a[156:157], v239 offset:12416
    v_mfma_f32_16x16x32_bf16 v[48:51], a[160:163], v[208:211], v[48:51]
    ds_read_b64_tr_b16 a[158:159], v239 offset:18560
    v_mfma_f32_16x16x32_bf16 v[96:99], a[160:163], v[212:215], v[96:99]
    buffer_load_dwordx4 v246, s[8:11], s31 offen offset:2048 nt lds
    v_mfma_f32_16x16x32_bf16 v[4:7], a[164:167], v[204:207], v[4:7]
    v_max3_f32 v251, v251, v159, v160
    v_fma_f32 v161, v161, s20, -v217
    v_mfma_f32_16x16x32_bf16 v[52:55], a[164:167], v[208:211], v[52:55]
    v_fma_f32 v162, v162, s20, -v217
    ds_read_b64_tr_b16 a[160:161], v236 offset:12544
    v_mfma_f32_16x16x32_bf16 v[100:103], a[164:167], v[212:215], v[100:103]
    ds_read_b64_tr_b16 a[162:163], v236 offset:18688
    v_mfma_f32_16x16x32_bf16 v[8:11], a[168:171], v[204:207], v[8:11]
    v_max3_f32 v251, v251, v161, v162
    v_fma_f32 v163, v163, s20, -v217
    v_mfma_f32_16x16x32_bf16 v[56:59], a[168:171], v[208:211], v[56:59]
    v_fma_f32 v164, v164, s20, -v218
    ds_read_b64_tr_b16 a[164:165], v237 offset:12544
    v_mfma_f32_16x16x32_bf16 v[104:107], a[168:171], v[212:215], v[104:107]
    ds_read_b64_tr_b16 a[166:167], v237 offset:18688
    v_mfma_f32_16x16x32_bf16 v[12:15], a[172:175], v[204:207], v[12:15]
    ds_read_b64_tr_b16 a[168:169], v238 offset:12544
    v_mfma_f32_16x16x32_bf16 v[60:63], a[172:175], v[208:211], v[60:63]
    v_mfma_f32_16x16x32_bf16 v[108:111], a[172:175], v[212:215], v[108:111]
    ds_read_b64_tr_b16 a[170:171], v238 offset:18688
    s_waitcnt vmcnt(13)
    s_barrier
    s_waitcnt lgkmcnt(6)
    v_mfma_f32_16x16x32_bf16 v[16:19], a[144:147], v[204:207], v[16:19]
    ds_read_b64_tr_b16 a[172:173], v239 offset:12544
    ds_read_b64_tr_b16 a[174:175], v239 offset:18688
    v_mfma_f32_16x16x32_bf16 v[64:67], a[144:147], v[208:211], v[64:67]
    s_add_u32 m0, s21, 49152
    s_add_u32 s32, s22, 49152
    v_mfma_f32_16x16x32_bf16 v[112:115], a[144:147], v[212:215], v[112:115]
    buffer_load_dwordx4 v247, s[12:15], s32 offen offset:0 lds
    v_mfma_f32_16x16x32_bf16 v[20:23], a[148:151], v[204:207], v[20:23]
    v_max3_f32 v251, v251, v163, v164
    v_fma_f32 v165, v165, s20, -v218
    v_mfma_f32_16x16x32_bf16 v[68:71], a[148:151], v[208:211], v[68:71]
    v_fma_f32 v166, v166, s20, -v218
    v_max3_f32 v251, v251, v165, v166
    v_mfma_f32_16x16x32_bf16 v[116:119], a[148:151], v[212:215], v[116:119]
    ds_read_b128 a[144:147], v232 offset:36864
    v_mfma_f32_16x16x32_bf16 v[24:27], a[152:155], v[204:207], v[24:27]
    v_fma_f32 v167, v167, s20, -v218
    v_fma_f32 v168, v168, s20, -v216
    v_mfma_f32_16x16x32_bf16 v[72:75], a[152:155], v[208:211], v[72:75]
    v_max3_f32 v251, v251, v167, v168
    v_fma_f32 v169, v169, s20, -v216
    v_fma_f32 v170, v170, s20, -v216
    v_mfma_f32_16x16x32_bf16 v[120:123], a[152:155], v[212:215], v[120:123]
    ds_read_b128 a[148:151], v232 offset:43008
    v_mfma_f32_16x16x32_bf16 v[28:31], a[156:159], v[204:207], v[28:31]
    v_max3_f32 v251, v251, v169, v170
    v_fma_f32 v171, v171, s20, -v216
    v_mfma_f32_16x16x32_bf16 v[76:79], a[156:159], v[208:211], v[76:79]
    v_fma_f32 v172, v172, s20, -v217
    v_max3_f32 v251, v251, v171, v172
    v_mfma_f32_16x16x32_bf16 v[124:127], a[156:159], v[212:215], v[124:127]
    ds_read_b128 a[152:155], v233 offset:36864
    s_waitcnt lgkmcnt(3)
    v_mfma_f32_16x16x32_bf16 v[32:35], a[160:163], v[204:207], v[32:35]
    v_fma_f32 v173, v173, s20, -v217
    v_fma_f32 v174, v174, s20, -v217
    v_mfma_f32_16x16x32_bf16 v[80:83], a[160:163], v[208:211], v[80:83]
    ds_read_b128 a[156:159], v233 offset:43008
    v_mfma_f32_16x16x32_bf16 v[128:131], a[160:163], v[212:215], v[128:131]
    buffer_load_dwordx4 v248, s[12:15], s32 offen offset:1024 lds
    v_mfma_f32_16x16x32_bf16 v[36:39], a[164:167], v[204:207], v[36:39]
    v_max3_f32 v251, v251, v173, v174
    v_fma_f32 v175, v175, s20, -v217
    v_mfma_f32_16x16x32_bf16 v[84:87], a[164:167], v[208:211], v[84:87]
    v_fma_f32 v176, v176, s20, -v218
    v_max3_f32 v251, v251, v175, v176
    v_fma_f32 v177, v177, s20, -v218
    v_mfma_f32_16x16x32_bf16 v[132:135], a[164:167], v[212:215], v[132:135]
    ds_read_b128 a[160:163], v232 offset:36992
    v_mfma_f32_16x16x32_bf16 v[40:43], a[168:171], v[204:207], v[40:43]
    v_fma_f32 v178, v178, s20, -v218
    v_max3_f32 v251, v251, v177, v178
    v_mfma_f32_16x16x32_bf16 v[88:91], a[168:171], v[208:211], v[88:91]
    v_fma_f32 v179, v179, s20, -v218
    v_max_f32 v251, v251, v179
    v_cmp_lt_f32 vcc, 0x41000000, v251
    v_mfma_f32_16x16x32_bf16 v[136:139], a[168:171], v[212:215], v[136:139]
    ds_read_b128 a[164:167], v232 offset:43136
    v_mfma_f32_16x16x32_bf16 v[44:47], a[172:175], v[204:207], v[44:47]
    v_mfma_f32_16x16x32_bf16 v[92:95], a[172:175], v[208:211], v[92:95]
    ds_read_b128 a[168:171], v233 offset:36992
    v_mfma_f32_16x16x32_bf16 v[140:143], a[172:175], v[212:215], v[140:143]
    s_cbranch_vccnz L_rare1
L_back1:
    s_waitcnt lgkmcnt(3)
    v_mfma_f32_16x16x32_bf16 v[180:183], a[144:147], a[0:3], 0
    v_exp_f32 v156, v156
    v_exp_f32 v157, v157
    v_mfma_f32_16x16x32_bf16 v[184:187], a[144:147], a[24:27], 0
    ds_read_b128 a[172:175], v233 offset:43136
    v_mfma_f32_16x16x32_bf16 v[188:191], a[144:147], a[48:51], 0
    buffer_load_dwordx4 v249, s[12:15], s32 offen offset:2048 lds
    v_mfma_f32_16x16x32_bf16 v[192:195], a[148:151], a[0:3], 0
    v_exp_f32 v158, v158
    v_exp_f32 v159, v159
    v_mfma_f32_16x16x32_bf16 v[196:199], a[148:151], a[24:27], 0
    v_cvt_pk_bf16_f32 v204, v156, v157
    v_exp_f32 v168, v168
    v_mfma_f32_16x16x32_bf16 v[200:203], a[148:151], a[48:51], 0
    v_exp_f32 v169, v169
    ds_read_b128 a[144:147], v232 offset:37120
    v_mfma_f32_16x16x32_bf16 v[180:183], a[152:155], a[4:7], v[180:183]
    v_cvt_pk_bf16_f32 v205, v158, v159
    v_exp_f32 v170, v170
    v_mfma_f32_16x16x32_bf16 v[184:187], a[152:155], a[28:31], v[184:187]
    v_exp_f32 v171, v171
    v_cvt_pk_bf16_f32 v206, v168, v169
    v_mfma_f32_16x16x32_bf16 v[188:191], a[152:155], a[52:55], v[188:191]
    v_exp_f32 v160, v160
    ds_read_b128 a[148:151], v232 offset:43264
    v_mfma_f32_16x16x32_bf16 v[192:195], a[156:159], a[4:7], v[192:195]
    v_exp_f32 v161, v161
    v_cvt_pk_bf16_f32 v207, v170, v171
    v_mfma_f32_16x16x32_bf16 v[196:199], a[156:159], a[28:31], v[196:199]
    v_exp_f32 v162, v162
    v_exp_f32 v163, v163
    v_mfma_f32_16x16x32_bf16 v[200:203], a[156:159], a[52:55], v[200:203]
    ds_read_b128 a[152:155], v233 offset:37120
    s_waitcnt lgkmcnt(3)
    v_mfma_f32_16x16x32_bf16 v[180:183], a[160:163], a[8:11], v[180:183]
    v_cvt_pk_bf16_f32 v208, v160, v161
    ds_read_b128 a[156:159], v233 offset:43264
    v_mfma_f32_16x16x32_bf16 v[184:187], a[160:163], a[32:35], v[184:187]
    s_add_u32 m0, s21, 24576
    s_add_u32 s31, s22, 73728
    v_mfma_f32_16x16x32_bf16 v[188:191], a[160:163], a[56:59], v[188:191]
    buffer_load_dwordx4 v244, s[8:11], s31 offen offset:0 nt lds
    v_mfma_f32_16x16x32_bf16 v[192:195], a[164:167], a[8:11], v[192:195]
    v_exp_f32 v172, v172
    v_exp_f32 v173, v173
    v_mfma_f32_16x16x32_bf16 v[196:199], a[164:167], a[32:35], v[196:199]
    v_cvt_pk_bf16_f32 v209, v162, v163
    v_exp_f32 v174, v174
    v_mfma_f32_16x16x32_bf16 v[200:203], a[164:167], a[56:59], v[200:203]
    ds_read_b64_tr_b16 a[160:161], v236 offset:24576
    ds_read_b64_tr_b16 a[162:163], v236 offset:30720
    v_mfma_f32_16x16x32_bf16 v[180:183], a[168:171], a[12:15], v[180:183]
    v_exp_f32 v175, v175
    v_cvt_pk_bf16_f32 v210, v172, v173
    v_mfma_f32_16x16x32_bf16 v[184:187], a[168:171], a[36:39], v[184:187]
    v_exp_f32 v164, v164
    ds_read_b64_tr_b16 a[164:165], v237 offset:24576
    v_mfma_f32_16x16x32_bf16 v[188:191], a[168:171], a[60:63], v[188:191]
    ds_read_b64_tr_b16 a[166:167], v237 offset:30720
    v_mfma_f32_16x16x32_bf16 v[192:195], a[172:175], a[12:15], v[192:195]
    v_exp_f32 v165, v165
    v_cvt_pk_bf16_f32 v211, v174, v175
    v_mfma_f32_16x16x32_bf16 v[196:199], a[172:175], a[36:39], v[196:199]
    v_exp_f32 v166, v166
    ds_read_b64_tr_b16 a[168:169], v238 offset:24576
    v_mfma_f32_16x16x32_bf16 v[200:203], a[172:175], a[60:63], v[200:203]
    ds_read_b64_tr_b16 a[170:171], v238 offset:30720
    s_waitcnt lgkmcnt(6)
    v_mfma_f32_16x16x32_bf16 v[180:183], a[144:147], a[16:19], v[180:183]
    ds_read_b64_tr_b16 a[172:173], v239 offset:24576
    ds_read_b64_tr_b16 a[174:175], v239 offset:30720
    v_mfma_f32_16x16x32_bf16 v[184:187], a[144:147], a[40:43], v[184:187]
    buffer_load_dwordx4 v245, s[8:11], s31 offen offset:1024 nt lds
    v_mfma_f32_16x16x32_bf16 v[188:191], a[144:147], a[64:67], v[188:191]
    buffer_store_dwordx4 a[188:191], v243, s[16:19], s24 offen offset:2048
    v_mfma_f32_16x16x32_bf16 v[192:195], a[148:151], a[16:19], v[192:195]
    v_exp_f32 v167, v167
    v_cvt_pk_bf16_f32 v212, v164, v165
    v_mfma_f32_16x16x32_bf16 v[196:199], a[148:151], a[40:43], v[196:199]
    ds_read_b64_tr_b16 a[144:145], v236 offset:24704
    ds_read_b64_tr_b16 a[146:147], v236 offset:30848
    v_mfma_f32_16x16x32_bf16 v[200:203], a[148:151], a[64:67], v[200:203]
    buffer_store_dwordx4 a[192:195], v243, s[16:19], s24 offen offset:3072
    v_mfma_f32_16x16x32_bf16 v[180:183], a[152:155], a[20:23], v[180:183]
    v_exp_f32 v176, v176
    v_exp_f32 v177, v177
    v_mfma_f32_16x16x32_bf16 v[184:187], a[152:155], a[44:47], v[184:187]
    v_cvt_pk_bf16_f32 v213, v166, v167
    ds_read_b64_tr_b16 a[148:149], v237 offset:24704
    v_mfma_f32_16x16x32_bf16 v[188:191], a[152:155], a[68:71], v[188:191]
    ds_read_b64_tr_b16 a[150:151], v237 offset:30848
    v_mfma_f32_16x16x32_bf16 v[192:195], a[156:159], a[20:23], v[192:195]
    v_exp_f32 v178, v178
    v_exp_f32 v179, v179
    v_mfma_f32_16x16x32_bf16 v[196:199], a[156:159], a[44:47], v[196:199]
    v_cvt_pk_bf16_f32 v214, v176, v177
    ds_read_b64_tr_b16 a[152:153], v238 offset:24704
    v_mfma_f32_16x16x32_bf16 v[200:203], a[156:159], a[68:71], v[200:203]
    ds_read_b64_tr_b16 a[154:155], v238 offset:30848
    v_cvt_pk_bf16_f32 v215, v178, v179
    s_nop 0
    v_mfma_f32_16x16x32_bf16 v[144:147], a[176:179], v[204:207], v[144:147]
    v_fma_f32 v180, v180, s20, -v216
    v_fma_f32 v181, v181, s20, -v216
    v_mfma_f32_16x16x32_bf16 v[148:151], a[176:179], v[208:211], v[148:151]
    v_fma_f32 v182, v182, s20, -v216
    v_max3_f32 v251, v180, v181, v182
    v_mfma_f32_16x16x32_bf16 v[152:155], a[176:179], v[212:215], v[152:155]
    v_fma_f32 v183, v183, s20, -v216
    v_fma_f32 v184, v184, s20, -v217
    s_waitcnt lgkmcnt(6)
    v_mfma_f32_16x16x32_bf16 v[0:3], a[160:163], v[204:207], v[0:3]
    ds_read_b64_tr_b16 a[156:157], v239 offset:24704
    v_mfma_f32_16x16x32_bf16 v[48:51], a[160:163], v[208:211], v[48:51]
    ds_read_b64_tr_b16 a[158:159], v239 offset:30848
    v_mfma_f32_16x16x32_bf16 v[96:99], a[160:163], v[212:215], v[96:99]
    buffer_load_dwordx4 v246, s[8:11], s31 offen offset:2048 nt lds
    v_mfma_f32_16x16x32_bf16 v[4:7], a[164:167], v[204:207], v[4:7]
    v_max3_f32 v251, v251, v183, v184
    v_fma_f32 v185, v185, s20, -v217
    v_mfma_f32_16x16x32_bf16 v[52:55], a[164:167], v[208:211], v[52:55]
    v_fma_f32 v186, v186, s20, -v217
    ds_read_b64_tr_b16 a[160:161], v236 offset:24832
    v_mfma_f32_16x16x32_bf16 v[100:103], a[164:167], v[212:215], v[100:103]
    ds_read_b64_tr_b16 a[162:163], v236 offset:30976
    v_mfma_f32_16x16x32_bf16 v[8:11], a[168:171], v[204:207], v[8:11]
    v_max3_f32 v251, v251, v185, v186
    v_fma_f32 v187, v187, s20, -v217
    v_mfma_f32_16x16x32_bf16 v[56:59], a[168:171], v[208:211], v[56:59]
    v_fma_f32 v188, v188, s20, -v218
    ds_read_b64_tr_b16 a[164:165], v237 offset:24832
    v_mfma_f32_16x16x32_bf16 v[104:107], a[168:171], v[212:215], v[104:107]
    ds_read_b64_tr_b16 a[166:167], v237 offset:30976
    v_mfma_f32_16x16x32_bf16 v[12:15], a[172:175], v[204:207], v[12:15]
    ds_read_b64_tr_b16 a[168:169], v238 offset:24832
    v_mfma_f32_16x16x32_bf16 v[60:63], a[172:175], v[208:211], v[60:63]
    v_mfma_f32_16x16x32_bf16 v[108:111], a[172:175], v[212:215], v[108:111]
    ds_read_b64_tr_b16 a[170:171], v238 offset:30976
    s_waitcnt vmcnt(13)
    s_barrier
    s_waitcnt lgkmcnt(6)
    v_mfma_f32_16x16x32_bf16 v[16:19], a[144:147], v[204:207], v[16:19]
    ds_read_b64_tr_b16 a[172:173], v239 offset:24832
    ds_read_b64_tr_b16 a[174:175], v239 offset:30976
    v_mfma_f32_16x16x32_bf16 v[64:67], a[144:147], v[208:211], v[64:67]
    s_add_u32 m0, s21, 61440
    s_add_u32 s32, s22, 61440
    v_mfma_f32_16x16x32_bf16 v[112:115], a[144:147], v[212:215], v[112:115]
    buffer_load_dwordx4 v247, s[12:15], s32 offen offset:0 lds
    v_mfma_f32_16x16x32_bf16 v[20:23], a[148:151], v[204:207], v[20:23]
    v_max3_f32 v251, v251, v187, v188
    v_fma_f32 v189, v189, s20, -v218
    v_mfma_f32_16x16x32_bf16 v[68:71], a[148:151], v[208:211], v[68:71]
    v_fma_f32 v190, v190, s20, -v218
    v_max3_f32 v251, v251, v189, v190
    v_mfma_f32_16x16x32_bf16 v[116:119], a[148:151], v[212:215], v[116:119]
    ds_read_b128 a[144:147], v232 offset:0
    v_mfma_f32_16x16x32_bf16 v[24:27], a[152:155], v[204:207], v[24:27]
    v_fma_f32 v191, v191, s20, -v218
    v_fma_f32 v192, v192, s20, -v216
    v_mfma_f32_16x16x32_bf16 v[72:75], a[152:155], v[208:211], v[72:75]
    v_max3_f32 v251, v251, v191, v192
    v_fma_f32 v193, v193, s20, -v216
    v_fma_f32 v194, v194, s20, -v216
    v_mfma_f32_16x16x32_bf16 v[120:123], a[152:155], v[212:215], v[120:123]
    ds_read_b128 a[148:151], v232 offset:6144
    v_mfma_f32_16x16x32_bf16 v[28:31], a[156:159], v[204:207], v[28:31]
    v_max3_f32 v251, v251, v193, v194
    v_fma_f32 v195, v195, s20, -v216
    v_mfma_f32_16x16x32_bf16 v[76:79], a[156:159], v[208:211], v[76:79]
    v_fma_f32 v196, v196, s20, -v217
    v_max3_f32 v251, v251, v195, v196
    v_mfma_f32_16x16x32_bf16 v[124:127], a[156:159], v[212:215], v[124:127]
    ds_read_b128 a[152:155], v233 offset:0
    s_waitcnt lgkmcnt(3)
    v_mfma_f32_16x16x32_bf16 v[32:35], a[160:163], v[204:207], v[32:35]
    v_fma_f32 v197, v197, s20, -v217
    v_fma_f32 v198, v198, s20, -v217
    v_mfma_f32_16x16x32_bf16 v[80:83], a[160:163], v[208:211], v[80:83]
    ds_read_b128 a[156:159], v233 offset:6144
    v_mfma_f32_16x16x32_bf16 v[128:131], a[160:163], v[212:215], v[128:131]
    buffer_load_dwordx4 v248, s[12:15], s32 offen offset:1024 lds
    v_mfma_f32_16x16x32_bf16 v[36:39], a[164:167], v[204:207], v[36:39]
    v_max3_f32 v251, v251, v197, v198
    v_fma_f32 v199, v199, s20, -v217
    v_mfma_f32_16x16x32_bf16 v[84:87], a[164:167], v[208:211], v[84:87]
    v_fma_f32 v200, v200, s20, -v218
    v_max3_f32 v251, v251, v199, v200
    v_fma_f32 v201, v201, s20, -v218
    v_mfma_f32_16x16x32_bf16 v[132:135], a[164:167], v[212:215], v[132:135]
    ds_read_b128 a[160:163], v232 offset:128
    v_mfma_f32_16x16x32_bf16 v[40:43], a[168:171], v[204:207], v[40:43]
    v_fma_f32 v202, v202, s20, -v218
    v_max3_f32 v251, v251, v201, v202
    v_mfma_f32_16x16x32_bf16 v[88:91], a[168:171], v[208:211], v[88:91]
    v_fma_f32 v203, v203, s20, -v218
    v_max_f32 v251, v251, v203
    v_cmp_lt_f32 vcc, 0x41000000, v251
    v_mfma_f32_16x16x32_bf16 v[136:139], a[168:171], v[212:215], v[136:139]
    ds_read_b128 a[164:167], v232 offset:6272
    v_mfma_f32_16x16x32_bf16 v[44:47], a[172:175], v[204:207], v[44:47]
    v_mfma_f32_16x16x32_bf16 v[92:95], a[172:175], v[208:211], v[92:95]
    ds_read_b128 a[168:171], v233 offset:128
    v_mfma_f32_16x16x32_bf16 v[140:143], a[172:175], v[212:215], v[140:143]
    s_cbranch_vccnz L_rare2
L_back2:
    s_waitcnt lgkmcnt(3)
    v_mfma_f32_16x16x32_bf16 v[156:159], a[144:147], a[0:3], 0
    v_exp_f32 v180, v180
    v_exp_f32 v181, v181
    v_mfma_f32_16x16x32_bf16 v[160:163], a[144:147], a[24:27], 0
    ds_read_b128 a[172:175], v233 offset:6272
    v_mfma_f32_16x16x32_bf16 v[164:167], a[144:147], a[48:51], 0
    buffer_load_dwordx4 v249, s[12:15], s32 offen offset:2048 lds
    v_mfma_f32_16x16x32_bf16 v[168:171], a[148:151], a[0:3], 0
    v_exp_f32 v182, v182
    v_exp_f32 v183, v183
    v_mfma_f32_16x16x32_bf16 v[172:175], a[148:151], a[24:27], 0
    v_cvt_pk_bf16_f32 v204, v180, v181
    v_exp_f32 v192, v192
    v_mfma_f32_16x16x32_bf16 v[176:179], a[148:151], a[48:51], 0
    ds_read_b128 a[144:147], v232 offset:256
    v_mfma_f32_16x16x32_bf16 v[156:159], a[152:155], a[4:7], v[156:159]
    v_exp_f32 v193, v193
    v_cvt_pk_bf16_f32 v205, v182, v183
    v_mfma_f32_16x16x32_bf16 v[160:163], a[152:155], a[28:31], v[160:163]
    v_exp_f32 v194, v194
    v_exp_f32 v195, v195
    v_mfma_f32_16x16x32_bf16 v[164:167], a[152:155], a[52:55], v[164:167]
    v_cvt_pk_bf16_f32 v206, v192, v193
    ds_read_b128 a[148:151], v232 offset:6400
    v_mfma_f32_16x16x32_bf16 v[168:171], a[156:159], a[4:7], v[168:171]
    v_exp_f32 v184, v184
    v_exp_f32 v185, v185
    v_mfma_f32_16x16x32_bf16 v[172:175], a[156:159], a[28:31], v[172:175]
    v_cvt_pk_bf16_f32 v207, v194, v195
    v_exp_f32 v186, v186
    v_mfma_f32_16x16x32_bf16 v[176:179], a[156:159], a[52:55], v[176:179]
    ds_read_b128 a[152:155], v233 offset:256
    s_waitcnt lgkmcnt(3)
    v_mfma_f32_16x16x32_bf16 v[156:159], a[160:163], a[8:11], v[156:159]
    v_exp_f32 v187, v187
    ds_read_b128 a[156:159], v233 offset:6400
    v_mfma_f32_16x16x32_bf16 v[160:163], a[160:163], a[32:35], v[160:163]
    s_add_u32 m0, s21, 36864
    s_add_u32 s31, s22, 86016
    v_mfma_f32_16x16x32_bf16 v[164:167], a[160:163], a[56:59], v[164:167]
    buffer_load_dwordx4 v244, s[8:11], s31 offen offset:0 nt lds
    buffer_load_dwordx4 a[80:83], v250, s[4:7], s27 offen offset:128 nt
    v_mfma_f32_16x16x32_bf16 v[168:171], a[164:167], a[8:11], v[168:171]
    v_cvt_pk_bf16_f32 v208, v184, v185
    v_exp_f32 v196, v196
    v_mfma_f32_16x16x32_bf16 v[172:175], a[164:167], a[32:35], v[172:175]
    ds_read_b64_tr_b16 a[160:161], v236 offset:36864
    v_mfma_f32_16x16x32_bf16 v[176:179], a[164:167], a[56:59], v[176:179]
    ds_read_b64_tr_b16 a[162:163], v236 offset:43008
    buffer_load_dwordx4 a[84:87], v250, s[4:7], s27 offen offset:192 nt
    v_mfma_f32_16x16x32_bf16 v[156:159], a[168:171], a[12:15], v[156:159]
    v_exp_f32 v197, v197
    v_cvt_pk_bf16_f32 v209, v186, v187
    v_mfma_f32_16x16x32_bf16 v[160:163], a[168:171], a[36:39], v[160:163]
    v_exp_f32 v198, v198
    ds_read_b64_tr_b16 a[164:165], v237 offset:36864
    v_mfma_f32_16x16x32_bf16 v[164:167], a[168:171], a[60:63], v[164:167]
    ds_read_b64_tr_b16 a[166:167], v237 offset:43008
    v_mfma_f32_16x16x32_bf16 v[168:171], a[172:175], a[12:15], v[168:171]
    v_exp_f32 v199, v199
    v_cvt_pk_bf16_f32 v210, v196, v197
    v_mfma_f32_16x16x32_bf16 v[172:175], a[172:175], a[36:39], v[172:175]
    v_exp_f32 v188, v188
    ds_read_b64_tr_b16 a[168:169], v238 offset:36864
    v_mfma_f32_16x16x32_bf16 v[176:179], a[172:175], a[60:63], v[176:179]
    ds_read_b64_tr_b16 a[170:171], v238 offset:43008
    s_waitcnt lgkmcnt(6)
    v_mfma_f32_16x16x32_bf16 v[156:159], a[144:147], a[16:19], v[156:159]
    v_exp_f32 v189, v189
    v_cvt_pk_bf16_f32 v211, v198, v199
    v_mfma_f32_16x16x32_bf16 v[160:163], a[144:147], a[40:43], v[160:163]
    ds_read_b64_tr_b16 a[172:173], v239 offset:36864
    ds_read_b64_tr_b16 a[174:175], v239 offset:43008
    v_mfma_f32_16x16x32_bf16 v[164:167], a[144:147], a[64:67], v[164:167]
    buffer_load_dwordx4 v245, s[8:11], s31 offen offset:1024 nt lds
    v_mfma_f32_16x16x32_bf16 v[168:171], a[148:151], a[16:19], v[168:171]
    v_exp_f32 v190, v190
    v_exp_f32 v191, v191
    v_mfma_f32_16x16x32_bf16 v[172:175], a[148:151], a[40:43], v[172:175]
    v_cvt_pk_bf16_f32 v212, v188, v189
    ds_read_b64_tr_b16 a[144:145], v236 offset:36992
    v_mfma_f32_16x16x32_bf16 v[176:179], a[148:151], a[64:67], v[176:179]
    ds_read_b64_tr_b16 a[146:147], v236 offset:43136
    v_mfma_f32_16x16x32_bf16 v[156:159], a[152:155], a[20:23], v[156:159]
    v_exp_f32 v200, v200
    v_exp_f32 v201, v201
    v_mfma_f32_16x16x32_bf16 v[160:163], a[152:155], a[44:47], v[160:163]
    v_cvt_pk_bf16_f32 v213, v190, v191
    ds_read_b64_tr_b16 a[148:149], v237 offset:36992
    v_mfma_f32_16x16x32_bf16 v[164:167], a[152:155], a[68:71], v[164:167]
    ds_read_b64_tr_b16 a[150:151], v237 offset:43136
    v_mfma_f32_16x16x32_bf16 v[168:171], a[156:159], a[20:23], v[168:171]
    v_exp_f32 v202, v202
    v_exp_f32 v203, v203
    v_mfma_f32_16x16x32_bf16 v[172:175], a[156:159], a[44:47], v[172:175]
    v_cvt_pk_bf16_f32 v214, v200, v201
    ds_read_b64_tr_b16 a[152:153], v238 offset:36992
    v_mfma_f32_16x16x32_bf16 v[176:179], a[156:159], a[68:71], v[176:179]
    ds_read_b64_tr_b16 a[154:155], v238 offset:43136
    v_cvt_pk_bf16_f32 v215, v202, v203
    s_nop 0
    v_mfma_f32_16x16x32_bf16 v[144:147], a[176:179], v[204:207], v[144:147]
    v_fma_f32 v156, v156, s20, -v216
    v_fma_f32 v157, v157, s20, -v216
    v_mfma_f32_16x16x32_bf16 v[148:151], a[176:179], v[208:211], v[148:151]
    v_fma_f32 v158, v158, s20, -v216
    v_max3_f32 v251, v156, v157, v158
    v_mfma_f32_16x16x32_bf16 v[152:155], a[176:179], v[212:215], v[152:155]
    v_fma_f32 v159, v159, s20, -v216
    v_fma_f32 v160, v160, s20, -v217
    s_waitcnt lgkmcnt(6)
    v_mfma_f32_16x16x32_bf16 v[0:3], a[160:163], v[204:207], v[0:3]
    ds_read_b64_tr_b16 a[156:157], v239 offset:36992
    v_mfma_f32_16x16x32_bf16 v[48:51], a[160:163], v[208:211], v[48:51]
    ds_read_b64_tr_b16 a[158:159], v239 offset:43136
    v_mfma_f32_16x16x32_bf16 v[96:99], a[160:163], v[212:215], v[96:99]
    buffer_load_dwordx4 v246, s[8:11], s31 offen offset:2048 nt lds
    v_mfma_f32_16x16x32_bf16 v[4:7], a[164:167], v[204:207], v[4:7]
    v_max3_f32 v251, v251, v159, v160
    v_fma_f32 v161, v161, s20, -v217
    v_mfma_f32_16x16x32_bf16 v[52:55], a[164:167], v[208:211], v[52:55]
    v_fma_f32 v162, v162, s20, -v217
    ds_read_b64_tr_b16 a[160:161], v236 offset:37120
    v_mfma_f32_16x16x32_bf16 v[100:103], a[164:167], v[212:215], v[100:103]
    ds_read_b64_tr_b16 a[162:163], v236 offset:43264
    v_mfma_f32_16x16x32_bf16 v[8:11], a[168:171], v[204:207], v[8:11]
    v_max3_f32 v251, v251, v161, v162
    v_fma_f32 v163, v163, s20, -v217
    v_mfma_f32_16x16x32_bf16 v[56:59], a[168:171], v[208:211], v[56:59]
    v_fma_f32 v164, v164, s20, -v218
    ds_read_b64_tr_b16 a[164:165], v237 offset:37120
    v_mfma_f32_16x16x32_bf16 v[104:107], a[168:171], v[212:215], v[104:107]
    ds_read_b64_tr_b16 a[166:167], v237 offset:43264
    v_mfma_f32_16x16x32_bf16 v[12:15], a[172:175], v[204:207], v[12:15]
    ds_read_b64_tr_b16 a[168:169], v238 offset:37120
    v_mfma_f32_16x16x32_bf16 v[60:63], a[172:175], v[208:211], v[60:63]
    v_mfma_f32_16x16x32_bf16 v[108:111], a[172:175], v[212:215], v[108:111]
    ds_read_b64_tr_b16 a[170:171], v238 offset:43264
    s_waitcnt vmcnt(13)
    s_barrier
    s_waitcnt lgkmcnt(6)
    v_mfma_f32_16x16x32_bf16 v[16:19], a[144:147], v[204:207], v[16:19]
    ds_read_b64_tr_b16 a[172:173], v239 offset:37120
    ds_read_b64_tr_b16 a[174:175], v239 offset:43264
    v_mfma_f32_16x16x32_bf16 v[64:67], a[144:147], v[208:211], v[64:67]
    s_add_u32 m0, s21, 73728
    s_add_u32 s32, s22, 73728
    v_mfma_f32_16x16x32_bf16 v[112:115], a[144:147], v[212:215], v[112:115]
    buffer_load_dwordx4 v247, s[12:15], s32 offen offset:0 lds
    v_mfma_f32_16x16x32_bf16 v[20:23], a[148:151], v[204:207], v[20:23]
    v_max3_f32 v251, v251, v163, v164
    v_fma_f32 v165, v165, s20, -v218
    v_mfma_f32_16x16x32_bf16 v[68:71], a[148:151], v[208:211], v[68:71]
    v_fma_f32 v166, v166, s20, -v218
    v_max3_f32 v251, v251, v165, v166
    v_mfma_f32_16x16x32_bf16 v[116:119], a[148:151], v[212:215], v[116:119]
    ds_read_b128 a[144:147], v232 offset:12288
    v_mfma_f32_16x16x32_bf16 v[24:27], a[152:155], v[204:207], v[24:27]
    v_fma_f32 v167, v167, s20, -v218
    v_fma_f32 v168, v168, s20, -v216
    v_mfma_f32_16x16x32_bf16 v[72:75], a[152:155], v[208:211], v[72:75]
    v_max3_f32 v251, v251, v167, v168
    v_fma_f32 v169, v169, s20, -v216
    v_fma_f32 v170, v170, s20, -v216
    v_mfma_f32_16x16x32_bf16 v[120:123], a[152:155], v[212:215], v[120:123]
    ds_read_b128 a[148:151], v232 offset:18432
    v_mfma_f32_16x16x32_bf16 v[28:31], a[156:159], v[204:207], v[28:31]
    v_max3_f32 v251, v251, v169, v170
    v_fma_f32 v171, v171, s20, -v216
    v_mfma_f32_16x16x32_bf16 v[76:79], a[156:159], v[208:211], v[76:79]
    v_fma_f32 v172, v172, s20, -v217
    v_max3_f32 v251, v251, v171, v172
    v_mfma_f32_16x16x32_bf16 v[124:127], a[156:159], v[212:215], v[124:127]
    ds_read_b128 a[152:155], v233 offset:12288
    s_waitcnt lgkmcnt(3)
    v_mfma_f32_16x16x32_bf16 v[32:35], a[160:163], v[204:207], v[32:35]
    v_fma_f32 v173, v173, s20, -v217
    v_fma_f32 v174, v174, s20, -v217
    v_mfma_f32_16x16x32_bf16 v[80:83], a[160:163], v[208:211], v[80:83]
    ds_read_b128 a[156:159], v233 offset:18432
    v_mfma_f32_16x16x32_bf16 v[128:131], a[160:163], v[212:215], v[128:131]
    buffer_load_dwordx4 v248, s[12:15], s32 offen offset:1024 lds
    v_mfma_f32_16x16x32_bf16 v[36:39], a[164:167], v[204:207], v[36:39]
    v_max3_f32 v251, v251, v173, v174
    v_fma_f32 v175, v175, s20, -v217
    v_mfma_f32_16x16x32_bf16 v[84:87], a[164:167], v[208:211], v[84:87]
    v_fma_f32 v176, v176, s20, -v218
    v_max3_f32 v251, v251, v175, v176
    v_fma_f32 v177, v177, s20, -v218
    v_mfma_f32_16x16x32_bf16 v[132:135], a[164:167], v[212:215], v[132:135]
    ds_read_b128 a[160:163], v232 offset:12416
    v_mfma_f32_16x16x32_bf16 v[40:43], a[168:171], v[204:207], v[40:43]
    v_fma_f32 v178, v178, s20, -v218
    v_max3_f32 v251, v251, v177, v178
    v_mfma_f32_16x16x32_bf16 v[88:91], a[168:171], v[208:211], v[88:91]
    v_fma_f32 v179, v179, s20, -v218
    v_max_f32 v251, v251, v179
    v_cmp_lt_f32 vcc, 0x41000000, v251
    v_mfma_f32_16x16x32_bf16 v[136:139], a[168:171], v[212:215], v[136:139]
    ds_read_b128 a[164:167], v232 offset:18560
    v_mfma_f32_16x16x32_bf16 v[44:47], a[172:175], v[204:207], v[44:47]
    v_mfma_f32_16x16x32_bf16 v[92:95], a[172:175], v[208:211], v[92:95]
    ds_read_b128 a[168:171], v233 offset:12416
    v_mfma_f32_16x16x32_bf16 v[140:143], a[172:175], v[212:215], v[140:143]
    s_cbranch_vccnz L_rare3
L_back3:
    s_waitcnt lgkmcnt(3)
    v_mfma_f32_16x16x32_bf16 v[180:183], a[144:147], a[0:3], 0
    v_exp_f32 v156, v156
    v_exp_f32 v157, v157
    v_mfma_f32_16x16x32_bf16 v[184:187], a[144:147], a[24:27], 0
    ds_read_b128 a[172:175], v233 offset:18560
    v_mfma_f32_16x16x32_bf16 v[188:191], a[144:147], a[48:51], 0
    buffer_load_dwordx4 v249, s[12:15], s32 offen offset:2048 lds
    v_mfma_f32_16x16x32_bf16 v[192:195], a[148:151], a[0:3], 0
    v_exp_f32 v158, v158
    v_exp_f32 v159, v159
    v_mfma_f32_16x16x32_bf16 v[196:199], a[148:151], a[24:27], 0
    v_cvt_pk_bf16_f32 v204, v156, v157
    v_exp_f32 v168, v168
    v_mfma_f32_16x16x32_bf16 v[200:203], a[148:151], a[48:51], 0
    v_exp_f32 v169, v169
    ds_read_b128 a[144:147], v232 offset:12544
    v_mfma_f32_16x16x32_bf16 v[180:183], a[152:155], a[4:7], v[180:183]
    v_cvt_pk_bf16_f32 v205, v158, v159
    v_exp_f32 v170, v170
    v_mfma_f32_16x16x32_bf16 v[184:187], a[152:155], a[28:31], v[184:187]
    v_exp_f32 v171, v171
    v_cvt_pk_bf16_f32 v206, v168, v169
    v_mfma_f32_16x16x32_bf16 v[188:191], a[152:155], a[52:55], v[188:191]
    v_exp_f32 v160, v160
    ds_read_b128 a[148:151], v232 offset:18688
    v_mfma_f32_16x16x32_bf16 v[192:195], a[156:159], a[4:7], v[192:195]
    v_exp_f32 v161, v161
    v_cvt_pk_bf16_f32 v207, v170, v171
    v_mfma_f32_16x16x32_bf16 v[196:199], a[156:159], a[28:31], v[196:199]
    v_exp_f32 v162, v162
    v_exp_f32 v163, v163
    v_mfma_f32_16x16x32_bf16 v[200:203], a[156:159], a[52:55], v[200:203]
    ds_read_b128 a[152:155], v233 offset:12544
    s_waitcnt lgkmcnt(3)
    v_mfma_f32_16x16x32_bf16 v[180:183], a[160:163], a[8:11], v[180:183]
    v_cvt_pk_bf16_f32 v208, v160, v161
    v_exp_f32 v172, v172
    v_mfma_f32_16x16x32_bf16 v[184:187], a[160:163], a[32:35], v[184:187]
    ds_read_b128 a[156:159], v233 offset:18688
    s_add_u32 m0, s21, 0
    s_add_u32 s31, s22, 98304
    v_mfma_f32_16x16x32_bf16 v[188:191], a[160:163], a[56:59], v[188:191]
    buffer_load_dwordx4 v244, s[8:11], s31 offen offset:0 nt lds
    v_mfma_f32_16x16x32_bf16 v[192:195], a[164:167], a[8:11], v[192:195]
    v_exp_f32 v173, v173
    v_cvt_pk_bf16_f32 v209, v162, v163
    v_mfma_f32_16x16x32_bf16 v[196:199], a[164:167], a[32:35], v[196:199]
    v_exp_f32 v174, v174
    ds_read_b64_tr_b16 a[160:161], v236 offset:0
    v_mfma_f32_16x16x32_bf16 v[200:203], a[164:167], a[56:59], v[200:203]
    ds_read_b64_tr_b16 a[162:163], v236 offset:6144
    v_mfma_f32_16x16x32_bf16 v[180:183], a[168:171], a[12:15], v[180:183]
    v_exp_f32 v175, v175
    v_cvt_pk_bf16_f32 v210, v172, v173
    v_mfma_f32_16x16x32_bf16 v[184:187], a[168:171], a[36:39], v[184:187]
    v_exp_f32 v164, v164
    v_exp_f32 v165, v165
    v_mfma_f32_16x16x32_bf16 v[188:191], a[168:171], a[60:63], v[188:191]
    ds_read_b64_tr_b16 a[164:165], v237 offset:0
    ds_read_b64_tr_b16 a[166:167], v237 offset:6144
    v_mfma_f32_16x16x32_bf16 v[192:195], a[172:175], a[12:15], v[192:195]
    v_cvt_pk_bf16_f32 v211, v174, v175
    v_exp_f32 v166, v166
    v_mfma_f32_16x16x32_bf16 v[196:199], a[172:175], a[36:39], v[196:199]
    v_exp_f32 v167, v167
    ds_read_b64_tr_b16 a[168:169], v238 offset:0
    v_mfma_f32_16x16x32_bf16 v[200:203], a[172:175], a[60:63], v[200:203]
    ds_read_b64_tr_b16 a[170:171], v238 offset:6144
    s_waitcnt lgkmcnt(6)
    v_mfma_f32_16x16x32_bf16 v[180:183], a[144:147], a[16:19], v[180:183]
    ds_read_b64_tr_b16 a[172:173], v239 offset:0
    ds_read_b64_tr_b16 a[174:175], v239 offset:6144
    v_mfma_f32_16x16x32_bf16 v[184:187], a[144:147], a[40:43], v[184:187]
    buffer_load_dwordx4 v245, s[8:11], s31 offen offset:1024 nt lds
    v_mfma_f32_16x16x32_bf16 v[188:191], a[144:147], a[64:67], v[188:191]
    s_add_u32 s33, s24, 4096
    buffer_store_dwordx4 a[196:199], v243, s[16:19], s33 offen offset:0
    v_mfma_f32_16x16x32_bf16 v[192:195], a[148:151], a[16:19], v[192:195]
    ds_read_b64_tr_b16 a[144:145], v236 offset:128
    v_mfma_f32_16x16x32_bf16 v[196:199], a[148:151], a[40:43], v[196:199]
    ds_read_b64_tr_b16 a[146:147], v236 offset:6272
    s_add_u32 s33, s24, 4096
    v_mfma_f32_16x16x32_bf16 v[200:203], a[148:151], a[64:67], v[200:203]
    buffer_store_dwordx4 a[200:203], v243, s[16:19], s33 offen offset:1024
    v_mfma_f32_16x16x32_bf16 v[180:183], a[152:155], a[20:23], v[180:183]
    v_cvt_pk_bf16_f32 v212, v164, v165
    v_exp_f32 v176, v176
    v_mfma_f32_16x16x32_bf16 v[184:187], a[152:155], a[44:47], v[184:187]
    v_exp_f32 v177, v177
    v_cvt_pk_bf16_f32 v213, v166, v167
    v_mfma_f32_16x16x32_bf16 v[188:191], a[152:155], a[68:71], v[188:191]
    ds_read_b64_tr_b16 a[148:149], v237 offset:128
    ds_read_b64_tr_b16 a[150:151], v237 offset:6272
    v_mfma_f32_16x16x32_bf16 v[192:195], a[156:159], a[20:23], v[192:195]
    v_exp_f32 v178, v178
    v_exp_f32 v179, v179
    v_mfma_f32_16x16x32_bf16 v[196:199], a[156:159], a[44:47], v[196:199]
    v_cvt_pk_bf16_f32 v214, v176, v177
    ds_read_b64_tr_b16 a[152:153], v238 offset:128
    v_mfma_f32_16x16x32_bf16 v[200:203], a[156:159], a[68:71], v[200:203]
    ds_read_b64_tr_b16 a[154:155], v238 offset:6272
    v_cvt_pk_bf16_f32 v215, v178, v179
    s_nop 0
    v_mfma_f32_16x16x32_bf16 v[144:147], a[176:179], v[204:207], v[144:147]
    v_fma_f32 v180, v180, s20, -v216
    v_fma_f32 v181, v181, s20, -v216
    v_mfma_f32_16x16x32_bf16 v[148:151], a[176:179], v[208:211], v[148:151]
    v_fma_f32 v182, v182, s20, -v216
    v_max3_f32 v251, v180, v181, v182
    v_mfma_f32_16x16x32_bf16 v[152:155], a[176:179], v[212:215], v[152:155]
    v_fma_f32 v183, v183, s20, -v216
    v_fma_f32 v184, v184, s20, -v217
    s_waitcnt lgkmcnt(6)
    v_mfma_f32_16x16x32_bf16 v[0:3], a[160:163], v[204:207], v[0:3]
    ds_read_b64_tr_b16 a[156:157], v239 offset:128
    v_mfma_f32_16x16x32_bf16 v[48:51], a[160:163], v[208:211], v[48:51]
    ds_read_b64_tr_b16 a[158:159], v239 offset:6272
    v_mfma_f32_16x16x32_bf16 v[96:99], a[160:163], v[212:215], v[96:99]
    buffer_load_dwordx4 v246, s[8:11], s31 offen offset:2048 nt lds
    v_mfma_f32_16x16x32_bf16 v[4:7], a[164:167], v[204:207], v[4:7]
    v_max3_f32 v251, v251, v183, v184
    v_fma_f32 v185, v185, s20, -v217
    v_mfma_f32_16x16x32_bf16 v[52:55], a[164:167], v[208:211], v[52:55]
    v_fma_f32 v186, v186, s20, -v217
    ds_read_b64_tr_b16 a[160:161], v236 offset:256
    v_mfma_f32_16x16x32_bf16 v[100:103], a[164:167], v[212:215], v[100:103]
    ds_read_b64_tr_b16 a[162:163], v236 offset:6400
    v_mfma_f32_16x16x32_bf16 v[8:11], a[168:171], v[204:207], v[8:11]
    v_max3_f32 v251, v251, v185, v186
    v_fma_f32 v187, v187, s20, -v217
    v_mfma_f32_16x16x32_bf16 v[56:59], a[168:171], v[208:211], v[56:59]
    v_fma_f32 v188, v188, s20, -v218
    ds_read_b64_tr_b16 a[164:165], v237 offset:256
    v_mfma_f32_16x16x32_bf16 v[104:107], a[168:171], v[212:215], v[104:107]
    ds_read_b64_tr_b16 a[166:167], v237 offset:6400
    v_mfma_f32_16x16x32_bf16 v[12:15], a[172:175], v[204:207], v[12:15]
    ds_read_b64_tr_b16 a[168:169], v238 offset:256
    v_mfma_f32_16x16x32_bf16 v[60:63], a[172:175], v[208:211], v[60:63]
    v_mfma_f32_16x16x32_bf16 v[108:111], a[172:175], v[212:215], v[108:111]
    ds_read_b64_tr_b16 a[170:171], v238 offset:6400
    s_waitcnt vmcnt(13)
    s_barrier
    s_waitcnt lgkmcnt(6)
    v_mfma_f32_16x16x32_bf16 v[16:19], a[144:147], v[204:207], v[16:19]
    ds_read_b64_tr_b16 a[172:173], v239 offset:256
    ds_read_b64_tr_b16 a[174:175], v239 offset:6400
    v_mfma_f32_16x16x32_bf16 v[64:67], a[144:147], v[208:211], v[64:67]
    s_add_u32 m0, s21, 86016
    s_add_u32 s32, s22, 86016
    v_mfma_f32_16x16x32_bf16 v[112:115], a[144:147], v[212:215], v[112:115]
    buffer_load_dwordx4 v247, s[12:15], s32 offen offset:0 lds
    v_mfma_f32_16x16x32_bf16 v[20:23], a[148:151], v[204:207], v[20:23]
    v_max3_f32 v251, v251, v187, v188
    v_fma_f32 v189, v189, s20, -v218
    v_mfma_f32_16x16x32_bf16 v[68:71], a[148:151], v[208:211], v[68:71]
    v_fma_f32 v190, v190, s20, -v218
    v_max3_f32 v251, v251, v189, v190
    v_mfma_f32_16x16x32_bf16 v[116:119], a[148:151], v[212:215], v[116:119]
    ds_read_b128 a[144:147], v232 offset:24576
    v_mfma_f32_16x16x32_bf16 v[24:27], a[152:155], v[204:207], v[24:27]
    v_fma_f32 v191, v191, s20, -v218
    v_fma_f32 v192, v192, s20, -v216
    v_mfma_f32_16x16x32_bf16 v[72:75], a[152:155], v[208:211], v[72:75]
    v_max3_f32 v251, v251, v191, v192
    v_fma_f32 v193, v193, s20, -v216
    v_fma_f32 v194, v194, s20, -v216
    v_mfma_f32_16x16x32_bf16 v[120:123], a[152:155], v[212:215], v[120:123]
    ds_read_b128 a[148:151], v232 offset:30720
    v_mfma_f32_16x16x32_bf16 v[28:31], a[156:159], v[204:207], v[28:31]
    v_max3_f32 v251, v251, v193, v194
    v_fma_f32 v195, v195, s20, -v216
    v_mfma_f32_16x16x32_bf16 v[76:79], a[156:159], v[208:211], v[76:79]
    v_fma_f32 v196, v196, s20, -v217
    v_max3_f32 v251, v251, v195, v196
    v_mfma_f32_16x16x32_bf16 v[124:127], a[156:159], v[212:215], v[124:127]
    ds_read_b128 a[152:155], v233 offset:24576
    s_waitcnt lgkmcnt(3)
    v_mfma_f32_16x16x32_bf16 v[32:35], a[160:163], v[204:207], v[32:35]
    v_fma_f32 v197, v197, s20, -v217
    v_fma_f32 v198, v198, s20, -v217
    v_mfma_f32_16x16x32_bf16 v[80:83], a[160:163], v[208:211], v[80:83]
    ds_read_b128 a[156:159], v233 offset:30720
    v_mfma_f32_16x16x32_bf16 v[128:131], a[160:163], v[212:215], v[128:131]
    buffer_load_dwordx4 v248, s[12:15], s32 offen offset:1024 lds
    v_mfma_f32_16x16x32_bf16 v[36:39], a[164:167], v[204:207], v[36:39]
    v_max3_f32 v251, v251, v197, v198
    v_fma_f32 v199, v199, s20, -v217
    v_mfma_f32_16x16x32_bf16 v[84:87], a[164:167], v[208:211], v[84:87]
    v_fma_f32 v200, v200, s20, -v218
    v_max3_f32 v251, v251, v199, v200
    v_fma_f32 v201, v201, s20, -v218
    v_mfma_f32_16x16x32_bf16 v[132:135], a[164:167], v[212:215], v[132:135]
    ds_read_b128 a[160:163], v232 offset:24704
    v_mfma_f32_16x16x32_bf16 v[40:43], a[168:171], v[204:207], v[40:43]
    v_fma_f32 v202, v202, s20, -v218
    v_max3_f32 v251, v251, v201, v202
    v_mfma_f32_16x16x32_bf16 v[88:91], a[168:171], v[208:211], v[88:91]
    v_fma_f32 v203, v203, s20, -v218
    v_max_f32 v251, v251, v203
    v_cmp_lt_f32 vcc, 0x41000000, v251
    v_mfma_f32_16x16x32_bf16 v[136:139], a[168:171], v[212:215], v[136:139]
    ds_read_b128 a[164:167], v232 offset:30848
    v_mfma_f32_16x16x32_bf16 v[44:47], a[172:175], v[204:207], v[44:47]
    v_mfma_f32_16x16x32_bf16 v[92:95], a[172:175], v[208:211], v[92:95]
    ds_read_b128 a[168:171], v233 offset:24704
    v_mfma_f32_16x16x32_bf16 v[140:143], a[172:175], v[212:215], v[140:143]
    s_cbranch_vccnz L_rare4
L_back4:
    s_waitcnt lgkmcnt(3)
    v_mfma_f32_16x16x32_bf16 v[156:159], a[144:147], a[0:3], 0
    v_exp_f32 v180, v180
    v_exp_f32 v181, v181
    v_mfma_f32_16x16x32_bf16 v[160:163], a[144:147], a[24:27], 0
    ds_read_b128 a[172:175], v233 offset:30848
    v_mfma_f32_16x16x32_bf16 v[164:167], a[144:147], a[48:51], 0
    buffer_load_dwordx4 v249, s[12:15], s32 offen offset:2048 lds
    v_mfma_f32_16x16x32_bf16 v[168:171], a[148:151], a[0:3], 0
    v_exp_f32 v182, v182
    v_exp_f32 v183, v183
    v_mfma_f32_16x16x32_bf16 v[172:175], a[148:151], a[24:27], 0
    v_cvt_pk_bf16_f32 v204, v180, v181
    v_exp_f32 v192, v192
    v_mfma_f32_16x16x32_bf16 v[176:179], a[148:151], a[48:51], 0
    ds_read_b128 a[144:147], v232 offset:24832
    v_mfma_f32_16x16x32_bf16 v[156:159], a[152:155], a[4:7], v[156:159]
    v_exp_f32 v193, v193
    v_cvt_pk_bf16_f32 v205, v182, v183
    v_mfma_f32_16x16x32_bf16 v[160:163], a[152:155], a[28:31], v[160:163]
    v_exp_f32 v194, v194
    v_exp_f32 v195, v195
    v_mfma_f32_16x16x32_bf16 v[164:167], a[152:155], a[52:55], v[164:167]
    v_cvt_pk_bf16_f32 v206, v192, v193
    ds_read_b128 a[148:151], v232 offset:30976
    v_mfma_f32_16x16x32_bf16 v[168:171], a[156:159], a[4:7], v[168:171]
    v_exp_f32 v184, v184
    v_exp_f32 v185, v185
    v_mfma_f32_16x16x32_bf16 v[172:175], a[156:159], a[28:31], v[172:175]
    v_cvt_pk_bf16_f32 v207, v194, v195
    v_exp_f32 v186, v186
    v_mfma_f32_16x16x32_bf16 v[176:179], a[156:159], a[52:55], v[176:179]
    ds_read_b128 a[152:155], v233 offset:24832
    s_waitcnt lgkmcnt(3)
    v_mfma_f32_16x16x32_bf16 v[156:159], a[160:163], a[8:11], v[156:159]
    v_exp_f32 v187, v187
    ds_read_b128 a[156:159], v233 offset:30976
    v_mfma_f32_16x16x32_bf16 v[160:163], a[160:163], a[32:35], v[160:163]
    s_add_u32 m0, s21, 12288
    s_add_u32 s31, s22, 110592
    v_mfma_f32_16x16x32_bf16 v[164:167], a[160:163], a[56:59], v[164:167]
    buffer_load_dwordx4 v244, s[8:11], s31 offen offset:0 nt lds
    buffer_load_dwordx4 a[88:91], v250, s[4:7], s27 offen offset:256 nt
    v_mfma_f32_16x16x32_bf16 v[168:171], a[164:167], a[8:11], v[168:171]
    v_cvt_pk_bf16_f32 v208, v184, v185
    v_exp_f32 v196, v196
    v_mfma_f32_16x16x32_bf16 v[172:175], a[164:167], a[32:35], v[172:175]
    ds_read_b64_tr_b16 a[160:161], v236 offset:12288
    v_mfma_f32_16x16x32_bf16 v[176:179], a[164:167], a[56:59], v[176:179]
    ds_read_b64_tr_b16 a[162:163], v236 offset:18432
    buffer_load_dwordx4 a[92:95], v250, s[4:7], s27 offen offset:320 nt
    v_mfma_f32_16x16x32_bf16 v[156:159], a[168:171], a[12:15], v[156:159]
    v_exp_f32 v197, v197
    v_cvt_pk_bf16_f32 v209, v186, v187
    v_mfma_f32_16x16x32_bf16 v[160:163], a[168:171], a[36:39], v[160:163]
    v_exp_f32 v198, v198
    ds_read_b64_tr_b16 a[164:165], v237 offset:12288
    v_mfma_f32_16x16x32_bf16 v[164:167], a[168:171], a[60:63], v[164:167]
    ds_read_b64_tr_b16 a[166:167], v237 offset:18432
    v_mfma_f32_16x16x32_bf16 v[168:171], a[172:175], a[12:15], v[168:171]
    v_exp_f32 v199, v199
    v_cvt_pk_bf16_f32 v210, v196, v197
    v_mfma_f32_16x16x32_bf16 v[172:175], a[172:175], a[36:39], v[172:175]
    v_exp_f32 v188, v188
    ds_read_b64_tr_b16 a[168:169], v238 offset:12288
    v_mfma_f32_16x16x32_bf16 v[176:179], a[172:175], a[60:63], v[176:179]
    ds_read_b64_tr_b16 a[170:171], v238 offset:18432
    s_waitcnt lgkmcnt(6)
    v_mfma_f32_16x16x32_bf16 v[156:159], a[144:147], a[16:19], v[156:159]
    v_exp_f32 v189, v189
    v_cvt_pk_bf16_f32 v211, v198, v199
    v_mfma_f32_16x16x32_bf16 v[160:163], a[144:147], a[40:43], v[160:163]
    ds_read_b64_tr_b16 a[172:173], v239 offset:12288
    ds_read_b64_tr_b16 a[174:175], v239 offset:18432
    v_mfma_f32_16x16x32_bf16 v[164:167], a[144:147], a[64:67], v[164:167]
    buffer_load_dwordx4 v245, s[8:11], s31 offen offset:1024 nt lds
    v_mfma_f32_16x16x32_bf16 v[168:171], a[148:151], a[16:19], v[168:171]
    v_exp_f32 v190, v190
    v_exp_f32 v191, v191
    v_mfma_f32_16x16x32_bf16 v[172:175], a[148:151], a[40:43], v[172:175]
    v_cvt_pk_bf16_f32 v212, v188, v189
    ds_read_b64_tr_b16 a[144:145], v236 offset:12416
    v_mfma_f32_16x16x32_bf16 v[176:179], a[148:151], a[64:67], v[176:179]
    ds_read_b64_tr_b16 a[146:147], v236 offset:18560
    v_mfma_f32_16x16x32_bf16 v[156:159], a[152:155], a[20:23], v[156:159]
    v_exp_f32 v200, v200
    v_exp_f32 v201, v201
    v_mfma_f32_16x16x32_bf16 v[160:163], a[152:155], a[44:47], v[160:163]
    v_cvt_pk_bf16_f32 v213, v190, v191
    ds_read_b64_tr_b16 a[148:149], v237 offset:12416
    v_mfma_f32_16x16x32_bf16 v[164:167], a[152:155], a[68:71], v[164:167]
    ds_read_b64_tr_b16 a[150:151], v237 offset:18560
    v_mfma_f32_16x16x32_bf16 v[168:171], a[156:159], a[20:23], v[168:171]
    v_exp_f32 v202, v202
    v_exp_f32 v203, v203
    v_mfma_f32_16x16x32_bf16 v[172:175], a[156:159], a[44:47], v[172:175]
    v_cvt_pk_bf16_f32 v214, v200, v201
    ds_read_b64_tr_b16 a[152:153], v238 offset:12416
    v_mfma_f32_16x16x32_bf16 v[176:179], a[156:159], a[68:71], v[176:179]
    ds_read_b64_tr_b16 a[154:155], v238 offset:18560
    v_cvt_pk_bf16_f32 v215, v202, v203
    s_nop 0
    v_mfma_f32_16x16x32_bf16 v[144:147], a[176:179], v[204:207], v[144:147]
    v_fma_f32 v156, v156, s20, -v216
    v_fma_f32 v157, v157, s20, -v216
    v_mfma_f32_16x16x32_bf16 v[148:151], a[176:179], v[208:211], v[148:151]
    v_fma_f32 v158, v158, s20, -v216
    v_max3_f32 v251, v156, v157, v158
    v_mfma_f32_16x16x32_bf16 v[152:155], a[176:179], v[212:215], v[152:155]
    v_fma_f32 v159, v159, s20, -v216
    v_fma_f32 v160, v160, s20, -v217
    s_waitcnt lgkmcnt(6)
    v_mfma_f32_16x16x32_bf16 v[0:3], a[160:163], v[204:207], v[0:3]
    ds_read_b64_tr_b16 a[156:157], v239 offset:12416
    v_mfma_f32_16x16x32_bf16 v[48:51], a[160:163], v[208:211], v[48:51]
    ds_read_b64_tr_b16 a[158:159], v239 offset:18560
    v_mfma_f32_16x16x32_bf16 v[96:99], a[160:163], v[212:215], v[96:99]
    buffer_load_dwordx4 v246, s[8:11], s31 offen offset:2048 nt lds
    v_mfma_f32_16x16x32_bf16 v[4:7], a[164:167], v[204:207], v[4:7]
    v_max3_f32 v251, v251, v159, v160
    v_fma_f32 v161, v161, s20, -v217
    v_mfma_f32_16x16x32_bf16 v[52:55], a[164:167], v[208:211], v[52:55]
    v_fma_f32 v162, v162, s20, -v217
    ds_read_b64_tr_b16 a[160:161], v236 offset:12544
    v_mfma_f32_16x16x32_bf16 v[100:103], a[164:167], v[212:215], v[100:103]
    ds_read_b64_tr_b16 a[162:163], v236 offset:18688
    v_mfma_f32_16x16x32_bf16 v[8:11], a[168:171], v[204:207], v[8:11]
    v_max3_f32 v251, v251, v161, v162
    v_fma_f32 v163, v163, s20, -v217
    v_mfma_f32_16x16x32_bf16 v[56:59], a[168:171], v[208:211], v[56:59]
    v_fma_f32 v164, v164, s20, -v218
    ds_read_b64_tr_b16 a[164:165], v237 offset:12544
    v_mfma_f32_16x16x32_bf16 v[104:107], a[168:171], v[212:215], v[104:107]
    ds_read_b64_tr_b16 a[166:167], v237 offset:18688
    v_mfma_f32_16x16x32_bf16 v[12:15], a[172:175], v[204:207], v[12:15]
    ds_read_b64_tr_b16 a[168:169], v238 offset:12544
    v_mfma_f32_16x16x32_bf16 v[60:63], a[172:175], v[208:211], v[60:63]
    v_mfma_f32_16x16x32_bf16 v[108:111], a[172:175], v[212:215], v[108:111]
    ds_read_b64_tr_b16 a[170:171], v238 offset:18688
    s_waitcnt vmcnt(13)
    s_barrier
    s_waitcnt lgkmcnt(6)
    v_mfma_f32_16x16x32_bf16 v[16:19], a[144:147], v[204:207], v[16:19]
    ds_read_b64_tr_b16 a[172:173], v239 offset:12544
    ds_read_b64_tr_b16 a[174:175], v239 offset:18688
    v_mfma_f32_16x16x32_bf16 v[64:67], a[144:147], v[208:211], v[64:67]
    s_add_u32 m0, s21, 49152
    s_add_u32 s32, s22, 98304
    v_mfma_f32_16x16x32_bf16 v[112:115], a[144:147], v[212:215], v[112:115]
    buffer_load_dwordx4 v247, s[12:15], s32 offen offset:0 lds
    v_mfma_f32_16x16x32_bf16 v[20:23], a[148:151], v[204:207], v[20:23]
    v_max3_f32 v251, v251, v163, v164
    v_fma_f32 v165, v165, s20, -v218
    v_mfma_f32_16x16x32_bf16 v[68:71], a[148:151], v[208:211], v[68:71]
    v_fma_f32 v166, v166, s20, -v218
    v_max3_f32 v251, v251, v165, v166
    v_mfma_f32_16x16x32_bf16 v[116:119], a[148:151], v[212:215], v[116:119]
    ds_read_b128 a[144:147], v232 offset:36864
    v_mfma_f32_16x16x32_bf16 v[24:27], a[152:155], v[204:207], v[24:27]
    v_fma_f32 v167, v167, s20, -v218
    v_fma_f32 v168, v168, s20, -v216
    v_mfma_f32_16x16x32_bf16 v[72:75], a[152:155], v[208:211], v[72:75]
    v_max3_f32 v251, v251, v167, v168
    v_fma_f32 v169, v169, s20, -v216
    v_fma_f32 v170, v170, s20, -v216
    v_mfma_f32_16x16x32_bf16 v[120:123], a[152:155], v[212:215], v[120:123]
    ds_read_b128 a[148:151], v232 offset:43008
    v_mfma_f32_16x16x32_bf16 v[28:31], a[156:159], v[204:207], v[28:31]
    v_max3_f32 v251, v251, v169, v170
    v_fma_f32 v171, v171, s20, -v216
    v_mfma_f32_16x16x32_bf16 v[76:79], a[156:159], v[208:211], v[76:79]
    v_fma_f32 v172, v172, s20, -v217
    v_max3_f32 v251, v251, v171, v172
    v_mfma_f32_16x16x32_bf16 v[124:127], a[156:159], v[212:215], v[124:127]
    ds_read_b128 a[152:155], v233 offset:36864
    s_waitcnt lgkmcnt(3)
    v_mfma_f32_16x16x32_bf16 v[32:35], a[160:163], v[204:207], v[32:35]
    v_fma_f32 v173, v173, s20, -v217
    v_fma_f32 v174, v174, s20, -v217
    v_mfma_f32_16x16x32_bf16 v[80:83], a[160:163], v[208:211], v[80:83]
    ds_read_b128 a[156:159], v233 offset:43008
    v_mfma_f32_16x16x32_bf16 v[128:131], a[160:163], v[212:215], v[128:131]
    buffer_load_dwordx4 v248, s[12:15], s32 offen offset:1024 lds
    v_mfma_f32_16x16x32_bf16 v[36:39], a[164:167], v[204:207], v[36:39]
    v_max3_f32 v251, v251, v173, v174
    v_fma_f32 v175, v175, s20, -v217
    v_mfma_f32_16x16x32_bf16 v[84:87], a[164:167], v[208:211], v[84:87]
    v_fma_f32 v176, v176, s20, -v218
    v_max3_f32 v251, v251, v175, v176
    v_fma_f32 v177, v177, s20, -v218
    v_mfma_f32_16x16x32_bf16 v[132:135], a[164:167], v[212:215], v[132:135]
    ds_read_b128 a[160:163], v232 offset:36992
    v_mfma_f32_16x16x32_bf16 v[40:43], a[168:171], v[204:207], v[40:43]
    v_fma_f32 v178, v178, s20, -v218
    v_max3_f32 v251, v251, v177, v178
    v_mfma_f32_16x16x32_bf16 v[88:91], a[168:171], v[208:211], v[88:91]
    v_fma_f32 v179, v179, s20, -v218
    v_max_f32 v251, v251, v179
    v_cmp_lt_f32 vcc, 0x41000000, v251
    v_mfma_f32_16x16x32_bf16 v[136:139], a[168:171], v[212:215], v[136:139]
    ds_read_b128 a[164:167], v232 offset:43136
    v_mfma_f32_16x16x32_bf16 v[44:47], a[172:175], v[204:207], v[44:47]
    v_mfma_f32_16x16x32_bf16 v[92:95], a[172:175], v[208:211], v[92:95]
    ds_read_b128 a[168:171], v233 offset:36992
    v_mfma_f32_16x16x32_bf16 v[140:143], a[172:175], v[212:215], v[140:143]
    s_cbranch_vccnz L_rare5
L_back5:
    s_waitcnt lgkmcnt(3)
    v_mfma_f32_16x16x32_bf16 v[180:183], a[144:147], a[0:3], 0
    v_exp_f32 v156, v156
    v_exp_f32 v157, v157
    v_mfma_f32_16x16x32_bf16 v[184:187], a[144:147], a[24:27], 0
    ds_read_b128 a[172:175], v233 offset:43136
    v_mfma_f32_16x16x32_bf16 v[188:191], a[144:147], a[48:51], 0
    buffer_load_dwordx4 v249, s[12:15], s32 offen offset:2048 lds
    v_mfma_f32_16x16x32_bf16 v[192:195], a[148:151], a[0:3], 0
    v_exp_f32 v158, v158
    v_exp_f32 v159, v159
    v_mfma_f32_16x16x32_bf16 v[196:199], a[148:151], a[24:27], 0
    v_cvt_pk_bf16_f32 v204, v156, v157
    v_exp_f32 v168, v168
    v_mfma_f32_16x16x32_bf16 v[200:203], a[148:151], a[48:51], 0
    v_exp_f32 v169, v169
    ds_read_b128 a[144:147], v232 offset:37120
    v_mfma_f32_16x16x32_bf16 v[180:183], a[152:155], a[4:7], v[180:183]
    v_cvt_pk_bf16_f32 v205, v158, v159
    v_exp_f32 v170, v170
    v_mfma_f32_16x16x32_bf16 v[184:187], a[152:155], a[28:31], v[184:187]
    v_exp_f32 v171, v171
    v_cvt_pk_bf16_f32 v206, v168, v169
    v_mfma_f32_16x16x32_bf16 v[188:191], a[152:155], a[52:55], v[188:191]
    v_exp_f32 v160, v160
    ds_read_b128 a[148:151], v232 offset:43264
    v_mfma_f32_16x16x32_bf16 v[192:195], a[156:159], a[4:7], v[192:195]
    v_exp_f32 v161, v161
    v_cvt_pk_bf16_f32 v207, v170, v171
    v_mfma_f32_16x16x32_bf16 v[196:199], a[156:159], a[28:31], v[196:199]
    v_exp_f32 v162, v162
    v_exp_f32 v163, v163
    v_mfma_f32_16x16x32_bf16 v[200:203], a[156:159], a[52:55], v[200:203]
    ds_read_b128 a[152:155], v233 offset:37120
    s_waitcnt lgkmcnt(3)
    v_mfma_f32_16x16x32_bf16 v[180:183], a[160:163], a[8:11], v[180:183]
    v_cvt_pk_bf16_f32 v208, v160, v161
    ds_read_b128 a[156:159], v233 offset:43264
    v_mfma_f32_16x16x32_bf16 v[184:187], a[160:163], a[32:35], v[184:187]
    s_add_u32 m0, s21, 24576
    s_add_u32 s31, s22, 122880
    v_mfma_f32_16x16x32_bf16 v[188:191], a[160:163], a[56:59], v[188:191]
    buffer_load_dwordx4 v244, s[8:11], s31 offen offset:0 nt lds
    v_mfma_f32_16x16x32_bf16 v[192:195], a[164:167], a[8:11], v[192:195]
    v_exp_f32 v172, v172
    v_exp_f32 v173, v173
    v_mfma_f32_16x16x32_bf16 v[196:199], a[164:167], a[32:35], v[196:199]
    v_cvt_pk_bf16_f32 v209, v162, v163
    v_exp_f32 v174, v174
    v_mfma_f32_16x16x32_bf16 v[200:203], a[164:167], a[56:59], v[200:203]
    ds_read_b64_tr_b16 a[160:161], v236 offset:24576
    ds_read_b64_tr_b16 a[162:163], v236 offset:30720
    v_mfma_f32_16x16x32_bf16 v[180:183], a[168:171], a[12:15], v[180:183]
    v_exp_f32 v175, v175
    v_cvt_pk_bf16_f32 v210, v172, v173
    v_mfma_f32_16x16x32_bf16 v[184:187], a[168:171], a[36:39], v[184:187]
    v_exp_f32 v164, v164
    ds_read_b64_tr_b16 a[164:165], v237 offset:24576
    v_mfma_f32_16x16x32_bf16 v[188:191], a[168:171], a[60:63], v[188:191]
    ds_read_b64_tr_b16 a[166:167], v237 offset:30720
    v_mfma_f32_16x16x32_bf16 v[192:195], a[172:175], a[12:15], v[192:195]
    v_exp_f32 v165, v165
    v_cvt_pk_bf16_f32 v211, v174, v175
    v_mfma_f32_16x16x32_bf16 v[196:199], a[172:175], a[36:39], v[196:199]
    v_exp_f32 v166, v166
    ds_read_b64_tr_b16 a[168:169], v238 offset:24576
    v_mfma_f32_16x16x32_bf16 v[200:203], a[172:175], a[60:63], v[200:203]
    ds_read_b64_tr_b16 a[170:171], v238 offset:30720
    s_waitcnt lgkmcnt(6)
    v_mfma_f32_16x16x32_bf16 v[180:183], a[144:147], a[16:19], v[180:183]
    ds_read_b64_tr_b16 a[172:173], v239 offset:24576
    ds_read_b64_tr_b16 a[174:175], v239 offset:30720
    v_mfma_f32_16x16x32_bf16 v[184:187], a[144:147], a[40:43], v[184:187]
    buffer_load_dwordx4 v245, s[8:11], s31 offen offset:1024 nt lds
    v_mfma_f32_16x16x32_bf16 v[188:191], a[144:147], a[64:67], v[188:191]
    buffer_store_dwordx4 a[204:207], v243, s[16:19], s25 offen offset:0
    v_mfma_f32_16x16x32_bf16 v[192:195], a[148:151], a[16:19], v[192:195]
    v_exp_f32 v167, v167
    v_cvt_pk_bf16_f32 v212, v164, v165
    v_mfma_f32_16x16x32_bf16 v[196:199], a[148:151], a[40:43], v[196:199]
    ds_read_b64_tr_b16 a[144:145], v236 offset:24704
    ds_read_b64_tr_b16 a[146:147], v236 offset:30848
    v_mfma_f32_16x16x32_bf16 v[200:203], a[148:151], a[64:67], v[200:203]
    buffer_store_dwordx4 a[208:211], v243, s[16:19], s25 offen offset:1024
    v_mfma_f32_16x16x32_bf16 v[180:183], a[152:155], a[20:23], v[180:183]
    v_exp_f32 v176, v176
    v_exp_f32 v177, v177
    v_mfma_f32_16x16x32_bf16 v[184:187], a[152:155], a[44:47], v[184:187]
    v_cvt_pk_bf16_f32 v213, v166, v167
    ds_read_b64_tr_b16 a[148:149], v237 offset:24704
    v_mfma_f32_16x16x32_bf16 v[188:191], a[152:155], a[68:71], v[188:191]
    ds_read_b64_tr_b16 a[150:151], v237 offset:30848
    v_mfma_f32_16x16x32_bf16 v[192:195], a[156:159], a[20:23], v[192:195]
    v_exp_f32 v178, v178
    v_exp_f32 v179, v179
    v_mfma_f32_16x16x32_bf16 v[196:199], a[156:159], a[44:47], v[196:199]
    v_cvt_pk_bf16_f32 v214, v176, v177
    ds_read_b64_tr_b16 a[152:153], v238 offset:24704
    v_mfma_f32_16x16x32_bf16 v[200:203], a[156:159], a[68:71], v[200:203]
    ds_read_b64_tr_b16 a[154:155], v238 offset:30848
    v_cvt_pk_bf16_f32 v215, v178, v179
    s_nop 0
    v_mfma_f32_16x16x32_bf16 v[144:147], a[176:179], v[204:207], v[144:147]
    v_fma_f32 v180, v180, s20, -v216
    v_fma_f32 v181, v181, s20, -v216
    v_mfma_f32_16x16x32_bf16 v[148:151], a[176:179], v[208:211], v[148:151]
    v_fma_f32 v182, v182, s20, -v216
    v_max3_f32 v251, v180, v181, v182
    v_mfma_f32_16x16x32_bf16 v[152:155], a[176:179], v[212:215], v[152:155]
    v_fma_f32 v183, v183, s20, -v216
    v_fma_f32 v184, v184, s20, -v217
    s_waitcnt lgkmcnt(6)
    v_mfma_f32_16x16x32_bf16 v[0:3], a[160:163], v[204:207], v[0:3]
    ds_read_b64_tr_b16 a[156:157], v239 offset:24704
    v_mfma_f32_16x16x32_bf16 v[48:51], a[160:163], v[208:211], v[48:51]
    ds_read_b64_tr_b16 a[158:159], v239 offset:30848
    v_mfma_f32_16x16x32_bf16 v[96:99], a[160:163], v[212:215], v[96:99]
    buffer_load_dwordx4 v246, s[8:11], s31 offen offset:2048 nt lds
    v_mfma_f32_16x16x32_bf16 v[4:7], a[164:167], v[204:207], v[4:7]
    v_max3_f32 v251, v251, v183, v184
    v_fma_f32 v185, v185, s20, -v217
    v_mfma_f32_16x16x32_bf16 v[52:55], a[164:167], v[208:211], v[52:55]
    v_fma_f32 v186, v186, s20, -v217
    ds_read_b64_tr_b16 a[160:161], v236 offset:24832
    v_mfma_f32_16x16x32_bf16 v[100:103], a[164:167], v[212:215], v[100:103]
    ds_read_b64_tr_b16 a[162:163], v236 offset:30976
    v_mfma_f32_16x16x32_bf16 v[8:11], a[168:171], v[204:207], v[8:11]
    v_max3_f32 v251, v251, v185, v186
    v_fma_f32 v187, v187, s20, -v217
    v_mfma_f32_16x16x32_bf16 v[56:59], a[168:171], v[208:211], v[56:59]
    v_fma_f32 v188, v188, s20, -v218
    ds_read_b64_tr_b16 a[164:165], v237 offset:24832
    v_mfma_f32_16x16x32_bf16 v[104:107], a[168:171], v[212:215], v[104:107]
    ds_read_b64_tr_b16 a[166:167], v237 offset:30976
    v_mfma_f32_16x16x32_bf16 v[12:15], a[172:175], v[204:207], v[12:15]
    ds_read_b64_tr_b16 a[168:169], v238 offset:24832
    v_mfma_f32_16x16x32_bf16 v[60:63], a[172:175], v[208:211], v[60:63]
    v_mfma_f32_16x16x32_bf16 v[108:111], a[172:175], v[212:215], v[108:111]
    ds_read_b64_tr_b16 a[170:171], v238 offset:30976
    s_waitcnt vmcnt(13)
    s_barrier
    s_waitcnt lgkmcnt(6)
    v_mfma_f32_16x16x32_bf16 v[16:19], a[144:147], v[204:207], v[16:19]
    ds_read_b64_tr_b16 a[172:173], v239 offset:24832
    ds_read_b64_tr_b16 a[174:175], v239 offset:30976
    v_mfma_f32_16x16x32_bf16 v[64:67], a[144:147], v[208:211], v[64:67]
    s_add_u32 m0, s21, 61440
    s_add_u32 s32, s22, 110592
    v_mfma_f32_16x16x32_bf16 v[112:115], a[144:147], v[212:215], v[112:115]
    buffer_load_dwordx4 v247, s[12:15], s32 offen offset:0 lds
    v_mfma_f32_16x16x32_bf16 v[20:23], a[148:151], v[204:207], v[20:23]
    v_max3_f32 v251, v251, v187, v188
    v_fma_f32 v189, v189, s20, -v218
    v_mfma_f32_16x16x32_bf16 v[68:71], a[148:151], v[208:211], v[68:71]
    v_fma_f32 v190, v190, s20, -v218
    v_max3_f32 v251, v251, v189, v190
    v_mfma_f32_16x16x32_bf16 v[116:119], a[148:151], v[212:215], v[116:119]
    ds_read_b128 a[144:147], v232 offset:0
    v_mfma_f32_16x16x32_bf16 v[24:27], a[152:155], v[204:207], v[24:27]
    v_fma_f32 v191, v191, s20, -v218
    v_fma_f32 v192, v192, s20, -v216
    v_mfma_f32_16x16x32_bf16 v[72:75], a[152:155], v[208:211], v[72:75]
    v_max3_f32 v251, v251, v191, v192
    v_fma_f32 v193, v193, s20, -v216
    v_fma_f32 v194, v194, s20, -v216
    v_mfma_f32_16x16x32_bf16 v[120:123], a[152:155], v[212:215], v[120:123]
    ds_read_b128 a[148:151], v232 offset:6144
    v_mfma_f32_16x16x32_bf16 v[28:31], a[156:159], v[204:207], v[28:31]
    v_max3_f32 v251, v251, v193, v194
    v_fma_f32 v195, v195, s20, -v216
    v_mfma_f32_16x16x32_bf16 v[76:79], a[156:159], v[208:211], v[76:79]
    v_fma_f32 v196, v196, s20, -v217
    v_max3_f32 v251, v251, v195, v196
    v_mfma_f32_16x16x32_bf16 v[124:127], a[156:159], v[212:215], v[124:127]
    ds_read_b128 a[152:155], v233 offset:0
    s_waitcnt lgkmcnt(3)
    v_mfma_f32_16x16x32_bf16 v[32:35], a[160:163], v[204:207], v[32:35]
    v_fma_f32 v197, v197, s20, -v217
    v_fma_f32 v198, v198, s20, -v217
    v_mfma_f32_16x16x32_bf16 v[80:83], a[160:163], v[208:211], v[80:83]
    ds_read_b128 a[156:159], v233 offset:6144
    v_mfma_f32_16x16x32_bf16 v[128:131], a[160:163], v[212:215], v[128:131]
    buffer_load_dwordx4 v248, s[12:15], s32 offen offset:1024 lds
    v_mfma_f32_16x16x32_bf16 v[36:39], a[164:167], v[204:207], v[36:39]
    v_max3_f32 v251, v251, v197, v198
    v_fma_f32 v199, v199, s20, -v217
    v_mfma_f32_16x16x32_bf16 v[84:87], a[164:167], v[208:211], v[84:87]
    v_fma_f32 v200, v200, s20, -v218
    v_max3_f32 v251, v251, v199, v200
    v_fma_f32 v201, v201, s20, -v218
    v_mfma_f32_16x16x32_bf16 v[132:135], a[164:167], v[212:215], v[132:135]
    ds_read_b128 a[160:163], v232 offset:128
    v_mfma_f32_16x16x32_bf16 v[40:43], a[168:171], v[204:207], v[40:43]
    v_fma_f32 v202, v202, s20, -v218
    v_max3_f32 v251, v251, v201, v202
    v_mfma_f32_16x16x32_bf16 v[88:91], a[168:171], v[208:211], v[88:91]
    v_fma_f32 v203, v203, s20, -v218
    v_max_f32 v251, v251, v203
    v_cmp_lt_f32 vcc, 0x41000000, v251
    v_mfma_f32_16x16x32_bf16 v[136:139], a[168:171], v[212:215], v[136:139]
    ds_read_b128 a[164:167], v232 offset:6272
    v_mfma_f32_16x16x32_bf16 v[44:47], a[172:175], v[204:207], v[44:47]
    v_mfma_f32_16x16x32_bf16 v[92:95], a[172:175], v[208:211], v[92:95]
    ds_read_b128 a[168:171], v233 offset:128
    v_mfma_f32_16x16x32_bf16 v[140:143], a[172:175], v[212:215], v[140:143]
    s_cbranch_vccnz L_rare6
L_back6:
    s_waitcnt lgkmcnt(3)
    v_mfma_f32_16x16x32_bf16 v[156:159], a[144:147], a[0:3], 0
    v_exp_f32 v180, v180
    v_exp_f32 v181, v181
    v_mfma_f32_16x16x32_bf16 v[160:163], a[144:147], a[24:27], 0
    ds_read_b128 a[172:175], v233 offset:6272
    v_mfma_f32_16x16x32_bf16 v[164:167], a[144:147], a[48:51], 0
    buffer_load_dwordx4 v249, s[12:15], s32 offen offset:2048 lds
    v_mfma_f32_16x16x32_bf16 v[168:171], a[148:151], a[0:3], 0
    v_exp_f32 v182, v182
    v_exp_f32 v183, v183
    v_mfma_f32_16x16x32_bf16 v[172:175], a[148:151], a[24:27], 0
    v_cvt_pk_bf16_f32 v204, v180, v181
    v_exp_f32 v192, v192
    v_mfma_f32_16x16x32_bf16 v[176:179], a[148:151], a[48:51], 0
    ds_read_b128 a[144:147], v232 offset:256
    v_mfma_f32_16x16x32_bf16 v[156:159], a[152:155], a[4:7], v[156:159]
    v_exp_f32 v193, v193
    v_cvt_pk_bf16_f32 v205, v182, v183
    v_mfma_f32_16x16x32_bf16 v[160:163], a[152:155], a[28:31], v[160:163]
    v_exp_f32 v194, v194
    v_exp_f32 v195, v195
    v_mfma_f32_16x16x32_bf16 v[164:167], a[152:155], a[52:55], v[164:167]
    v_cvt_pk_bf16_f32 v206, v192, v193
    ds_read_b128 a[148:151], v232 offset:6400
    v_mfma_f32_16x16x32_bf16 v[168:171], a[156:159], a[4:7], v[168:171]
    v_exp_f32 v184, v184
    v_exp_f32 v185, v185
    v_mfma_f32_16x16x32_bf16 v[172:175], a[156:159], a[28:31], v[172:175]
    v_cvt_pk_bf16_f32 v207, v194, v195
    v_exp_f32 v186, v186
    v_mfma_f32_16x16x32_bf16 v[176:179], a[156:159], a[52:55], v[176:179]
    ds_read_b128 a[152:155], v233 offset:256
    s_waitcnt lgkmcnt(3)
    v_mfma_f32_16x16x32_bf16 v[156:159], a[160:163], a[8:11], v[156:159]
    v_exp_f32 v187, v187
    ds_read_b128 a[156:159], v233 offset:6400
    v_mfma_f32_16x16x32_bf16 v[160:163], a[160:163], a[32:35], v[160:163]
    s_add_u32 m0, s21, 36864
    s_add_u32 s31, s22, 135168
    v_mfma_f32_16x16x32_bf16 v[164:167], a[160:163], a[56:59], v[164:167]
    buffer_load_dwordx4 v244, s[8:11], s31 offen offset:0 nt lds
    buffer_load_dwordx4 a[96:99], v250, s[4:7], s28 offen offset:0 nt
    v_mfma_f32_16x16x32_bf16 v[168:171], a[164:167], a[8:11], v[168:171]
    v_cvt_pk_bf16_f32 v208, v184, v185
    v_exp_f32 v196, v196
    v_mfma_f32_16x16x32_bf16 v[172:175], a[164:167], a[32:35], v[172:175]
    ds_read_b64_tr_b16 a[160:161], v236 offset:36864
    v_mfma_f32_16x16x32_bf16 v[176:179], a[164:167], a[56:59], v[176:179]
    ds_read_b64_tr_b16 a[162:163], v236 offset:43008
    buffer_load_dwordx4 a[100:103], v250, s[4:7], s28 offen offset:64 nt
    v_mfma_f32_16x16x32_bf16 v[156:159], a[168:171], a[12:15], v[156:159]
    v_exp_f32 v197, v197
    v_cvt_pk_bf16_f32 v209, v186, v187
    v_mfma_f32_16x16x32_bf16 v[160:163], a[168:171], a[36:39], v[160:163]
    v_exp_f32 v198, v198
    ds_read_b64_tr_b16 a[164:165], v237 offset:36864
    v_mfma_f32_16x16x32_bf16 v[164:167], a[168:171], a[60:63], v[164:167]
    ds_read_b64_tr_b16 a[166:167], v237 offset:43008
    v_mfma_f32_16x16x32_bf16 v[168:171], a[172:175], a[12:15], v[168:171]
    v_exp_f32 v199, v199
    v_cvt_pk_bf16_f32 v210, v196, v197
    v_mfma_f32_16x16x32_bf16 v[172:175], a[172:175], a[36:39], v[172:175]
    v_exp_f32 v188, v188
    ds_read_b64_tr_b16 a[168:169], v238 offset:36864
    v_mfma_f32_16x16x32_bf16 v[176:179], a[172:175], a[60:63], v[176:179]
    ds_read_b64_tr_b16 a[170:171], v238 offset:43008
    s_waitcnt lgkmcnt(6)
    v_mfma_f32_16x16x32_bf16 v[156:159], a[144:147], a[16:19], v[156:159]
    v_exp_f32 v189, v189
    v_cvt_pk_bf16_f32 v211, v198, v199
    v_mfma_f32_16x16x32_bf16 v[160:163], a[144:147], a[40:43], v[160:163]
    ds_read_b64_tr_b16 a[172:173], v239 offset:36864
    ds_read_b64_tr_b16 a[174:175], v239 offset:43008
    v_mfma_f32_16x16x32_bf16 v[164:167], a[144:147], a[64:67], v[164:167]
    buffer_load_dwordx4 v245, s[8:11], s31 offen offset:1024 nt lds
    v_mfma_f32_16x16x32_bf16 v[168:171], a[148:151], a[16:19], v[168:171]
    v_exp_f32 v190, v190
    v_exp_f32 v191, v191
    v_mfma_f32_16x16x32_bf16 v[172:175], a[148:151], a[40:43], v[172:175]
    v_cvt_pk_bf16_f32 v212, v188, v189
    ds_read_b64_tr_b16 a[144:145], v236 offset:36992
    v_mfma_f32_16x16x32_bf16 v[176:179], a[148:151], a[64:67], v[176:179]
    ds_read_b64_tr_b16 a[146:147], v236 offset:43136
    v_mfma_f32_16x16x32_bf16 v[156:159], a[152:155], a[20:23], v[156:159]
    v_exp_f32 v200, v200
    v_exp_f32 v201, v201
    v_mfma_f32_16x16x32_bf16 v[160:163], a[152:155], a[44:47], v[160:163]
    v_cvt_pk_bf16_f32 v213, v190, v191
    ds_read_b64_tr_b16 a[148:149], v237 offset:36992
    v_mfma_f32_16x16x32_bf16 v[164:167], a[152:155], a[68:71], v[164:167]
    ds_read_b64_tr_b16 a[150:151], v237 offset:43136
    v_mfma_f32_16x16x32_bf16 v[168:171], a[156:159], a[20:23], v[168:171]
    v_exp_f32 v202, v202
    v_exp_f32 v203, v203
    v_mfma_f32_16x16x32_bf16 v[172:175], a[156:159], a[44:47], v[172:175]
    v_cvt_pk_bf16_f32 v214, v200, v201
    ds_read_b64_tr_b16 a[152:153], v238 offset:36992
    v_mfma_f32_16x16x32_bf16 v[176:179], a[156:159], a[68:71], v[176:179]
    ds_read_b64_tr_b16 a[154:155], v238 offset:43136
    v_cvt_pk_bf16_f32 v215, v202, v203
    s_nop 0
    v_mfma_f32_16x16x32_bf16 v[144:147], a[176:179], v[204:207], v[144:147]
    v_fma_f32 v156, v156, s20, -v216
    v_fma_f32 v157, v157, s20, -v216
    v_mfma_f32_16x16x32_bf16 v[148:151], a[176:179], v[208:211], v[148:151]
    v_fma_f32 v158, v158, s20, -v216
    v_max3_f32 v251, v156, v157, v158
    v_mfma_f32_16x16x32_bf16 v[152:155], a[176:179], v[212:215], v[152:155]
    v_fma_f32 v159, v159, s20, -v216
    v_fma_f32 v160, v160, s20, -v217
    s_waitcnt lgkmcnt(6)
    v_mfma_f32_16x16x32_bf16 v[0:3], a[160:163], v[204:207], v[0:3]
    ds_read_b64_tr_b16 a[156:157], v239 offset:36992
    v_mfma_f32_16x16x32_bf16 v[48:51], a[160:163], v[208:211], v[48:51]
    ds_read_b64_tr_b16 a[158:159], v239 offset:43136
    v_mfma_f32_16x16x32_bf16 v[96:99], a[160:163], v[212:215], v[96:99]
    buffer_load_dwordx4 v246, s[8:11], s31 offen offset:2048 nt lds
    v_mfma_f32_16x16x32_bf16 v[4:7], a[164:167], v[204:207], v[4:7]
    v_max3_f32 v251, v251, v159, v160
    v_fma_f32 v161, v161, s20, -v217
    v_mfma_f32_16x16x32_bf16 v[52:55], a[164:167], v[208:211], v[52:55]
    v_fma_f32 v162, v162, s20, -v217
    ds_read_b64_tr_b16 a[160:161], v236 offset:37120
    v_mfma_f32_16x16x32_bf16 v[100:103], a[164:167], v[212:215], v[100:103]
    ds_read_b64_tr_b16 a[162:163], v236 offset:43264
    v_mfma_f32_16x16x32_bf16 v[8:11], a[168:171], v[204:207], v[8:11]
    v_max3_f32 v251, v251, v161, v162
    v_fma_f32 v163, v163, s20, -v217
    v_mfma_f32_16x16x32_bf16 v[56:59], a[168:171], v[208:211], v[56:59]
    v_fma_f32 v164, v164, s20, -v218
    ds_read_b64_tr_b16 a[164:165], v237 offset:37120
    v_mfma_f32_16x16x32_bf16 v[104:107], a[168:171], v[212:215], v[104:107]
    ds_read_b64_tr_b16 a[166:167], v237 offset:43264
    v_mfma_f32_16x16x32_bf16 v[12:15], a[172:175], v[204:207], v[12:15]
    ds_read_b64_tr_b16 a[168:169], v238 offset:37120
    v_mfma_f32_16x16x32_bf16 v[60:63], a[172:175], v[208:211], v[60:63]
    v_mfma_f32_16x16x32_bf16 v[108:111], a[172:175], v[212:215], v[108:111]
    ds_read_b64_tr_b16 a[170:171], v238 offset:43264
    s_waitcnt vmcnt(13)
    s_barrier
    s_waitcnt lgkmcnt(6)
    v_mfma_f32_16x16x32_bf16 v[16:19], a[144:147], v[204:207], v[16:19]
    ds_read_b64_tr_b16 a[172:173], v239 offset:37120
    ds_read_b64_tr_b16 a[174:175], v239 offset:43264
    v_mfma_f32_16x16x32_bf16 v[64:67], a[144:147], v[208:211], v[64:67]
    s_add_u32 m0, s21, 73728
    s_add_u32 s32, s22, 122880
    v_mfma_f32_16x16x32_bf16 v[112:115], a[144:147], v[212:215], v[112:115]
    buffer_load_dwordx4 v247, s[12:15], s32 offen offset:0 lds
    v_mfma_f32_16x16x32_bf16 v[20:23], a[148:151], v[204:207], v[20:23]
    v_max3_f32 v251, v251, v163, v164
    v_fma_f32 v165, v165, s20, -v218
    v_mfma_f32_16x16x32_bf16 v[68:71], a[148:151], v[208:211], v[68:71]
    v_fma_f32 v166, v166, s20, -v218
    v_max3_f32 v251, v251, v165, v166
    v_mfma_f32_16x16x32_bf16 v[116:119], a[148:151], v[212:215], v[116:119]
    ds_read_b128 a[144:147], v232 offset:12288
    v_mfma_f32_16x16x32_bf16 v[24:27], a[152:155], v[204:207], v[24:27]
    v_fma_f32 v167, v167, s20, -v218
    v_fma_f32 v168, v168, s20, -v216
    v_mfma_f32_16x16x32_bf16 v[72:75], a[152:155], v[208:211], v[72:75]
    v_max3_f32 v251, v251, v167, v168
    v_fma_f32 v169, v169, s20, -v216
    v_fma_f32 v170, v170, s20, -v216
    v_mfma_f32_16x16x32_bf16 v[120:123], a[152:155], v[212:215], v[120:123]
    ds_read_b128 a[148:151], v232 offset:18432
    v_mfma_f32_16x16x32_bf16 v[28:31], a[156:159], v[204:207], v[28:31]
    v_max3_f32 v251, v251, v169, v170
    v_fma_f32 v171, v171, s20, -v216
    v_mfma_f32_16x16x32_bf16 v[76:79], a[156:159], v[208:211], v[76:79]
    v_fma_f32 v172, v172, s20, -v217
    v_max3_f32 v251, v251, v171, v172
    v_mfma_f32_16x16x32_bf16 v[124:127], a[156:159], v[212:215], v[124:127]
    ds_read_b128 a[152:155], v233 offset:12288
    s_waitcnt lgkmcnt(3)
    v_mfma_f32_16x16x32_bf16 v[32:35], a[160:163], v[204:207], v[32:35]
    v_fma_f32 v173, v173, s20, -v217
    v_fma_f32 v174, v174, s20, -v217
    v_mfma_f32_16x16x32_bf16 v[80:83], a[160:163], v[208:211], v[80:83]
    ds_read_b128 a[156:159], v233 offset:18432
    v_mfma_f32_16x16x32_bf16 v[128:131], a[160:163], v[212:215], v[128:131]
    buffer_load_dwordx4 v248, s[12:15], s32 offen offset:1024 lds
    v_mfma_f32_16x16x32_bf16 v[36:39], a[164:167], v[204:207], v[36:39]
    v_max3_f32 v251, v251, v173, v174
    v_fma_f32 v175, v175, s20, -v217
    v_mfma_f32_16x16x32_bf16 v[84:87], a[164:167], v[208:211], v[84:87]
    v_fma_f32 v176, v176, s20, -v218
    v_max3_f32 v251, v251, v175, v176
    v_fma_f32 v177, v177, s20, -v218
    v_mfma_f32_16x16x32_bf16 v[132:135], a[164:167], v[212:215], v[132:135]
    ds_read_b128 a[160:163], v232 offset:12416
    v_mfma_f32_16x16x32_bf16 v[40:43], a[168:171], v[204:207], v[40:43]
    v_fma_f32 v178, v178, s20, -v218
    v_max3_f32 v251, v251, v177, v178
    v_mfma_f32_16x16x32_bf16 v[88:91], a[168:171], v[208:211], v[88:91]
    v_fma_f32 v179, v179, s20, -v218
    v_max_f32 v251, v251, v179
    v_cmp_lt_f32 vcc, 0x41000000, v251
    v_mfma_f32_16x16x32_bf16 v[136:139], a[168:171], v[212:215], v[136:139]
    ds_read_b128 a[164:167], v232 offset:18560
    v_mfma_f32_16x16x32_bf16 v[44:47], a[172:175], v[204:207], v[44:47]
    v_mfma_f32_16x16x32_bf16 v[92:95], a[172:175], v[208:211], v[92:95]
    ds_read_b128 a[168:171], v233 offset:12416
    v_mfma_f32_16x16x32_bf16 v[140:143], a[172:175], v[212:215], v[140:143]
    s_cbranch_vccnz L_rare7
L_back7:
    s_waitcnt lgkmcnt(3)
    v_mfma_f32_16x16x32_bf16 v[180:183], a[144:147], a[0:3], 0
    v_exp_f32 v156, v156
    v_exp_f32 v157, v157
    v_mfma_f32_16x16x32_bf16 v[184:187], a[144:147], a[24:27], 0
    ds_read_b128 a[172:175], v233 offset:18560
    v_mfma_f32_16x16x32_bf16 v[188:191], a[144:147], a[48:51], 0
    buffer_load_dwordx4 v249, s[12:15], s32 offen offset:2048 lds
    v_mfma_f32_16x16x32_bf16 v[192:195], a[148:151], a[0:3], 0
    v_exp_f32 v158, v158
    v_exp_f32 v159, v159
    v_mfma_f32_16x16x32_bf16 v[196:199], a[148:151], a[24:27], 0
    v_cvt_pk_bf16_f32 v204, v156, v157
    v_exp_f32 v168, v168
    v_mfma_f32_16x16x32_bf16 v[200:203], a[148:151], a[48:51], 0
    v_exp_f32 v169, v169
    ds_read_b128 a[144:147], v232 offset:12544
    v_mfma_f32_16x16x32_bf16 v[180:183], a[152:155], a[4:7], v[180:183]
    v_cvt_pk_bf16_f32 v205, v158, v159
    v_exp_f32 v170, v170
    v_mfma_f32_16x16x32_bf16 v[184:187], a[152:155], a[28:31], v[184:187]
    v_exp_f32 v171, v171
    v_cvt_pk_bf16_f32 v206, v168, v169
    v_mfma_f32_16x16x32_bf16 v[188:191], a[152:155], a[52:55], v[188:191]
    v_exp_f32 v160, v160
    ds_read_b128 a[148:151], v232 offset:18688
    v_mfma_f32_16x16x32_bf16 v[192:195], a[156:159], a[4:7], v[192:195]
    v_exp_f32 v161, v161
    v_cvt_pk_bf16_f32 v207, v170, v171
    v_mfma_f32_16x16x32_bf16 v[196:199], a[156:159], a[28:31], v[196:199]
    v_exp_f32 v162, v162
    v_exp_f32 v163, v163
    v_mfma_f32_16x16x32_bf16 v[200:203], a[156:159], a[52:55], v[200:203]
    ds_read_b128 a[152:155], v233 offset:12544
    s_waitcnt lgkmcnt(3)
    v_mfma_f32_16x16x32_bf16 v[180:183], a[160:163], a[8:11], v[180:183]
    v_cvt_pk_bf16_f32 v208, v160, v161
    ds_read_b128 a[156:159], v233 offset:18688
    v_mfma_f32_16x16x32_bf16 v[184:187], a[160:163], a[32:35], v[184:187]
    s_add_u32 m0, s21, 0
    s_add_u32 s31, s22, 147456
    v_mfma_f32_16x16x32_bf16 v[188:191], a[160:163], a[56:59], v[188:191]
    buffer_load_dwordx4 v244, s[8:11], s31 offen offset:0 nt lds
    v_mfma_f32_16x16x32_bf16 v[192:195], a[164:167], a[8:11], v[192:195]
    v_exp_f32 v172, v172
    v_exp_f32 v173, v173
    v_mfma_f32_16x16x32_bf16 v[196:199], a[164:167], a[32:35], v[196:199]
    v_cvt_pk_bf16_f32 v209, v162, v163
    v_exp_f32 v174, v174
    v_mfma_f32_16x16x32_bf16 v[200:203], a[164:167], a[56:59], v[200:203]
    ds_read_b64_tr_b16 a[160:161], v236 offset:0
    ds_read_b64_tr_b16 a[162:163], v236 offset:6144
    v_mfma_f32_16x16x32_bf16 v[180:183], a[168:171], a[12:15], v[180:183]
    v_exp_f32 v175, v175
    v_cvt_pk_bf16_f32 v210, v172, v173
    v_mfma_f32_16x16x32_bf16 v[184:187], a[168:171], a[36:39], v[184:187]
    v_exp_f32 v164, v164
    ds_read_b64_tr_b16 a[164:165], v237 offset:0
    v_mfma_f32_16x16x32_bf16 v[188:191], a[168:171], a[60:63], v[188:191]
    ds_read_b64_tr_b16 a[166:167], v237 offset:6144
    v_mfma_f32_16x16x32_bf16 v[192:195], a[172:175], a[12:15], v[192:195]
    v_exp_f32 v165, v165
    v_cvt_pk_bf16_f32 v211, v174, v175
    v_mfma_f32_16x16x32_bf16 v[196:199], a[172:175], a[36:39], v[196:199]
    v_exp_f32 v166, v166
    ds_read_b64_tr_b16 a[168:169], v238 offset:0
    v_mfma_f32_16x16x32_bf16 v[200:203], a[172:175], a[60:63], v[200:203]
    ds_read_b64_tr_b16 a[170:171], v238 offset:6144
    s_waitcnt lgkmcnt(6)
    v_mfma_f32_16x16x32_bf16 v[180:183], a[144:147], a[16:19], v[180:183]
    ds_read_b64_tr_b16 a[172:173], v239 offset:0
    ds_read_b64_tr_b16 a[174:175], v239 offset:6144
    v_mfma_f32_16x16x32_bf16 v[184:187], a[144:147], a[40:43], v[184:187]
    buffer_load_dwordx4 v245, s[8:11], s31 offen offset:1024 nt lds
    v_mfma_f32_16x16x32_bf16 v[188:191], a[144:147], a[64:67], v[188:191]
    buffer_store_dwordx4 a[212:215], v243, s[16:19], s25 offen offset:2048
    v_mfma_f32_16x16x32_bf16 v[192:195], a[148:151], a[16:19], v[192:195]
    v_exp_f32 v167, v167
    v_cvt_pk_bf16_f32 v212, v164, v165
    v_mfma_f32_16x16x32_bf16 v[196:199], a[148:151], a[40:43], v[196:199]
    ds_read_b64_tr_b16 a[144:145], v236 offset:128
    ds_read_b64_tr_b16 a[146:147], v236 offset:6272
    v_mfma_f32_16x16x32_bf16 v[200:203], a[148:151], a[64:67], v[200:203]
    buffer_store_dwordx4 a[216:219], v243, s[16:19], s25 offen offset:3072
    v_mfma_f32_16x16x32_bf16 v[180:183], a[152:155], a[20:23], v[180:183]
    v_exp_f32 v176, v176
    v_exp_f32 v177, v177
    v_mfma_f32_16x16x32_bf16 v[184:187], a[152:155], a[44:47], v[184:187]
    v_cvt_pk_bf16_f32 v213, v166, v167
    ds_read_b64_tr_b16 a[148:149], v237 offset:128
    v_mfma_f32_16x16x32_bf16 v[188:191], a[152:155], a[68:71], v[188:191]
    ds_read_b64_tr_b16 a[150:151], v237 offset:6272
    v_mfma_f32_16x16x32_bf16 v[192:195], a[156:159], a[20:23], v[192:195]
    v_exp_f32 v178, v178
    v_exp_f32 v179, v179
    v_mfma_f32_16x16x32_bf16 v[196:199], a[156:159], a[44:47], v[196:199]
    v_cvt_pk_bf16_f32 v214, v176, v177
    ds_read_b64_tr_b16 a[152:153], v238 offset:128
    v_mfma_f32_16x16x32_bf16 v[200:203], a[156:159], a[68:71], v[200:203]
    ds_read_b64_tr_b16 a[154:155], v238 offset:6272
    v_cvt_pk_bf16_f32 v215, v178, v179
    s_nop 0
    v_mfma_f32_16x16x32_bf16 v[144:147], a[176:179], v[204:207], v[144:147]
    v_fma_f32 v180, v180, s20, -v216
    v_fma_f32 v181, v181, s20, -v216
    v_mfma_f32_16x16x32_bf16 v[148:151], a[176:179], v[208:211], v[148:151]
    v_fma_f32 v182, v182, s20, -v216
    v_max3_f32 v251, v180, v181, v182
    v_mfma_f32_16x16x32_bf16 v[152:155], a[176:179], v[212:215], v[152:155]
    v_fma_f32 v183, v183, s20, -v216
    v_fma_f32 v184, v184, s20, -v217
    s_waitcnt lgkmcnt(6)
    v_mfma_f32_16x16x32_bf16 v[0:3], a[160:163], v[204:207], v[0:3]
    ds_read_b64_tr_b16 a[156:157], v239 offset:128
    v_mfma_f32_16x16x32_bf16 v[48:51], a[160:163], v[208:211], v[48:51]
    ds_read_b64_tr_b16 a[158:159], v239 offset:6272
    v_mfma_f32_16x16x32_bf16 v[96:99], a[160:163], v[212:215], v[96:99]
    buffer_load_dwordx4 v246, s[8:11], s31 offen offset:2048 nt lds
    v_mfma_f32_16x16x32_bf16 v[4:7], a[164:167], v[204:207], v[4:7]
    v_max3_f32 v251, v251, v183, v184
    v_fma_f32 v185, v185, s20, -v217
    v_mfma_f32_16x16x32_bf16 v[52:55], a[164:167], v[208:211], v[52:55]
    v_fma_f32 v186, v186, s20, -v217
    ds_read_b64_tr_b16 a[160:161], v236 offset:256
    v_mfma_f32_16x16x32_bf16 v[100:103], a[164:167], v[212:215], v[100:103]
    ds_read_b64_tr_b16 a[162:163], v236 offset:6400
    v_mfma_f32_16x16x32_bf16 v[8:11], a[168:171], v[204:207], v[8:11]
    v_max3_f32 v251, v251, v185, v186
    v_fma_f32 v187, v187, s20, -v217
    v_mfma_f32_16x16x32_bf16 v[56:59], a[168:171], v[208:211], v[56:59]
    v_fma_f32 v188, v188, s20, -v218
    ds_read_b64_tr_b16 a[164:165], v237 offset:256
    v_mfma_f32_16x16x32_bf16 v[104:107], a[168:171], v[212:215], v[104:107]
    ds_read_b64_tr_b16 a[166:167], v237 offset:6400
    v_mfma_f32_16x16x32_bf16 v[12:15], a[172:175], v[204:207], v[12:15]
    ds_read_b64_tr_b16 a[168:169], v238 offset:256
    v_mfma_f32_16x16x32_bf16 v[60:63], a[172:175], v[208:211], v[60:63]
    v_mfma_f32_16x16x32_bf16 v[108:111], a[172:175], v[212:215], v[108:111]
    ds_read_b64_tr_b16 a[170:171], v238 offset:6400
    s_waitcnt vmcnt(13)
    s_barrier
    s_waitcnt lgkmcnt(6)
    v_mfma_f32_16x16x32_bf16 v[16:19], a[144:147], v[204:207], v[16:19]
    ds_read_b64_tr_b16 a[172:173], v239 offset:256
    ds_read_b64_tr_b16 a[174:175], v239 offset:6400
    v_mfma_f32_16x16x32_bf16 v[64:67], a[144:147], v[208:211], v[64:67]
    s_add_u32 m0, s21, 86016
    s_add_u32 s32, s22, 135168
    v_mfma_f32_16x16x32_bf16 v[112:115], a[144:147], v[212:215], v[112:115]
    buffer_load_dwordx4 v247, s[12:15], s32 offen offset:0 lds
    v_mfma_f32_16x16x32_bf16 v[20:23], a[148:151], v[204:207], v[20:23]
    v_max3_f32 v251, v251, v187, v188
    v_fma_f32 v189, v189, s20, -v218
    v_mfma_f32_16x16x32_bf16 v[68:71], a[148:151], v[208:211], v[68:71]
    v_fma_f32 v190, v190, s20, -v218
    v_max3_f32 v251, v251, v189, v190
    v_mfma_f32_16x16x32_bf16 v[116:119], a[148:151], v[212:215], v[116:119]
    ds_read_b128 a[144:147], v232 offset:24576
    v_mfma_f32_16x16x32_bf16 v[24:27], a[152:155], v[204:207], v[24:27]
    v_fma_f32 v191, v191, s20, -v218
    v_fma_f32 v192, v192, s20, -v216
    v_mfma_f32_16x16x32_bf16 v[72:75], a[152:155], v[208:211], v[72:75]
    v_max3_f32 v251, v251, v191, v192
    v_fma_f32 v193, v193, s20, -v216
    v_fma_f32 v194, v194, s20, -v216
    v_mfma_f32_16x16x32_bf16 v[120:123], a[152:155], v[212:215], v[120:123]
    ds_read_b128 a[148:151], v232 offset:30720
    v_mfma_f32_16x16x32_bf16 v[28:31], a[156:159], v[204:207], v[28:31]
    v_max3_f32 v251, v251, v193, v194
    v_fma_f32 v195, v195, s20, -v216
    v_mfma_f32_16x16x32_bf16 v[76:79], a[156:159], v[208:211], v[76:79]
    v_fma_f32 v196, v196, s20, -v217
    v_max3_f32 v251, v251, v195, v196
    v_mfma_f32_16x16x32_bf16 v[124:127], a[156:159], v[212:215], v[124:127]
    ds_read_b128 a[152:155], v233 offset:24576
    s_waitcnt lgkmcnt(3)
    v_mfma_f32_16x16x32_bf16 v[32:35], a[160:163], v[204:207], v[32:35]
    v_fma_f32 v197, v197, s20, -v217
    v_fma_f32 v198, v198, s20, -v217
    v_mfma_f32_16x16x32_bf16 v[80:83], a[160:163], v[208:211], v[80:83]
    ds_read_b128 a[156:159], v233 offset:30720
    v_mfma_f32_16x16x32_bf16 v[128:131], a[160:163], v[212:215], v[128:131]
    buffer_load_dwordx4 v248, s[12:15], s32 offen offset:1024 lds
    v_mfma_f32_16x16x32_bf16 v[36:39], a[164:167], v[204:207], v[36:39]
    v_max3_f32 v251, v251, v197, v198
    v_fma_f32 v199, v199, s20, -v217
    v_mfma_f32_16x16x32_bf16 v[84:87], a[164:167], v[208:211], v[84:87]
    v_fma_f32 v200, v200, s20, -v218
    v_max3_f32 v251, v251, v199, v200
    v_fma_f32 v201, v201, s20, -v218
    v_mfma_f32_16x16x32_bf16 v[132:135], a[164:167], v[212:215], v[132:135]
    ds_read_b128 a[160:163], v232 offset:24704
    v_mfma_f32_16x16x32_bf16 v[40:43], a[168:171], v[204:207], v[40:43]
    v_fma_f32 v202, v202, s20, -v218
    v_max3_f32 v251, v251, v201, v202
    v_mfma_f32_16x16x32_bf16 v[88:91], a[168:171], v[208:211], v[88:91]
    v_fma_f32 v203, v203, s20, -v218
    v_max_f32 v251, v251, v203
    v_cmp_lt_f32 vcc, 0x41000000, v251
    v_mfma_f32_16x16x32_bf16 v[136:139], a[168:171], v[212:215], v[136:139]
    ds_read_b128 a[164:167], v232 offset:30848
    v_mfma_f32_16x16x32_bf16 v[44:47], a[172:175], v[204:207], v[44:47]
    v_mfma_f32_16x16x32_bf16 v[92:95], a[172:175], v[208:211], v[92:95]
    ds_read_b128 a[168:171], v233 offset:24704
    v_mfma_f32_16x16x32_bf16 v[140:143], a[172:175], v[212:215], v[140:143]
    s_cbranch_vccnz L_rare8
L_back8:
    s_waitcnt lgkmcnt(3)
    v_mfma_f32_16x16x32_bf16 v[156:159], a[144:147], a[0:3], 0
    v_exp_f32 v180, v180
    v_exp_f32 v181, v181
    v_mfma_f32_16x16x32_bf16 v[160:163], a[144:147], a[24:27], 0
    ds_read_b128 a[172:175], v233 offset:30848
    v_mfma_f32_16x16x32_bf16 v[164:167], a[144:147], a[48:51], 0
    buffer_load_dwordx4 v249, s[12:15], s32 offen offset:2048 lds
    v_mfma_f32_16x16x32_bf16 v[168:171], a[148:151], a[0:3], 0
    v_exp_f32 v182, v182
    v_exp_f32 v183, v183
    v_mfma_f32_16x16x32_bf16 v[172:175], a[148:151], a[24:27], 0
    v_cvt_pk_bf16_f32 v204, v180, v181
    v_exp_f32 v192, v192
    v_mfma_f32_16x16x32_bf16 v[176:179], a[148:151], a[48:51], 0
    ds_read_b128 a[144:147], v232 offset:24832
    v_mfma_f32_16x16x32_bf16 v[156:159], a[152:155], a[4:7], v[156:159]
    v_exp_f32 v193, v193
    v_cvt_pk_bf16_f32 v205, v182, v183
    v_mfma_f32_16x16x32_bf16 v[160:163], a[152:155], a[28:31], v[160:163]
    v_exp_f32 v194, v194
    v_exp_f32 v195, v195
    v_mfma_f32_16x16x32_bf16 v[164:167], a[152:155], a[52:55], v[164:167]
    v_cvt_pk_bf16_f32 v206, v192, v193
    ds_read_b128 a[148:151], v232 offset:30976
    v_mfma_f32_16x16x32_bf16 v[168:171], a[156:159], a[4:7], v[168:171]
    v_exp_f32 v184, v184
    v_exp_f32 v185, v185
    v_mfma_f32_16x16x32_bf16 v[172:175], a[156:159], a[28:31], v[172:175]
    v_cvt_pk_bf16_f32 v207, v194, v195
    v_exp_f32 v186, v186
    v_mfma_f32_16x16x32_bf16 v[176:179], a[156:159], a[52:55], v[176:179]
    ds_read_b128 a[152:155], v233 offset:24832
    s_waitcnt lgkmcnt(3)
    v_mfma_f32_16x16x32_bf16 v[156:159], a[160:163], a[8:11], v[156:159]
    v_exp_f32 v187, v187
    ds_read_b128 a[156:159], v233 offset:30976
    v_mfma_f32_16x16x32_bf16 v[160:163], a[160:163], a[32:35], v[160:163]
    s_add_u32 m0, s21, 12288
    s_add_u32 s31, s22, 159744
    v_mfma_f32_16x16x32_bf16 v[164:167], a[160:163], a[56:59], v[164:167]
    buffer_load_dwordx4 v244, s[8:11], s31 offen offset:0 nt lds
    buffer_load_dwordx4 a[104:107], v250, s[4:7], s28 offen offset:128 nt
    v_mfma_f32_16x16x32_bf16 v[168:171], a[164:167], a[8:11], v[168:171]
    v_cvt_pk_bf16_f32 v208, v184, v185
    v_exp_f32 v196, v196
    v_mfma_f32_16x16x32_bf16 v[172:175], a[164:167], a[32:35], v[172:175]
    ds_read_b64_tr_b16 a[160:161], v236 offset:12288
    v_mfma_f32_16x16x32_bf16 v[176:179], a[164:167], a[56:59], v[176:179]
    ds_read_b64_tr_b16 a[162:163], v236 offset:18432
    buffer_load_dwordx4 a[108:111], v250, s[4:7], s28 offen offset:192 nt
    v_mfma_f32_16x16x32_bf16 v[156:159], a[168:171], a[12:15], v[156:159]
    v_exp_f32 v197, v197
    v_cvt_pk_bf16_f32 v209, v186, v187
    v_mfma_f32_16x16x32_bf16 v[160:163], a[168:171], a[36:39], v[160:163]
    v_exp_f32 v198, v198
    ds_read_b64_tr_b16 a[164:165], v237 offset:12288
    v_mfma_f32_16x16x32_bf16 v[164:167], a[168:171], a[60:63], v[164:167]
    ds_read_b64_tr_b16 a[166:167], v237 offset:18432
    v_mfma_f32_16x16x32_bf16 v[168:171], a[172:175], a[12:15], v[168:171]
    v_exp_f32 v199, v199
    v_cvt_pk_bf16_f32 v210, v196, v197
    v_mfma_f32_16x16x32_bf16 v[172:175], a[172:175], a[36:39], v[172:175]
    v_exp_f32 v188, v188
    ds_read_b64_tr_b16 a[168:169], v238 offset:12288
    v_mfma_f32_16x16x32_bf16 v[176:179], a[172:175], a[60:63], v[176:179]
    ds_read_b64_tr_b16 a[170:171], v238 offset:18432
    s_waitcnt lgkmcnt(6)
    v_mfma_f32_16x16x32_bf16 v[156:159], a[144:147], a[16:19], v[156:159]
    v_exp_f32 v189, v189
    v_cvt_pk_bf16_f32 v211, v198, v199
    v_mfma_f32_16x16x32_bf16 v[160:163], a[144:147], a[40:43], v[160:163]
    ds_read_b64_tr_b16 a[172:173], v239 offset:12288
    ds_read_b64_tr_b16 a[174:175], v239 offset:18432
    v_mfma_f32_16x16x32_bf16 v[164:167], a[144:147], a[64:67], v[164:167]
    buffer_load_dwordx4 v245, s[8:11], s31 offen offset:1024 nt lds
    v_mfma_f32_16x16x32_bf16 v[168:171], a[148:151], a[16:19], v[168:171]
    v_exp_f32 v190, v190
    v_exp_f32 v191, v191
    v_mfma_f32_16x16x32_bf16 v[172:175], a[148:151], a[40:43], v[172:175]
    v_cvt_pk_bf16_f32 v212, v188, v189
    ds_read_b64_tr_b16 a[144:145], v236 offset:12416
    v_mfma_f32_16x16x32_bf16 v[176:179], a[148:151], a[64:67], v[176:179]
    ds_read_b64_tr_b16 a[146:147], v236 offset:18560
    v_mfma_f32_16x16x32_bf16 v[156:159], a[152:155], a[20:23], v[156:159]
    v_exp_f32 v200, v200
    v_exp_f32 v201, v201
    v_mfma_f32_16x16x32_bf16 v[160:163], a[152:155], a[44:47], v[160:163]
    v_cvt_pk_bf16_f32 v213, v190, v191
    ds_read_b64_tr_b16 a[148:149], v237 offset:12416
    v_mfma_f32_16x16x32_bf16 v[164:167], a[152:155], a[68:71], v[164:167]
    ds_read_b64_tr_b16 a[150:151], v237 offset:18560
    v_mfma_f32_16x16x32_bf16 v[168:171], a[156:159], a[20:23], v[168:171]
    v_exp_f32 v202, v202
    v_exp_f32 v203, v203
    v_mfma_f32_16x16x32_bf16 v[172:175], a[156:159], a[44:47], v[172:175]
    v_cvt_pk_bf16_f32 v214, v200, v201
    ds_read_b64_tr_b16 a[152:153], v238 offset:12416
    v_mfma_f32_16x16x32_bf16 v[176:179], a[156:159], a[68:71], v[176:179]
    ds_read_b64_tr_b16 a[154:155], v238 offset:18560
    v_cvt_pk_bf16_f32 v215, v202, v203
    s_nop 0
    v_mfma_f32_16x16x32_bf16 v[144:147], a[176:179], v[204:207], v[144:147]
    v_fma_f32 v156, v156, s20, -v216
    v_fma_f32 v157, v157, s20, -v216
    v_mfma_f32_16x16x32_bf16 v[148:151], a[176:179], v[208:211], v[148:151]
    v_fma_f32 v158, v158, s20, -v216
    v_max3_f32 v251, v156, v157, v158
    v_mfma_f32_16x16x32_bf16 v[152:155], a[176:179], v[212:215], v[152:155]
    v_fma_f32 v159, v159, s20, -v216
    v_fma_f32 v160, v160, s20, -v217
    s_waitcnt lgkmcnt(6)
    v_mfma_f32_16x16x32_bf16 v[0:3], a[160:163], v[204:207], v[0:3]
    ds_read_b64_tr_b16 a[156:157], v239 offset:12416
    v_mfma_f32_16x16x32_bf16 v[48:51], a[160:163], v[208:211], v[48:51]
    ds_read_b64_tr_b16 a[158:159], v239 offset:18560
    v_mfma_f32_16x16x32_bf16 v[96:99], a[160:163], v[212:215], v[96:99]
    buffer_load_dwordx4 v246, s[8:11], s31 offen offset:2048 nt lds
    v_mfma_f32_16x16x32_bf16 v[4:7], a[164:167], v[204:207], v[4:7]
    v_max3_f32 v251, v251, v159, v160
    v_fma_f32 v161, v161, s20, -v217
    v_mfma_f32_16x16x32_bf16 v[52:55], a[164:167], v[208:211], v[52:55]
    v_fma_f32 v162, v162, s20, -v217
    ds_read_b64_tr_b16 a[160:161], v236 offset:12544
    v_mfma_f32_16x16x32_bf16 v[100:103], a[164:167], v[212:215], v[100:103]
    ds_read_b64_tr_b16 a[162:163], v236 offset:18688
    v_mfma_f32_16x16x32_bf16 v[8:11], a[168:171], v[204:207], v[8:11]
    v_max3_f32 v251, v251, v161, v162
    v_fma_f32 v163, v163, s20, -v217
    v_mfma_f32_16x16x32_bf16 v[56:59], a[168:171], v[208:211], v[56:59]
    v_fma_f32 v164, v164, s20, -v218
    ds_read_b64_tr_b16 a[164:165], v237 offset:12544
    v_mfma_f32_16x16x32_bf16 v[104:107], a[168:171], v[212:215], v[104:107]
    ds_read_b64_tr_b16 a[166:167], v237 offset:18688
    v_mfma_f32_16x16x32_bf16 v[12:15], a[172:175], v[204:207], v[12:15]
    ds_read_b64_tr_b16 a[168:169], v238 offset:12544
    v_mfma_f32_16x16x32_bf16 v[60:63], a[172:175], v[208:211], v[60:63]
    v_mfma_f32_16x16x32_bf16 v[108:111], a[172:175], v[212:215], v[108:111]
    ds_read_b64_tr_b16 a[170:171], v238 offset:18688
    s_waitcnt vmcnt(13)
    s_barrier
    s_waitcnt lgkmcnt(6)
    v_mfma_f32_16x16x32_bf16 v[16:19], a[144:147], v[204:207], v[16:19]
    ds_read_b64_tr_b16 a[172:173], v239 offset:12544
    ds_read_b64_tr_b16 a[174:175], v239 offset:18688
    v_mfma_f32_16x16x32_bf16 v[64:67], a[144:147], v[208:211], v[64:67]
    s_add_u32 m0, s21, 49152
    s_add_u32 s32, s22, 147456
    v_mfma_f32_16x16x32_bf16 v[112:115], a[144:147], v[212:215], v[112:115]
    buffer_load_dwordx4 v247, s[12:15], s32 offen offset:0 lds
    v_mfma_f32_16x16x32_bf16 v[20:23], a[148:151], v[204:207], v[20:23]
    v_max3_f32 v251, v251, v163, v164
    v_fma_f32 v165, v165, s20, -v218
    v_mfma_f32_16x16x32_bf16 v[68:71], a[148:151], v[208:211], v[68:71]
    v_fma_f32 v166, v166, s20, -v218
    v_max3_f32 v251, v251, v165, v166
    v_mfma_f32_16x16x32_bf16 v[116:119], a[148:151], v[212:215], v[116:119]
    ds_read_b128 a[144:147], v232 offset:36864
    v_mfma_f32_16x16x32_bf16 v[24:27], a[152:155], v[204:207], v[24:27]
    v_fma_f32 v167, v167, s20, -v218
    v_fma_f32 v168, v168, s20, -v216
    v_mfma_f32_16x16x32_bf16 v[72:75], a[152:155], v[208:211], v[72:75]
    v_max3_f32 v251, v251, v167, v168
    v_fma_f32 v169, v169, s20, -v216
    v_fma_f32 v170, v170, s20, -v216
    v_mfma_f32_16x16x32_bf16 v[120:123], a[152:155], v[212:215], v[120:123]
    ds_read_b128 a[148:151], v232 offset:43008
    v_mfma_f32_16x16x32_bf16 v[28:31], a[156:159], v[204:207], v[28:31]
    v_max3_f32 v251, v251, v169, v170
    v_fma_f32 v171, v171, s20, -v216
    v_mfma_f32_16x16x32_bf16 v[76:79], a[156:159], v[208:211], v[76:79]
    v_fma_f32 v172, v172, s20, -v217
    v_max3_f32 v251, v251, v171, v172
    v_mfma_f32_16x16x32_bf16 v[124:127], a[156:159], v[212:215], v[124:127]
    ds_read_b128 a[152:155], v233 offset:36864
    s_waitcnt lgkmcnt(3)
    v_mfma_f32_16x16x32_bf16 v[32:35], a[160:163], v[204:207], v[32:35]
    v_fma_f32 v173, v173, s20, -v217
    v_fma_f32 v174, v174, s20, -v217
    v_mfma_f32_16x16x32_bf16 v[80:83], a[160:163], v[208:211], v[80:83]
    ds_read_b128 a[156:159], v233 offset:43008
    v_mfma_f32_16x16x32_bf16 v[128:131], a[160:163], v[212:215], v[128:131]
    buffer_load_dwordx4 v248, s[12:15], s32 offen offset:1024 lds
    v_mfma_f32_16x16x32_bf16 v[36:39], a[164:167], v[204:207], v[36:39]
    v_max3_f32 v251, v251, v173, v174
    v_fma_f32 v175, v175, s20, -v217
    v_mfma_f32_16x16x32_bf16 v[84:87], a[164:167], v[208:211], v[84:87]
    v_fma_f32 v176, v176, s20, -v218
    v_max3_f32 v251, v251, v175, v176
    v_fma_f32 v177, v177, s20, -v218
    v_mfma_f32_16x16x32_bf16 v[132:135], a[164:167], v[212:215], v[132:135]
    ds_read_b128 a[160:163], v232 offset:36992
    v_mfma_f32_16x16x32_bf16 v[40:43], a[168:171], v[204:207], v[40:43]
    v_fma_f32 v178, v178, s20, -v218
    v_max3_f32 v251, v251, v177, v178
    v_mfma_f32_16x16x32_bf16 v[88:91], a[168:171], v[208:211], v[88:91]
    v_fma_f32 v179, v179, s20, -v218
    v_max_f32 v251, v251, v179
    v_cmp_lt_f32 vcc, 0x41000000, v251
    v_mfma_f32_16x16x32_bf16 v[136:139], a[168:171], v[212:215], v[136:139]
    ds_read_b128 a[164:167], v232 offset:43136
    v_mfma_f32_16x16x32_bf16 v[44:47], a[172:175], v[204:207], v[44:47]
    v_mfma_f32_16x16x32_bf16 v[92:95], a[172:175], v[208:211], v[92:95]
    ds_read_b128 a[168:171], v233 offset:36992
    v_mfma_f32_16x16x32_bf16 v[140:143], a[172:175], v[212:215], v[140:143]
    s_cbranch_vccnz L_rare9
L_back9:
    s_waitcnt lgkmcnt(3)
    v_mfma_f32_16x16x32_bf16 v[180:183], a[144:147], a[0:3], 0
    v_exp_f32 v156, v156
    v_exp_f32 v157, v157
    v_mfma_f32_16x16x32_bf16 v[184:187], a[144:147], a[24:27], 0
    v_exp_f32 v158, v158
    ds_read_b128 a[172:175], v233 offset:43136
    v_mfma_f32_16x16x32_bf16 v[188:191], a[144:147], a[48:51], 0
    buffer_load_dwordx4 v249, s[12:15], s32 offen offset:2048 lds
    v_mfma_f32_16x16x32_bf16 v[192:195], a[148:151], a[0:3], 0
    v_exp_f32 v159, v159
    v_cvt_pk_bf16_f32 v204, v156, v157
    v_mfma_f32_16x16x32_bf16 v[196:199], a[148:151], a[24:27], 0
    v_exp_f32 v168, v168
    v_exp_f32 v169, v169
    v_mfma_f32_16x16x32_bf16 v[200:203], a[148:151], a[48:51], 0
    ds_read_b128 a[144:147], v232 offset:37120
    v_mfma_f32_16x16x32_bf16 v[180:183], a[152:155], a[4:7], v[180:183]
    v_cvt_pk_bf16_f32 v205, v158, v159
    v_exp_f32 v170, v170
    v_mfma_f32_16x16x32_bf16 v[184:187], a[152:155], a[28:31], v[184:187]
    v_exp_f32 v171, v171
    v_cvt_pk_bf16_f32 v206, v168, v169
    v_mfma_f32_16x16x32_bf16 v[188:191], a[152:155], a[52:55], v[188:191]
    v_exp_f32 v160, v160
    ds_read_b128 a[148:151], v232 offset:43264
    v_mfma_f32_16x16x32_bf16 v[192:195], a[156:159], a[4:7], v[192:195]
    v_exp_f32 v161, v161
    v_cvt_pk_bf16_f32 v207, v170, v171
    v_mfma_f32_16x16x32_bf16 v[196:199], a[156:159], a[28:31], v[196:199]
    v_exp_f32 v162, v162
    v_exp_f32 v163, v163
    v_mfma_f32_16x16x32_bf16 v[200:203], a[156:159], a[52:55], v[200:203]
    ds_read_b128 a[152:155], v233 offset:37120
    s_waitcnt lgkmcnt(3)
    v_mfma_f32_16x16x32_bf16 v[180:183], a[160:163], a[8:11], v[180:183]
    v_cvt_pk_bf16_f32 v208, v160, v161
    v_exp_f32 v172, v172
    v_mfma_f32_16x16x32_bf16 v[184:187], a[160:163], a[32:35], v[184:187]
    ds_read_b128 a[156:159], v233 offset:43264
    s_add_u32 m0, s21, 24576
    s_add_u32 s31, s22, 172032
    v_mfma_f32_16x16x32_bf16 v[188:191], a[160:163], a[56:59], v[188:191]
    buffer_load_dwordx4 v244, s[8:11], s31 offen offset:0 nt lds
    buffer_load_dwordx4 a[112:115], v250, s[4:7], s28 offen offset:256 nt
    v_mfma_f32_16x16x32_bf16 v[192:195], a[164:167], a[8:11], v[192:195]
    v_exp_f32 v173, v173
    v_cvt_pk_bf16_f32 v209, v162, v163
    v_mfma_f32_16x16x32_bf16 v[196:199], a[164:167], a[32:35], v[196:199]
    v_exp_f32 v174, v174
    ds_read_b64_tr_b16 a[160:161], v236 offset:24576
    v_mfma_f32_16x16x32_bf16 v[200:203], a[164:167], a[56:59], v[200:203]
    ds_read_b64_tr_b16 a[162:163], v236 offset:30720
    buffer_load_dwordx4 a[116:119], v250, s[4:7], s28 offen offset:320 nt
    v_mfma_f32_16x16x32_bf16 v[180:183], a[168:171], a[12:15], v[180:183]
    v_exp_f32 v175, v175
    v_cvt_pk_bf16_f32 v210, v172, v173
    v_mfma_f32_16x16x32_bf16 v[184:187], a[168:171], a[36:39], v[184:187]
    v_exp_f32 v164, v164
    ds_read_b64_tr_b16 a[164:165], v237 offset:24576
    v_mfma_f32_16x16x32_bf16 v[188:191], a[168:171], a[60:63], v[188:191]
    ds_read_b64_tr_b16 a[166:167], v237 offset:30720
    v_mfma_f32_16x16x32_bf16 v[192:195], a[172:175], a[12:15], v[192:195]
    v_exp_f32 v165, v165
    v_cvt_pk_bf16_f32 v211, v174, v175
    v_mfma_f32_16x16x32_bf16 v[196:199], a[172:175], a[36:39], v[196:199]
    v_exp_f32 v166, v166
    ds_read_b64_tr_b16 a[168:169], v238 offset:24576
    v_mfma_f32_16x16x32_bf16 v[200:203], a[172:175], a[60:63], v[200:203]
    ds_read_b64_tr_b16 a[170:171], v238 offset:30720
    s_waitcnt lgkmcnt(6)
    v_mfma_f32_16x16x32_bf16 v[180:183], a[144:147], a[16:19], v[180:183]
    ds_read_b64_tr_b16 a[172:173], v239 offset:24576
    ds_read_b64_tr_b16 a[174:175], v239 offset:30720
    v_mfma_f32_16x16x32_bf16 v[184:187], a[144:147], a[40:43], v[184:187]
    buffer_load_dwordx4 v245, s[8:11], s31 offen offset:1024 nt lds
    v_mfma_f32_16x16x32_bf16 v[188:191], a[144:147], a[64:67], v[188:191]
    s_add_u32 s33, s25, 4096
    buffer_store_dwordx4 a[220:223], v243, s[16:19], s33 offen offset:0
    v_mfma_f32_16x16x32_bf16 v[192:195], a[148:151], a[16:19], v[192:195]
    v_exp_f32 v167, v167
    ds_read_b64_tr_b16 a[144:145], v236 offset:24704
    v_mfma_f32_16x16x32_bf16 v[196:199], a[148:151], a[40:43], v[196:199]
    ds_read_b64_tr_b16 a[146:147], v236 offset:30848
    s_add_u32 s33, s25, 4096
    v_mfma_f32_16x16x32_bf16 v[200:203], a[148:151], a[64:67], v[200:203]
    buffer_store_dwordx4 a[224:227], v243, s[16:19], s33 offen offset:1024
    v_mfma_f32_16x16x32_bf16 v[180:183], a[152:155], a[20:23], v[180:183]
    v_cvt_pk_bf16_f32 v212, v164, v165
    v_exp_f32 v176, v176
    v_mfma_f32_16x16x32_bf16 v[184:187], a[152:155], a[44:47], v[184:187]
    v_exp_f32 v177, v177
    v_cvt_pk_bf16_f32 v213, v166, v167
    v_mfma_f32_16x16x32_bf16 v[188:191], a[152:155], a[68:71], v[188:191]
    ds_read_b64_tr_b16 a[148:149], v237 offset:24704
    ds_read_b64_tr_b16 a[150:151], v237 offset:30848
    v_mfma_f32_16x16x32_bf16 v[192:195], a[156:159], a[20:23], v[192:195]
    v_exp_f32 v178, v178
    v_exp_f32 v179, v179
    v_mfma_f32_16x16x32_bf16 v[196:199], a[156:159], a[44:47], v[196:199]
    v_cvt_pk_bf16_f32 v214, v176, v177
    ds_read_b64_tr_b16 a[152:153], v238 offset:24704
    v_mfma_f32_16x16x32_bf16 v[200:203], a[156:159], a[68:71], v[200:203]
    ds_read_b64_tr_b16 a[154:155], v238 offset:30848
    v_cvt_pk_bf16_f32 v215, v178, v179
    s_nop 0
    v_mfma_f32_16x16x32_bf16 v[144:147], a[176:179], v[204:207], v[144:147]
    v_fma_f32 v180, v180, s20, -v216
    v_fma_f32 v181, v181, s20, -v216
    v_mfma_f32_16x16x32_bf16 v[148:151], a[176:179], v[208:211], v[148:151]
    v_fma_f32 v182, v182, s20, -v216
    v_max3_f32 v251, v180, v181, v182
    v_mfma_f32_16x16x32_bf16 v[152:155], a[176:179], v[212:215], v[152:155]
    v_fma_f32 v183, v183, s20, -v216
    v_fma_f32 v184, v184, s20, -v217
    s_waitcnt lgkmcnt(6)
    v_mfma_f32_16x16x32_bf16 v[0:3], a[160:163], v[204:207], v[0:3]
    ds_read_b64_tr_b16 a[156:157], v239 offset:24704
    v_mfma_f32_16x16x32_bf16 v[48:51], a[160:163], v[208:211], v[48:51]
    ds_read_b64_tr_b16 a[158:159], v239 offset:30848
    v_mfma_f32_16x16x32_bf16 v[96:99], a[160:163], v[212:215], v[96:99]
    buffer_load_dwordx4 v246, s[8:11], s31 offen offset:2048 nt lds
    v_mfma_f32_16x16x32_bf16 v[4:7], a[164:167], v[204:207], v[4:7]
    v_max3_f32 v251, v251, v183, v184
    v_fma_f32 v185, v185, s20, -v217
    v_mfma_f32_16x16x32_bf16 v[52:55], a[164:167], v[208:211], v[52:55]
    v_fma_f32 v186, v186, s20, -v217
    ds_read_b64_tr_b16 a[160:161], v236 offset:24832
    v_mfma_f32_16x16x32_bf16 v[100:103], a[164:167], v[212:215], v[100:103]
    ds_read_b64_tr_b16 a[162:163], v236 offset:30976
    v_mfma_f32_16x16x32_bf16 v[8:11], a[168:171], v[204:207], v[8:11]
    v_max3_f32 v251, v251, v185, v186
    v_fma_f32 v187, v187, s20, -v217
    v_mfma_f32_16x16x32_bf16 v[56:59], a[168:171], v[208:211], v[56:59]
    v_fma_f32 v188, v188, s20, -v218
    ds_read_b64_tr_b16 a[164:165], v237 offset:24832
    v_mfma_f32_16x16x32_bf16 v[104:107], a[168:171], v[212:215], v[104:107]
    ds_read_b64_tr_b16 a[166:167], v237 offset:30976
    v_mfma_f32_16x16x32_bf16 v[12:15], a[172:175], v[204:207], v[12:15]
    ds_read_b64_tr_b16 a[168:169], v238 offset:24832
    v_mfma_f32_16x16x32_bf16 v[60:63], a[172:175], v[208:211], v[60:63]
    v_mfma_f32_16x16x32_bf16 v[108:111], a[172:175], v[212:215], v[108:111]
    ds_read_b64_tr_b16 a[170:171], v238 offset:30976
    s_waitcnt vmcnt(15)
    s_barrier
    s_waitcnt lgkmcnt(6)
    v_mfma_f32_16x16x32_bf16 v[16:19], a[144:147], v[204:207], v[16:19]
    ds_read_b64_tr_b16 a[172:173], v239 offset:24832
    ds_read_b64_tr_b16 a[174:175], v239 offset:30976
    v_mfma_f32_16x16x32_bf16 v[64:67], a[144:147], v[208:211], v[64:67]
    s_add_u32 m0, s21, 61440
    s_add_u32 s32, s22, 159744
    v_mfma_f32_16x16x32_bf16 v[112:115], a[144:147], v[212:215], v[112:115]
    buffer_load_dwordx4 v247, s[12:15], s32 offen offset:0 lds
    v_mfma_f32_16x16x32_bf16 v[20:23], a[148:151], v[204:207], v[20:23]
    v_max3_f32 v251, v251, v187, v188
    v_fma_f32 v189, v189, s20, -v218
    v_mfma_f32_16x16x32_bf16 v[68:71], a[148:151], v[208:211], v[68:71]
    v_fma_f32 v190, v190, s20, -v218
    v_max3_f32 v251, v251, v189, v190
    v_mfma_f32_16x16x32_bf16 v[116:119], a[148:151], v[212:215], v[116:119]
    ds_read_b128 a[144:147], v232 offset:0
    v_mfma_f32_16x16x32_bf16 v[24:27], a[152:155], v[204:207], v[24:27]
    v_fma_f32 v191, v191, s20, -v218
    v_fma_f32 v192, v192, s20, -v216
    v_mfma_f32_16x16x32_bf16 v[72:75], a[152:155], v[208:211], v[72:75]
    v_max3_f32 v251, v251, v191, v192
    v_fma_f32 v193, v193, s20, -v216
    v_fma_f32 v194, v194, s20, -v216
    v_mfma_f32_16x16x32_bf16 v[120:123], a[152:155], v[212:215], v[120:123]
    ds_read_b128 a[148:151], v232 offset:6144
    v_mfma_f32_16x16x32_bf16 v[28:31], a[156:159], v[204:207], v[28:31]
    v_max3_f32 v251, v251, v193, v194
    v_fma_f32 v195, v195, s20, -v216
    v_mfma_f32_16x16x32_bf16 v[76:79], a[156:159], v[208:211], v[76:79]
    v_fma_f32 v196, v196, s20, -v217
    v_max3_f32 v251, v251, v195, v196
    v_mfma_f32_16x16x32_bf16 v[124:127], a[156:159], v[212:215], v[124:127]
    ds_read_b128 a[152:155], v233 offset:0
    s_waitcnt lgkmcnt(3)
    v_mfma_f32_16x16x32_bf16 v[32:35], a[160:163], v[204:207], v[32:35]
    v_fma_f32 v197, v197, s20, -v217
    v_fma_f32 v198, v198, s20, -v217
    v_mfma_f32_16x16x32_bf16 v[80:83], a[160:163], v[208:211], v[80:83]
    ds_read_b128 a[156:159], v233 offset:6144
    v_mfma_f32_16x16x32_bf16 v[128:131], a[160:163], v[212:215], v[128:131]
    buffer_load_dwordx4 v248, s[12:15], s32 offen offset:1024 lds
    v_mfma_f32_16x16x32_bf16 v[36:39], a[164:167], v[204:207], v[36:39]
    v_max3_f32 v251, v251, v197, v198
    v_fma_f32 v199, v199, s20, -v217
    v_mfma_f32_16x16x32_bf16 v[84:87], a[164:167], v[208:211], v[84:87]
    v_fma_f32 v200, v200, s20, -v218
    v_max3_f32 v251, v251, v199, v200
    v_fma_f32 v201, v201, s20, -v218
    v_mfma_f32_16x16x32_bf16 v[132:135], a[164:167], v[212:215], v[132:135]
    ds_read_b128 a[160:163], v232 offset:128
    v_mfma_f32_16x16x32_bf16 v[40:43], a[168:171], v[204:207], v[40:43]
    v_fma_f32 v202, v202, s20, -v218
    v_max3_f32 v251, v251, v201, v202
    v_mfma_f32_16x16x32_bf16 v[88:91], a[168:171], v[208:211], v[88:91]
    v_fma_f32 v203, v203, s20, -v218
    v_max_f32 v251, v251, v203
    v_cmp_lt_f32 vcc, 0x41000000, v251
    v_mfma_f32_16x16x32_bf16 v[136:139], a[168:171], v[212:215], v[136:139]
    ds_read_b128 a[164:167], v232 offset:6272
    v_mfma_f32_16x16x32_bf16 v[44:47], a[172:175], v[204:207], v[44:47]
    v_mfma_f32_16x16x32_bf16 v[92:95], a[172:175], v[208:211], v[92:95]
    ds_read_b128 a[168:171], v233 offset:128
    v_mfma_f32_16x16x32_bf16 v[140:143], a[172:175], v[212:215], v[140:143]
    s_cbranch_vccnz L_rare10
L_back10:
    s_waitcnt lgkmcnt(3)
    v_mfma_f32_16x16x32_bf16 v[156:159], a[144:147], a[0:3], 0
    v_exp_f32 v180, v180
    v_exp_f32 v181, v181
    v_mfma_f32_16x16x32_bf16 v[160:163], a[144:147], a[24:27], 0
    ds_read_b128 a[172:175], v233 offset:6272
    v_mfma_f32_16x16x32_bf16 v[164:167], a[144:147], a[48:51], 0
    buffer_load_dwordx4 v249, s[12:15], s32 offen offset:2048 lds
    v_mfma_f32_16x16x32_bf16 v[168:171], a[148:151], a[0:3], 0
    v_exp_f32 v182, v182
    v_exp_f32 v183, v183
    v_mfma_f32_16x16x32_bf16 v[172:175], a[148:151], a[24:27], 0
    v_cvt_pk_bf16_f32 v204, v180, v181
    v_exp_f32 v192, v192
    v_mfma_f32_16x16x32_bf16 v[176:179], a[148:151], a[48:51], 0
    ds_read_b128 a[144:147], v232 offset:256
    v_mfma_f32_16x16x32_bf16 v[156:159], a[152:155], a[4:7], v[156:159]
    v_exp_f32 v193, v193
    v_cvt_pk_bf16_f32 v205, v182, v183
    v_mfma_f32_16x16x32_bf16 v[160:163], a[152:155], a[28:31], v[160:163]
    v_exp_f32 v194, v194
    v_exp_f32 v195, v195
    v_mfma_f32_16x16x32_bf16 v[164:167], a[152:155], a[52:55], v[164:167]
    v_cvt_pk_bf16_f32 v206, v192, v193
    ds_read_b128 a[148:151], v232 offset:6400
    v_mfma_f32_16x16x32_bf16 v[168:171], a[156:159], a[4:7], v[168:171]
    v_exp_f32 v184, v184
    v_exp_f32 v185, v185
    v_mfma_f32_16x16x32_bf16 v[172:175], a[156:159], a[28:31], v[172:175]
    v_cvt_pk_bf16_f32 v207, v194, v195
    v_exp_f32 v186, v186
    v_mfma_f32_16x16x32_bf16 v[176:179], a[156:159], a[52:55], v[176:179]
    ds_read_b128 a[152:155], v233 offset:256
    s_waitcnt lgkmcnt(3)
    v_mfma_f32_16x16x32_bf16 v[156:159], a[160:163], a[8:11], v[156:159]
    v_exp_f32 v187, v187
    ds_read_b128 a[156:159], v233 offset:6400
    v_mfma_f32_16x16x32_bf16 v[160:163], a[160:163], a[32:35], v[160:163]
    s_add_u32 m0, s21, 36864
    s_add_u32 s31, s22, 184320
    v_mfma_f32_16x16x32_bf16 v[164:167], a[160:163], a[56:59], v[164:167]
    buffer_load_dwordx4 v244, s[8:11], s31 offen offset:0 nt lds
    buffer_load_dwordx4 a[120:123], v250, s[4:7], s29 offen offset:0 nt
    v_mfma_f32_16x16x32_bf16 v[168:171], a[164:167], a[8:11], v[168:171]
    v_cvt_pk_bf16_f32 v208, v184, v185
    v_exp_f32 v196, v196
    v_mfma_f32_16x16x32_bf16 v[172:175], a[164:167], a[32:35], v[172:175]
    ds_read_b64_tr_b16 a[160:161], v236 offset:36864
    v_mfma_f32_16x16x32_bf16 v[176:179], a[164:167], a[56:59], v[176:179]
    ds_read_b64_tr_b16 a[162:163], v236 offset:43008
    buffer_load_dwordx4 a[124:127], v250, s[4:7], s29 offen offset:64 nt
    v_mfma_f32_16x16x32_bf16 v[156:159], a[168:171], a[12:15], v[156:159]
    v_exp_f32 v197, v197
    v_cvt_pk_bf16_f32 v209, v186, v187
    v_mfma_f32_16x16x32_bf16 v[160:163], a[168:171], a[36:39], v[160:163]
    v_exp_f32 v198, v198
    ds_read_b64_tr_b16 a[164:165], v237 offset:36864
    v_mfma_f32_16x16x32_bf16 v[164:167], a[168:171], a[60:63], v[164:167]
    ds_read_b64_tr_b16 a[166:167], v237 offset:43008
    v_mfma_f32_16x16x32_bf16 v[168:171], a[172:175], a[12:15], v[168:171]
    v_exp_f32 v199, v199
    v_cvt_pk_bf16_f32 v210, v196, v197
    v_mfma_f32_16x16x32_bf16 v[172:175], a[172:175], a[36:39], v[172:175]
    v_exp_f32 v188, v188
    ds_read_b64_tr_b16 a[168:169], v238 offset:36864
    v_mfma_f32_16x16x32_bf16 v[176:179], a[172:175], a[60:63], v[176:179]
    ds_read_b64_tr_b16 a[170:171], v238 offset:43008
    s_waitcnt lgkmcnt(6)
    v_mfma_f32_16x16x32_bf16 v[156:159], a[144:147], a[16:19], v[156:159]
    v_exp_f32 v189, v189
    v_cvt_pk_bf16_f32 v211, v198, v199
    v_mfma_f32_16x16x32_bf16 v[160:163], a[144:147], a[40:43], v[160:163]
    ds_read_b64_tr_b16 a[172:173], v239 offset:36864
    ds_read_b64_tr_b16 a[174:175], v239 offset:43008
    v_mfma_f32_16x16x32_bf16 v[164:167], a[144:147], a[64:67], v[164:167]
    buffer_load_dwordx4 v245, s[8:11], s31 offen offset:1024 nt lds
    v_mfma_f32_16x16x32_bf16 v[168:171], a[148:151], a[16:19], v[168:171]
    v_exp_f32 v190, v190
    v_exp_f32 v191, v191
    v_mfma_f32_16x16x32_bf16 v[172:175], a[148:151], a[40:43], v[172:175]
    v_cvt_pk_bf16_f32 v212, v188, v189
    ds_read_b64_tr_b16 a[144:145], v236 offset:36992
    v_mfma_f32_16x16x32_bf16 v[176:179], a[148:151], a[64:67], v[176:179]
    ds_read_b64_tr_b16 a[146:147], v236 offset:43136
    v_mfma_f32_16x16x32_bf16 v[156:159], a[152:155], a[20:23], v[156:159]
    v_exp_f32 v200, v200
    v_exp_f32 v201, v201
    v_mfma_f32_16x16x32_bf16 v[160:163], a[152:155], a[44:47], v[160:163]
    v_cvt_pk_bf16_f32 v213, v190, v191
    ds_read_b64_tr_b16 a[148:149], v237 offset:36992
    v_mfma_f32_16x16x32_bf16 v[164:167], a[152:155], a[68:71], v[164:167]
    ds_read_b64_tr_b16 a[150:151], v237 offset:43136
    v_mfma_f32_16x16x32_bf16 v[168:171], a[156:159], a[20:23], v[168:171]
    v_exp_f32 v202, v202
    v_exp_f32 v203, v203
    v_mfma_f32_16x16x32_bf16 v[172:175], a[156:159], a[44:47], v[172:175]
    v_cvt_pk_bf16_f32 v214, v200, v201
    ds_read_b64_tr_b16 a[152:153], v238 offset:36992
    v_mfma_f32_16x16x32_bf16 v[176:179], a[156:159], a[68:71], v[176:179]
    ds_read_b64_tr_b16 a[154:155], v238 offset:43136
    v_cvt_pk_bf16_f32 v215, v202, v203
    s_nop 0
    v_mfma_f32_16x16x32_bf16 v[144:147], a[176:179], v[204:207], v[144:147]
    v_fma_f32 v156, v156, s20, -v216
    v_fma_f32 v157, v157, s20, -v216
    v_mfma_f32_16x16x32_bf16 v[148:151], a[176:179], v[208:211], v[148:151]
    v_fma_f32 v158, v158, s20, -v216
    v_max3_f32 v251, v156, v157, v158
    v_mfma_f32_16x16x32_bf16 v[152:155], a[176:179], v[212:215], v[152:155]
    v_fma_f32 v159, v159, s20, -v216
    v_fma_f32 v160, v160, s20, -v217
    s_waitcnt lgkmcnt(6)
    v_mfma_f32_16x16x32_bf16 v[0:3], a[160:163], v[204:207], v[0:3]
    ds_read_b64_tr_b16 a[156:157], v239 offset:36992
    v_mfma_f32_16x16x32_bf16 v[48:51], a[160:163], v[208:211], v[48:51]
    ds_read_b64_tr_b16 a[158:159], v239 offset:43136
    v_mfma_f32_16x16x32_bf16 v[96:99], a[160:163], v[212:215], v[96:99]
    buffer_load_dwordx4 v246, s[8:11], s31 offen offset:2048 nt lds
    v_mfma_f32_16x16x32_bf16 v[4:7], a[164:167], v[204:207], v[4:7]
    v_max3_f32 v251, v251, v159, v160
    v_fma_f32 v161, v161, s20, -v217
    v_mfma_f32_16x16x32_bf16 v[52:55], a[164:167], v[208:211], v[52:55]
    v_fma_f32 v162, v162, s20, -v217
    ds_read_b64_tr_b16 a[160:161], v236 offset:37120
    v_mfma_f32_16x16x32_bf16 v[100:103], a[164:167], v[212:215], v[100:103]
    ds_read_b64_tr_b16 a[162:163], v236 offset:43264
    v_mfma_f32_16x16x32_bf16 v[8:11], a[168:171], v[204:207], v[8:11]
    v_max3_f32 v251, v251, v161, v162
    v_fma_f32 v163, v163, s20, -v217
    v_mfma_f32_16x16x32_bf16 v[56:59], a[168:171], v[208:211], v[56:59]
    v_fma_f32 v164, v164, s20, -v218
    ds_read_b64_tr_b16 a[164:165], v237 offset:37120
    v_mfma_f32_16x16x32_bf16 v[104:107], a[168:171], v[212:215], v[104:107]
    ds_read_b64_tr_b16 a[166:167], v237 offset:43264
    v_mfma_f32_16x16x32_bf16 v[12:15], a[172:175], v[204:207], v[12:15]
    ds_read_b64_tr_b16 a[168:169], v238 offset:37120
    v_mfma_f32_16x16x32_bf16 v[60:63], a[172:175], v[208:211], v[60:63]
    v_mfma_f32_16x16x32_bf16 v[108:111], a[172:175], v[212:215], v[108:111]
    ds_read_b64_tr_b16 a[170:171], v238 offset:43264
    s_waitcnt vmcnt(15)
    s_barrier
    s_waitcnt lgkmcnt(6)
    v_mfma_f32_16x16x32_bf16 v[16:19], a[144:147], v[204:207], v[16:19]
    ds_read_b64_tr_b16 a[172:173], v239 offset:37120
    ds_read_b64_tr_b16 a[174:175], v239 offset:43264
    v_mfma_f32_16x16x32_bf16 v[64:67], a[144:147], v[208:211], v[64:67]
    s_add_u32 m0, s21, 73728
    s_add_u32 s32, s22, 172032
    v_mfma_f32_16x16x32_bf16 v[112:115], a[144:147], v[212:215], v[112:115]
    buffer_load_dwordx4 v247, s[12:15], s32 offen offset:0 lds
    v_mfma_f32_16x16x32_bf16 v[20:23], a[148:151], v[204:207], v[20:23]
    v_max3_f32 v251, v251, v163, v164
    v_fma_f32 v165, v165, s20, -v218
    v_mfma_f32_16x16x32_bf16 v[68:71], a[148:151], v[208:211], v[68:71]
    v_fma_f32 v166, v166, s20, -v218
    v_max3_f32 v251, v251, v165, v166
    v_mfma_f32_16x16x32_bf16 v[116:119], a[148:151], v[212:215], v[116:119]
    ds_read_b128 a[144:147], v232 offset:12288
    v_mfma_f32_16x16x32_bf16 v[24:27], a[152:155], v[204:207], v[24:27]
    v_fma_f32 v167, v167, s20, -v218
    v_fma_f32 v168, v168, s20, -v216
    v_mfma_f32_16x16x32_bf16 v[72:75], a[152:155], v[208:211], v[72:75]
    v_max3_f32 v251, v251, v167, v168
    v_fma_f32 v169, v169, s20, -v216
    v_fma_f32 v170, v170, s20, -v216
    v_mfma_f32_16x16x32_bf16 v[120:123], a[152:155], v[212:215], v[120:123]
    ds_read_b128 a[148:151], v232 offset:18432
    v_mfma_f32_16x16x32_bf16 v[28:31], a[156:159], v[204:207], v[28:31]
    v_max3_f32 v251, v251, v169, v170
    v_fma_f32 v171, v171, s20, -v216
    v_mfma_f32_16x16x32_bf16 v[76:79], a[156:159], v[208:211], v[76:79]
    v_fma_f32 v172, v172, s20, -v217
    v_max3_f32 v251, v251, v171, v172
    v_mfma_f32_16x16x32_bf16 v[124:127], a[156:159], v[212:215], v[124:127]
    ds_read_b128 a[152:155], v233 offset:12288
    s_waitcnt lgkmcnt(3)
    v_mfma_f32_16x16x32_bf16 v[32:35], a[160:163], v[204:207], v[32:35]
    v_fma_f32 v173, v173, s20, -v217
    v_fma_f32 v174, v174, s20, -v217
    v_mfma_f32_16x16x32_bf16 v[80:83], a[160:163], v[208:211], v[80:83]
    ds_read_b128 a[156:159], v233 offset:18432
    v_mfma_f32_16x16x32_bf16 v[128:131], a[160:163], v[212:215], v[128:131]
    buffer_load_dwordx4 v248, s[12:15], s32 offen offset:1024 lds
    v_mfma_f32_16x16x32_bf16 v[36:39], a[164:167], v[204:207], v[36:39]
    v_max3_f32 v251, v251, v173, v174
    v_fma_f32 v175, v175, s20, -v217
    v_mfma_f32_16x16x32_bf16 v[84:87], a[164:167], v[208:211], v[84:87]
    v_fma_f32 v176, v176, s20, -v218
    v_max3_f32 v251, v251, v175, v176
    v_fma_f32 v177, v177, s20, -v218
    v_mfma_f32_16x16x32_bf16 v[132:135], a[164:167], v[212:215], v[132:135]
    ds_read_b128 a[160:163], v232 offset:12416
    v_mfma_f32_16x16x32_bf16 v[40:43], a[168:171], v[204:207], v[40:43]
    v_fma_f32 v178, v178, s20, -v218
    v_max3_f32 v251, v251, v177, v178
    v_mfma_f32_16x16x32_bf16 v[88:91], a[168:171], v[208:211], v[88:91]
    v_fma_f32 v179, v179, s20, -v218
    v_max_f32 v251, v251, v179
    v_cmp_lt_f32 vcc, 0x41000000, v251
    v_mfma_f32_16x16x32_bf16 v[136:139], a[168:171], v[212:215], v[136:139]
    ds_read_b128 a[164:167], v232 offset:18560
    v_mfma_f32_16x16x32_bf16 v[44:47], a[172:175], v[204:207], v[44:47]
    v_mfma_f32_16x16x32_bf16 v[92:95], a[172:175], v[208:211], v[92:95]
    ds_read_b128 a[168:171], v233 offset:12416
    v_mfma_f32_16x16x32_bf16 v[140:143], a[172:175], v[212:215], v[140:143]
    s_cbranch_vccnz L_rare11
L_back11:
    s_waitcnt lgkmcnt(3)
    v_mfma_f32_16x16x32_bf16 v[180:183], a[144:147], a[0:3], 0
    v_exp_f32 v156, v156
    v_exp_f32 v157, v157
    v_mfma_f32_16x16x32_bf16 v[184:187], a[144:147], a[24:27], 0
    ds_read_b128 a[172:175], v233 offset:18560
    v_mfma_f32_16x16x32_bf16 v[188:191], a[144:147], a[48:51], 0
    buffer_load_dwordx4 v249, s[12:15], s32 offen offset:2048 lds
    v_mfma_f32_16x16x32_bf16 v[192:195], a[148:151], a[0:3], 0
    v_exp_f32 v158, v158
    v_exp_f32 v159, v159
    v_mfma_f32_16x16x32_bf16 v[196:199], a[148:151], a[24:27], 0
    v_cvt_pk_bf16_f32 v204, v156, v157
    v_exp_f32 v168, v168
    v_mfma_f32_16x16x32_bf16 v[200:203], a[148:151], a[48:51], 0
    v_exp_f32 v169, v169
    ds_read_b128 a[144:147], v232 offset:12544
    v_mfma_f32_16x16x32_bf16 v[180:183], a[152:155], a[4:7], v[180:183]
    v_cvt_pk_bf16_f32 v205, v158, v159
    v_exp_f32 v170, v170
    v_mfma_f32_16x16x32_bf16 v[184:187], a[152:155], a[28:31], v[184:187]
    v_exp_f32 v171, v171
    v_cvt_pk_bf16_f32 v206, v168, v169
    v_mfma_f32_16x16x32_bf16 v[188:191], a[152:155], a[52:55], v[188:191]
    v_exp_f32 v160, v160
    ds_read_b128 a[148:151], v232 offset:18688
    v_mfma_f32_16x16x32_bf16 v[192:195], a[156:159], a[4:7], v[192:195]
    v_exp_f32 v161, v161
    v_cvt_pk_bf16_f32 v207, v170, v171
    v_mfma_f32_16x16x32_bf16 v[196:199], a[156:159], a[28:31], v[196:199]
    v_exp_f32 v162, v162
    v_exp_f32 v163, v163
    v_mfma_f32_16x16x32_bf16 v[200:203], a[156:159], a[52:55], v[200:203]
    ds_read_b128 a[152:155], v233 offset:12544
    s_waitcnt lgkmcnt(3)
    v_mfma_f32_16x16x32_bf16 v[180:183], a[160:163], a[8:11], v[180:183]
    v_cvt_pk_bf16_f32 v208, v160, v161
    ds_read_b128 a[156:159], v233 offset:18688
    v_mfma_f32_16x16x32_bf16 v[184:187], a[160:163], a[32:35], v[184:187]
    s_add_u32 m0, s21, 0
    s_add_u32 s31, s23, 0
    v_mfma_f32_16x16x32_bf16 v[188:191], a[160:163], a[56:59], v[188:191]
    buffer_load_dwordx4 v244, s[8:11], s31 offen offset:0 nt lds
    buffer_load_dwordx4 a[128:131], v250, s[4:7], s29 offen offset:128 nt
    v_mfma_f32_16x16x32_bf16 v[192:195], a[164:167], a[8:11], v[192:195]
    v_exp_f32 v172, v172
    v_exp_f32 v173, v173
    v_mfma_f32_16x16x32_bf16 v[196:199], a[164:167], a[32:35], v[196:199]
    v_cvt_pk_bf16_f32 v209, v162, v163
    ds_read_b64_tr_b16 a[160:161], v236 offset:0
    v_mfma_f32_16x16x32_bf16 v[200:203], a[164:167], a[56:59], v[200:203]
    ds_read_b64_tr_b16 a[162:163], v236 offset:6144
    buffer_load_dwordx4 a[132:135], v250, s[4:7], s29 offen offset:192 nt
    v_mfma_f32_16x16x32_bf16 v[180:183], a[168:171], a[12:15], v[180:183]
    v_exp_f32 v174, v174
    v_exp_f32 v175, v175
    v_mfma_f32_16x16x32_bf16 v[184:187], a[168:171], a[36:39], v[184:187]
    v_cvt_pk_bf16_f32 v210, v172, v173
    v_exp_f32 v164, v164
    v_mfma_f32_16x16x32_bf16 v[188:191], a[168:171], a[60:63], v[188:191]
    ds_read_b64_tr_b16 a[164:165], v237 offset:0
    ds_read_b64_tr_b16 a[166:167], v237 offset:6144
    v_mfma_f32_16x16x32_bf16 v[192:195], a[172:175], a[12:15], v[192:195]
    v_exp_f32 v165, v165
    v_cvt_pk_bf16_f32 v211, v174, v175
    v_mfma_f32_16x16x32_bf16 v[196:199], a[172:175], a[36:39], v[196:199]
    v_exp_f32 v166, v166
    ds_read_b64_tr_b16 a[168:169], v238 offset:0
    v_mfma_f32_16x16x32_bf16 v[200:203], a[172:175], a[60:63], v[200:203]
    ds_read_b64_tr_b16 a[170:171], v238 offset:6144
    s_waitcnt lgkmcnt(6)
    v_mfma_f32_16x16x32_bf16 v[180:183], a[144:147], a[16:19], v[180:183]
    ds_read_b64_tr_b16 a[172:173], v239 offset:0
    ds_read_b64_tr_b16 a[174:175], v239 offset:6144
    v_mfma_f32_16x16x32_bf16 v[184:187], a[144:147], a[40:43], v[184:187]
    buffer_load_dwordx4 v245, s[8:11], s31 offen offset:1024 nt lds
    v_mfma_f32_16x16x32_bf16 v[188:191], a[144:147], a[64:67], v[188:191]
    buffer_store_dwordx4 a[228:231], v243, s[16:19], s26 offen offset:0
    v_mfma_f32_16x16x32_bf16 v[192:195], a[148:151], a[16:19], v[192:195]
    v_exp_f32 v167, v167
    ds_read_b64_tr_b16 a[144:145], v236 offset:128
    v_mfma_f32_16x16x32_bf16 v[196:199], a[148:151], a[40:43], v[196:199]
    ds_read_b64_tr_b16 a[146:147], v236 offset:6272
    v_mfma_f32_16x16x32_bf16 v[200:203], a[148:151], a[64:67], v[200:203]
    buffer_store_dwordx4 a[232:235], v243, s[16:19], s26 offen offset:1024
    v_mfma_f32_16x16x32_bf16 v[180:183], a[152:155], a[20:23], v[180:183]
    v_cvt_pk_bf16_f32 v212, v164, v165
    v_exp_f32 v176, v176
    v_mfma_f32_16x16x32_bf16 v[184:187], a[152:155], a[44:47], v[184:187]
    v_exp_f32 v177, v177
    v_cvt_pk_bf16_f32 v213, v166, v167
    v_mfma_f32_16x16x32_bf16 v[188:191], a[152:155], a[68:71], v[188:191]
    ds_read_b64_tr_b16 a[148:149], v237 offset:128
    ds_read_b64_tr_b16 a[150:151], v237 offset:6272
    v_mfma_f32_16x16x32_bf16 v[192:195], a[156:159], a[20:23], v[192:195]
    v_exp_f32 v178, v178
    v_exp_f32 v179, v179
    v_mfma_f32_16x16x32_bf16 v[196:199], a[156:159], a[44:47], v[196:199]
    v_cvt_pk_bf16_f32 v214, v176, v177
    ds_read_b64_tr_b16 a[152:153], v238 offset:128
    v_mfma_f32_16x16x32_bf16 v[200:203], a[156:159], a[68:71], v[200:203]
    ds_read_b64_tr_b16 a[154:155], v238 offset:6272
    v_cvt_pk_bf16_f32 v215, v178, v179
    s_nop 0
    v_mfma_f32_16x16x32_bf16 v[144:147], a[176:179], v[204:207], v[144:147]
    v_fma_f32 v180, v180, s20, -v216
    v_fma_f32 v181, v181, s20, -v216
    v_mfma_f32_16x16x32_bf16 v[148:151], a[176:179], v[208:211], v[148:151]
    v_fma_f32 v182, v182, s20, -v216
    v_max3_f32 v251, v180, v181, v182
    v_mfma_f32_16x16x32_bf16 v[152:155], a[176:179], v[212:215], v[152:155]
    v_fma_f32 v183, v183, s20, -v216
    v_fma_f32 v184, v184, s20, -v217
    s_waitcnt lgkmcnt(6)
    v_mfma_f32_16x16x32_bf16 v[0:3], a[160:163], v[204:207], v[0:3]
    ds_read_b64_tr_b16 a[156:157], v239 offset:128
    v_mfma_f32_16x16x32_bf16 v[48:51], a[160:163], v[208:211], v[48:51]
    ds_read_b64_tr_b16 a[158:159], v239 offset:6272
    v_mfma_f32_16x16x32_bf16 v[96:99], a[160:163], v[212:215], v[96:99]
    buffer_load_dwordx4 v246, s[8:11], s31 offen offset:2048 nt lds
    v_mfma_f32_16x16x32_bf16 v[4:7], a[164:167], v[204:207], v[4:7]
    v_max3_f32 v251, v251, v183, v184
    v_fma_f32 v185, v185, s20, -v217
    v_mfma_f32_16x16x32_bf16 v[52:55], a[164:167], v[208:211], v[52:55]
    v_fma_f32 v186, v186, s20, -v217
    ds_read_b64_tr_b16 a[160:161], v236 offset:256
    v_mfma_f32_16x16x32_bf16 v[100:103], a[164:167], v[212:215], v[100:103]
    ds_read_b64_tr_b16 a[162:163], v236 offset:6400
    v_mfma_f32_16x16x32_bf16 v[8:11], a[168:171], v[204:207], v[8:11]
    v_max3_f32 v251, v251, v185, v186
    v_fma_f32 v187, v187, s20, -v217
    v_mfma_f32_16x16x32_bf16 v[56:59], a[168:171], v[208:211], v[56:59]
    v_fma_f32 v188, v188, s20, -v218
    ds_read_b64_tr_b16 a[164:165], v237 offset:256
    v_mfma_f32_16x16x32_bf16 v[104:107], a[168:171], v[212:215], v[104:107]
    ds_read_b64_tr_b16 a[166:167], v237 offset:6400
    v_mfma_f32_16x16x32_bf16 v[12:15], a[172:175], v[204:207], v[12:15]
    ds_read_b64_tr_b16 a[168:169], v238 offset:256
    v_mfma_f32_16x16x32_bf16 v[60:63], a[172:175], v[208:211], v[60:63]
    v_mfma_f32_16x16x32_bf16 v[108:111], a[172:175], v[212:215], v[108:111]
    ds_read_b64_tr_b16 a[170:171], v238 offset:6400
    s_waitcnt vmcnt(15)
    s_barrier
    s_waitcnt lgkmcnt(6)
    v_mfma_f32_16x16x32_bf16 v[16:19], a[144:147], v[204:207], v[16:19]
    ds_read_b64_tr_b16 a[172:173], v239 offset:256
    ds_read_b64_tr_b16 a[174:175], v239 offset:6400
    v_mfma_f32_16x16x32_bf16 v[64:67], a[144:147], v[208:211], v[64:67]
    s_add_u32 m0, s21, 86016
    s_add_u32 s32, s22, 184320
    v_mfma_f32_16x16x32_bf16 v[112:115], a[144:147], v[212:215], v[112:115]
    buffer_load_dwordx4 v247, s[12:15], s32 offen offset:0 lds
    v_mfma_f32_16x16x32_bf16 v[20:23], a[148:151], v[204:207], v[20:23]
    v_max3_f32 v251, v251, v187, v188
    v_fma_f32 v189, v189, s20, -v218
    v_mfma_f32_16x16x32_bf16 v[68:71], a[148:151], v[208:211], v[68:71]
    v_fma_f32 v190, v190, s20, -v218
    v_max3_f32 v251, v251, v189, v190
    v_mfma_f32_16x16x32_bf16 v[116:119], a[148:151], v[212:215], v[116:119]
    ds_read_b128 a[144:147], v232 offset:24576
    v_mfma_f32_16x16x32_bf16 v[24:27], a[152:155], v[204:207], v[24:27]
    v_fma_f32 v191, v191, s20, -v218
    v_fma_f32 v192, v192, s20, -v216
    v_mfma_f32_16x16x32_bf16 v[72:75], a[152:155], v[208:211], v[72:75]
    v_max3_f32 v251, v251, v191, v192
    v_fma_f32 v193, v193, s20, -v216
    v_fma_f32 v194, v194, s20, -v216
    v_mfma_f32_16x16x32_bf16 v[120:123], a[152:155], v[212:215], v[120:123]
    ds_read_b128 a[148:151], v232 offset:30720
    v_mfma_f32_16x16x32_bf16 v[28:31], a[156:159], v[204:207], v[28:31]
    v_max3_f32 v251, v251, v193, v194
    v_fma_f32 v195, v195, s20, -v216
    v_mfma_f32_16x16x32_bf16 v[76:79], a[156:159], v[208:211], v[76:79]
    v_fma_f32 v196, v196, s20, -v217
    v_max3_f32 v251, v251, v195, v196
    v_mfma_f32_16x16x32_bf16 v[124:127], a[156:159], v[212:215], v[124:127]
    ds_read_b128 a[152:155], v233 offset:24576
    s_waitcnt lgkmcnt(3)
    v_mfma_f32_16x16x32_bf16 v[32:35], a[160:163], v[204:207], v[32:35]
    v_fma_f32 v197, v197, s20, -v217
    v_fma_f32 v198, v198, s20, -v217
    v_mfma_f32_16x16x32_bf16 v[80:83], a[160:163], v[208:211], v[80:83]
    ds_read_b128 a[156:159], v233 offset:30720
    v_mfma_f32_16x16x32_bf16 v[128:131], a[160:163], v[212:215], v[128:131]
    buffer_load_dwordx4 v248, s[12:15], s32 offen offset:1024 lds
    v_mfma_f32_16x16x32_bf16 v[36:39], a[164:167], v[204:207], v[36:39]
    v_max3_f32 v251, v251, v197, v198
    v_fma_f32 v199, v199, s20, -v217
    v_mfma_f32_16x16x32_bf16 v[84:87], a[164:167], v[208:211], v[84:87]
    v_fma_f32 v200, v200, s20, -v218
    v_max3_f32 v251, v251, v199, v200
    v_fma_f32 v201, v201, s20, -v218
    v_mfma_f32_16x16x32_bf16 v[132:135], a[164:167], v[212:215], v[132:135]
    ds_read_b128 a[160:163], v232 offset:24704
    v_mfma_f32_16x16x32_bf16 v[40:43], a[168:171], v[204:207], v[40:43]
    v_fma_f32 v202, v202, s20, -v218
    v_max3_f32 v251, v251, v201, v202
    v_mfma_f32_16x16x32_bf16 v[88:91], a[168:171], v[208:211], v[88:91]
    v_fma_f32 v203, v203, s20, -v218
    v_max_f32 v251, v251, v203
    v_cmp_lt_f32 vcc, 0x41000000, v251
    v_mfma_f32_16x16x32_bf16 v[136:139], a[168:171], v[212:215], v[136:139]
    ds_read_b128 a[164:167], v232 offset:30848
    v_mfma_f32_16x16x32_bf16 v[44:47], a[172:175], v[204:207], v[44:47]
    v_mfma_f32_16x16x32_bf16 v[92:95], a[172:175], v[208:211], v[92:95]
    ds_read_b128 a[168:171], v233 offset:24704
    v_mfma_f32_16x16x32_bf16 v[140:143], a[172:175], v[212:215], v[140:143]
    s_cbranch_vccnz L_rare12
L_back12:
    s_waitcnt lgkmcnt(3)
    v_mfma_f32_16x16x32_bf16 v[156:159], a[144:147], a[0:3], 0
    v_exp_f32 v180, v180
    v_exp_f32 v181, v181
    v_mfma_f32_16x16x32_bf16 v[160:163], a[144:147], a[24:27], 0
    ds_read_b128 a[172:175], v233 offset:30848
    v_mfma_f32_16x16x32_bf16 v[164:167], a[144:147], a[48:51], 0
    buffer_load_dwordx4 v249, s[12:15], s32 offen offset:2048 lds
    v_mfma_f32_16x16x32_bf16 v[168:171], a[148:151], a[0:3], 0
    v_exp_f32 v182, v182
    v_exp_f32 v183, v183
    v_mfma_f32_16x16x32_bf16 v[172:175], a[148:151], a[24:27], 0
    v_cvt_pk_bf16_f32 v204, v180, v181
    v_exp_f32 v192, v192
    v_mfma_f32_16x16x32_bf16 v[176:179], a[148:151], a[48:51], 0
    ds_read_b128 a[144:147], v232 offset:24832
    v_mfma_f32_16x16x32_bf16 v[156:159], a[152:155], a[4:7], v[156:159]
    v_exp_f32 v193, v193
    v_cvt_pk_bf16_f32 v205, v182, v183
    v_mfma_f32_16x16x32_bf16 v[160:163], a[152:155], a[28:31], v[160:163]
    v_exp_f32 v194, v194
    v_exp_f32 v195, v195
    v_mfma_f32_16x16x32_bf16 v[164:167], a[152:155], a[52:55], v[164:167]
    v_cvt_pk_bf16_f32 v206, v192, v193
    ds_read_b128 a[148:151], v232 offset:30976
    v_mfma_f32_16x16x32_bf16 v[168:171], a[156:159], a[4:7], v[168:171]
    v_exp_f32 v184, v184
    v_exp_f32 v185, v185
    v_mfma_f32_16x16x32_bf16 v[172:175], a[156:159], a[28:31], v[172:175]
    v_cvt_pk_bf16_f32 v207, v194, v195
    v_exp_f32 v186, v186
    v_mfma_f32_16x16x32_bf16 v[176:179], a[156:159], a[52:55], v[176:179]
    ds_read_b128 a[152:155], v233 offset:24832
    s_waitcnt lgkmcnt(3)
    v_mfma_f32_16x16x32_bf16 v[156:159], a[160:163], a[8:11], v[156:159]
    v_exp_f32 v187, v187
    ds_read_b128 a[156:159], v233 offset:30976
    v_mfma_f32_16x16x32_bf16 v[160:163], a[160:163], a[32:35], v[160:163]
    s_add_u32 m0, s21, 12288
    s_add_u32 s31, s23, 12288
    v_mfma_f32_16x16x32_bf16 v[164:167], a[160:163], a[56:59], v[164:167]
    buffer_load_dwordx4 v244, s[8:11], s31 offen offset:0 nt lds
    buffer_load_dwordx4 a[136:139], v250, s[4:7], s29 offen offset:256 nt
    v_mfma_f32_16x16x32_bf16 v[168:171], a[164:167], a[8:11], v[168:171]
    v_cvt_pk_bf16_f32 v208, v184, v185
    v_exp_f32 v196, v196
    v_mfma_f32_16x16x32_bf16 v[172:175], a[164:167], a[32:35], v[172:175]
    ds_read_b64_tr_b16 a[160:161], v236 offset:12288
    v_mfma_f32_16x16x32_bf16 v[176:179], a[164:167], a[56:59], v[176:179]
    ds_read_b64_tr_b16 a[162:163], v236 offset:18432
    buffer_load_dwordx4 a[140:143], v250, s[4:7], s29 offen offset:320 nt
    v_mfma_f32_16x16x32_bf16 v[156:159], a[168:171], a[12:15], v[156:159]
    v_exp_f32 v197, v197
    v_cvt_pk_bf16_f32 v209, v186, v187
    v_mfma_f32_16x16x32_bf16 v[160:163], a[168:171], a[36:39], v[160:163]
    v_exp_f32 v198, v198
    ds_read_b64_tr_b16 a[164:165], v237 offset:12288
    v_mfma_f32_16x16x32_bf16 v[164:167], a[168:171], a[60:63], v[164:167]
    ds_read_b64_tr_b16 a[166:167], v237 offset:18432
    v_mfma_f32_16x16x32_bf16 v[168:171], a[172:175], a[12:15], v[168:171]
    v_exp_f32 v199, v199
    v_cvt_pk_bf16_f32 v210, v196, v197
    v_mfma_f32_16x16x32_bf16 v[172:175], a[172:175], a[36:39], v[172:175]
    v_exp_f32 v188, v188
    ds_read_b64_tr_b16 a[168:169], v238 offset:12288
    v_mfma_f32_16x16x32_bf16 v[176:179], a[172:175], a[60:63], v[176:179]
    ds_read_b64_tr_b16 a[170:171], v238 offset:18432
    s_waitcnt lgkmcnt(6)
    v_mfma_f32_16x16x32_bf16 v[156:159], a[144:147], a[16:19], v[156:159]
    v_exp_f32 v189, v189
    v_cvt_pk_bf16_f32 v211, v198, v199
    v_mfma_f32_16x16x32_bf16 v[160:163], a[144:147], a[40:43], v[160:163]
    ds_read_b64_tr_b16 a[172:173], v239 offset:12288
    ds_read_b64_tr_b16 a[174:175], v239 offset:18432
    v_mfma_f32_16x16x32_bf16 v[164:167], a[144:147], a[64:67], v[164:167]
    buffer_load_dwordx4 v245, s[8:11], s31 offen offset:1024 nt lds
    v_mfma_f32_16x16x32_bf16 v[168:171], a[148:151], a[16:19], v[168:171]
    v_exp_f32 v190, v190
    v_exp_f32 v191, v191
    v_mfma_f32_16x16x32_bf16 v[172:175], a[148:151], a[40:43], v[172:175]
    v_cvt_pk_bf16_f32 v212, v188, v189
    ds_read_b64_tr_b16 a[144:145], v236 offset:12416
    v_mfma_f32_16x16x32_bf16 v[176:179], a[148:151], a[64:67], v[176:179]
    ds_read_b64_tr_b16 a[146:147], v236 offset:18560
    v_mfma_f32_16x16x32_bf16 v[156:159], a[152:155], a[20:23], v[156:159]
    v_exp_f32 v200, v200
    v_exp_f32 v201, v201
    v_mfma_f32_16x16x32_bf16 v[160:163], a[152:155], a[44:47], v[160:163]
    v_cvt_pk_bf16_f32 v213, v190, v191
    ds_read_b64_tr_b16 a[148:149], v237 offset:12416
    v_mfma_f32_16x16x32_bf16 v[164:167], a[152:155], a[68:71], v[164:167]
    ds_read_b64_tr_b16 a[150:151], v237 offset:18560
    v_mfma_f32_16x16x32_bf16 v[168:171], a[156:159], a[20:23], v[168:171]
    v_exp_f32 v202, v202
    v_exp_f32 v203, v203
    v_mfma_f32_16x16x32_bf16 v[172:175], a[156:159], a[44:47], v[172:175]
    v_cvt_pk_bf16_f32 v214, v200, v201
    ds_read_b64_tr_b16 a[152:153], v238 offset:12416
    v_mfma_f32_16x16x32_bf16 v[176:179], a[156:159], a[68:71], v[176:179]
    ds_read_b64_tr_b16 a[154:155], v238 offset:18560
    v_cvt_pk_bf16_f32 v215, v202, v203
    s_nop 0
    v_mfma_f32_16x16x32_bf16 v[144:147], a[176:179], v[204:207], v[144:147]
    v_fma_f32 v156, v156, s20, -v216
    v_fma_f32 v157, v157, s20, -v216
    v_mfma_f32_16x16x32_bf16 v[148:151], a[176:179], v[208:211], v[148:151]
    v_fma_f32 v158, v158, s20, -v216
    v_max3_f32 v251, v156, v157, v158
    v_mfma_f32_16x16x32_bf16 v[152:155], a[176:179], v[212:215], v[152:155]
    v_fma_f32 v159, v159, s20, -v216
    v_fma_f32 v160, v160, s20, -v217
    s_waitcnt lgkmcnt(6)
    v_mfma_f32_16x16x32_bf16 v[0:3], a[160:163], v[204:207], v[0:3]
    ds_read_b64_tr_b16 a[156:157], v239 offset:12416
    v_mfma_f32_16x16x32_bf16 v[48:51], a[160:163], v[208:211], v[48:51]
    ds_read_b64_tr_b16 a[158:159], v239 offset:18560
    v_mfma_f32_16x16x32_bf16 v[96:99], a[160:163], v[212:215], v[96:99]
    buffer_load_dwordx4 v246, s[8:11], s31 offen offset:2048 nt lds
    v_mfma_f32_16x16x32_bf16 v[4:7], a[164:167], v[204:207], v[4:7]
    v_max3_f32 v251, v251, v159, v160
    v_fma_f32 v161, v161, s20, -v217
    v_mfma_f32_16x16x32_bf16 v[52:55], a[164:167], v[208:211], v[52:55]
    v_fma_f32 v162, v162, s20, -v217
    ds_read_b64_tr_b16 a[160:161], v236 offset:12544
    v_mfma_f32_16x16x32_bf16 v[100:103], a[164:167], v[212:215], v[100:103]
    ds_read_b64_tr_b16 a[162:163], v236 offset:18688
    v_mfma_f32_16x16x32_bf16 v[8:11], a[168:171], v[204:207], v[8:11]
    v_max3_f32 v251, v251, v161, v162
    v_fma_f32 v163, v163, s20, -v217
    v_mfma_f32_16x16x32_bf16 v[56:59], a[168:171], v[208:211], v[56:59]
    v_fma_f32 v164, v164, s20, -v218
    ds_read_b64_tr_b16 a[164:165], v237 offset:12544
    v_mfma_f32_16x16x32_bf16 v[104:107], a[168:171], v[212:215], v[104:107]
    ds_read_b64_tr_b16 a[166:167], v237 offset:18688
    v_mfma_f32_16x16x32_bf16 v[12:15], a[172:175], v[204:207], v[12:15]
    ds_read_b64_tr_b16 a[168:169], v238 offset:12544
    v_mfma_f32_16x16x32_bf16 v[60:63], a[172:175], v[208:211], v[60:63]
    v_mfma_f32_16x16x32_bf16 v[108:111], a[172:175], v[212:215], v[108:111]
    ds_read_b64_tr_b16 a[170:171], v238 offset:18688
    s_waitcnt vmcnt(15)
    s_barrier
    s_waitcnt lgkmcnt(6)
    v_mfma_f32_16x16x32_bf16 v[16:19], a[144:147], v[204:207], v[16:19]
    ds_read_b64_tr_b16 a[172:173], v239 offset:12544
    ds_read_b64_tr_b16 a[174:175], v239 offset:18688
    v_mfma_f32_16x16x32_bf16 v[64:67], a[144:147], v[208:211], v[64:67]
    s_add_u32 m0, s21, 49152
    s_add_u32 s32, s23, 0
    v_mfma_f32_16x16x32_bf16 v[112:115], a[144:147], v[212:215], v[112:115]
    buffer_load_dwordx4 v247, s[12:15], s32 offen offset:0 lds
    v_mfma_f32_16x16x32_bf16 v[20:23], a[148:151], v[204:207], v[20:23]
    v_max3_f32 v251, v251, v163, v164
    v_fma_f32 v165, v165, s20, -v218
    v_mfma_f32_16x16x32_bf16 v[68:71], a[148:151], v[208:211], v[68:71]
    v_fma_f32 v166, v166, s20, -v218
    v_max3_f32 v251, v251, v165, v166
    v_mfma_f32_16x16x32_bf16 v[116:119], a[148:151], v[212:215], v[116:119]
    ds_read_b128 a[144:147], v232 offset:36864
    v_mfma_f32_16x16x32_bf16 v[24:27], a[152:155], v[204:207], v[24:27]
    v_fma_f32 v167, v167, s20, -v218
    v_fma_f32 v168, v168, s20, -v216
    v_mfma_f32_16x16x32_bf16 v[72:75], a[152:155], v[208:211], v[72:75]
    v_max3_f32 v251, v251, v167, v168
    v_fma_f32 v169, v169, s20, -v216
    v_fma_f32 v170, v170, s20, -v216
    v_mfma_f32_16x16x32_bf16 v[120:123], a[152:155], v[212:215], v[120:123]
    ds_read_b128 a[148:151], v232 offset:43008
    v_mfma_f32_16x16x32_bf16 v[28:31], a[156:159], v[204:207], v[28:31]
    v_max3_f32 v251, v251, v169, v170
    v_fma_f32 v171, v171, s20, -v216
    v_mfma_f32_16x16x32_bf16 v[76:79], a[156:159], v[208:211], v[76:79]
    v_fma_f32 v172, v172, s20, -v217
    v_max3_f32 v251, v251, v171, v172
    v_mfma_f32_16x16x32_bf16 v[124:127], a[156:159], v[212:215], v[124:127]
    ds_read_b128 a[152:155], v233 offset:36864
    s_waitcnt lgkmcnt(3)
    v_mfma_f32_16x16x32_bf16 v[32:35], a[160:163], v[204:207], v[32:35]
    v_fma_f32 v173, v173, s20, -v217
    v_fma_f32 v174, v174, s20, -v217
    v_mfma_f32_16x16x32_bf16 v[80:83], a[160:163], v[208:211], v[80:83]
    ds_read_b128 a[156:159], v233 offset:43008
    v_mfma_f32_16x16x32_bf16 v[128:131], a[160:163], v[212:215], v[128:131]
    buffer_load_dwordx4 v248, s[12:15], s32 offen offset:1024 lds
    v_mfma_f32_16x16x32_bf16 v[36:39], a[164:167], v[204:207], v[36:39]
    v_max3_f32 v251, v251, v173, v174
    v_fma_f32 v175, v175, s20, -v217
    v_mfma_f32_16x16x32_bf16 v[84:87], a[164:167], v[208:211], v[84:87]
    v_fma_f32 v176, v176, s20, -v218
    v_max3_f32 v251, v251, v175, v176
    v_fma_f32 v177, v177, s20, -v218
    v_mfma_f32_16x16x32_bf16 v[132:135], a[164:167], v[212:215], v[132:135]
    ds_read_b128 a[160:163], v232 offset:36992
    v_mfma_f32_16x16x32_bf16 v[40:43], a[168:171], v[204:207], v[40:43]
    v_fma_f32 v178, v178, s20, -v218
    v_max3_f32 v251, v251, v177, v178
    v_mfma_f32_16x16x32_bf16 v[88:91], a[168:171], v[208:211], v[88:91]
    v_fma_f32 v179, v179, s20, -v218
    v_max_f32 v251, v251, v179
    v_cmp_lt_f32 vcc, 0x41000000, v251
    v_mfma_f32_16x16x32_bf16 v[136:139], a[168:171], v[212:215], v[136:139]
    ds_read_b128 a[164:167], v232 offset:43136
    v_mfma_f32_16x16x32_bf16 v[44:47], a[172:175], v[204:207], v[44:47]
    v_mfma_f32_16x16x32_bf16 v[92:95], a[172:175], v[208:211], v[92:95]
    ds_read_b128 a[168:171], v233 offset:36992
    v_mfma_f32_16x16x32_bf16 v[140:143], a[172:175], v[212:215], v[140:143]
    s_cbranch_vccnz L_rare13
L_back13:
    s_waitcnt lgkmcnt(3)
    v_mfma_f32_16x16x32_bf16 v[180:183], a[144:147], a[0:3], 0
    v_exp_f32 v156, v156
    v_exp_f32 v157, v157
    v_mfma_f32_16x16x32_bf16 v[184:187], a[144:147], a[24:27], 0
    ds_read_b128 a[172:175], v233 offset:43136
    v_mfma_f32_16x16x32_bf16 v[188:191], a[144:147], a[48:51], 0
    buffer_load_dwordx4 v249, s[12:15], s32 offen offset:2048 lds
    v_mfma_f32_16x16x32_bf16 v[192:195], a[148:151], a[0:3], 0
    v_exp_f32 v158, v158
    v_exp_f32 v159, v159
    v_mfma_f32_16x16x32_bf16 v[196:199], a[148:151], a[24:27], 0
    v_cvt_pk_bf16_f32 v204, v156, v157
    v_exp_f32 v168, v168
    v_mfma_f32_16x16x32_bf16 v[200:203], a[148:151], a[48:51], 0
    v_exp_f32 v169, v169
    ds_read_b128 a[144:147], v232 offset:37120
    v_mfma_f32_16x16x32_bf16 v[180:183], a[152:155], a[4:7], v[180:183]
    v_cvt_pk_bf16_f32 v205, v158, v159
    v_exp_f32 v170, v170
    v_mfma_f32_16x16x32_bf16 v[184:187], a[152:155], a[28:31], v[184:187]
    v_exp_f32 v171, v171
    v_cvt_pk_bf16_f32 v206, v168, v169
    v_mfma_f32_16x16x32_bf16 v[188:191], a[152:155], a[52:55], v[188:191]
    v_exp_f32 v160, v160
    ds_read_b128 a[148:151], v232 offset:43264
    v_mfma_f32_16x16x32_bf16 v[192:195], a[156:159], a[4:7], v[192:195]
    v_exp_f32 v161, v161
    v_cvt_pk_bf16_f32 v207, v170, v171
    v_mfma_f32_16x16x32_bf16 v[196:199], a[156:159], a[28:31], v[196:199]
    v_exp_f32 v162, v162
    v_exp_f32 v163, v163
    v_mfma_f32_16x16x32_bf16 v[200:203], a[156:159], a[52:55], v[200:203]
    ds_read_b128 a[152:155], v233 offset:37120
    s_waitcnt lgkmcnt(3)
    v_mfma_f32_16x16x32_bf16 v[180:183], a[160:163], a[8:11], v[180:183]
    v_cvt_pk_bf16_f32 v208, v160, v161
    ds_read_b128 a[156:159], v233 offset:43264
    v_mfma_f32_16x16x32_bf16 v[184:187], a[160:163], a[32:35], v[184:187]
    s_add_u32 m0, s21, 24576
    s_add_u32 s31, s23, 24576
    v_mfma_f32_16x16x32_bf16 v[188:191], a[160:163], a[56:59], v[188:191]
    buffer_load_dwordx4 v244, s[8:11], s31 offen offset:0 nt lds
    v_mfma_f32_16x16x32_bf16 v[192:195], a[164:167], a[8:11], v[192:195]
    v_exp_f32 v172, v172
    v_exp_f32 v173, v173
    v_mfma_f32_16x16x32_bf16 v[196:199], a[164:167], a[32:35], v[196:199]
    v_cvt_pk_bf16_f32 v209, v162, v163
    v_exp_f32 v174, v174
    v_mfma_f32_16x16x32_bf16 v[200:203], a[164:167], a[56:59], v[200:203]
    ds_read_b64_tr_b16 a[160:161], v236 offset:24576
    ds_read_b64_tr_b16 a[162:163], v236 offset:30720
    v_mfma_f32_16x16x32_bf16 v[180:183], a[168:171], a[12:15], v[180:183]
    v_exp_f32 v175, v175
    v_cvt_pk_bf16_f32 v210, v172, v173
    v_mfma_f32_16x16x32_bf16 v[184:187], a[168:171], a[36:39], v[184:187]
    v_exp_f32 v164, v164
    ds_read_b64_tr_b16 a[164:165], v237 offset:24576
    v_mfma_f32_16x16x32_bf16 v[188:191], a[168:171], a[60:63], v[188:191]
    ds_read_b64_tr_b16 a[166:167], v237 offset:30720
    v_mfma_f32_16x16x32_bf16 v[192:195], a[172:175], a[12:15], v[192:195]
    v_exp_f32 v165, v165
    v_cvt_pk_bf16_f32 v211, v174, v175
    v_mfma_f32_16x16x32_bf16 v[196:199], a[172:175], a[36:39], v[196:199]
    v_exp_f32 v166, v166
    ds_read_b64_tr_b16 a[168:169], v238 offset:24576
    v_mfma_f32_16x16x32_bf16 v[200:203], a[172:175], a[60:63], v[200:203]
    ds_read_b64_tr_b16 a[170:171], v238 offset:30720
    s_waitcnt lgkmcnt(6)
    v_mfma_f32_16x16x32_bf16 v[180:183], a[144:147], a[16:19], v[180:183]
    ds_read_b64_tr_b16 a[172:173], v239 offset:24576
    ds_read_b64_tr_b16 a[174:175], v239 offset:30720
    v_mfma_f32_16x16x32_bf16 v[184:187], a[144:147], a[40:43], v[184:187]
    buffer_load_dwordx4 v245, s[8:11], s31 offen offset:1024 nt lds
    v_mfma_f32_16x16x32_bf16 v[188:191], a[144:147], a[64:67], v[188:191]
    buffer_store_dwordx4 a[236:239], v243, s[16:19], s26 offen offset:2048
    v_mfma_f32_16x16x32_bf16 v[192:195], a[148:151], a[16:19], v[192:195]
    v_exp_f32 v167, v167
    v_cvt_pk_bf16_f32 v212, v164, v165
    v_mfma_f32_16x16x32_bf16 v[196:199], a[148:151], a[40:43], v[196:199]
    ds_read_b64_tr_b16 a[144:145], v236 offset:24704
    ds_read_b64_tr_b16 a[146:147], v236 offset:30848
    v_mfma_f32_16x16x32_bf16 v[200:203], a[148:151], a[64:67], v[200:203]
    buffer_store_dwordx4 a[240:243], v243, s[16:19], s26 offen offset:3072
    v_mfma_f32_16x16x32_bf16 v[180:183], a[152:155], a[20:23], v[180:183]
    v_exp_f32 v176, v176
    v_exp_f32 v177, v177
    v_mfma_f32_16x16x32_bf16 v[184:187], a[152:155], a[44:47], v[184:187]
    v_cvt_pk_bf16_f32 v213, v166, v167
    ds_read_b64_tr_b16 a[148:149], v237 offset:24704
    v_mfma_f32_16x16x32_bf16 v[188:191], a[152:155], a[68:71], v[188:191]
    ds_read_b64_tr_b16 a[150:151], v237 offset:30848
    v_mfma_f32_16x16x32_bf16 v[192:195], a[156:159], a[20:23], v[192:195]
    v_exp_f32 v178, v178
    v_exp_f32 v179, v179
    v_mfma_f32_16x16x32_bf16 v[196:199], a[156:159], a[44:47], v[196:199]
    v_cvt_pk_bf16_f32 v214, v176, v177
    ds_read_b64_tr_b16 a[152:153], v238 offset:24704
    v_mfma_f32_16x16x32_bf16 v[200:203], a[156:159], a[68:71], v[200:203]
    ds_read_b64_tr_b16 a[154:155], v238 offset:30848
    v_cvt_pk_bf16_f32 v215, v178, v179
    s_nop 0
    v_mfma_f32_16x16x32_bf16 v[144:147], a[176:179], v[204:207], v[144:147]
    v_fma_f32 v180, v180, s20, -v216
    v_fma_f32 v181, v181, s20, -v216
    v_mfma_f32_16x16x32_bf16 v[148:151], a[176:179], v[208:211], v[148:151]
    v_fma_f32 v182, v182, s20, -v216
    v_max3_f32 v251, v180, v181, v182
    v_mfma_f32_16x16x32_bf16 v[152:155], a[176:179], v[212:215], v[152:155]
    v_fma_f32 v183, v183, s20, -v216
    v_fma_f32 v184, v184, s20, -v217
    s_waitcnt lgkmcnt(6)
    v_mfma_f32_16x16x32_bf16 v[0:3], a[160:163], v[204:207], v[0:3]
    ds_read_b64_tr_b16 a[156:157], v239 offset:24704
    v_mfma_f32_16x16x32_bf16 v[48:51], a[160:163], v[208:211], v[48:51]
    ds_read_b64_tr_b16 a[158:159], v239 offset:30848
    v_mfma_f32_16x16x32_bf16 v[96:99], a[160:163], v[212:215], v[96:99]
    buffer_load_dwordx4 v246, s[8:11], s31 offen offset:2048 nt lds
    v_mfma_f32_16x16x32_bf16 v[4:7], a[164:167], v[204:207], v[4:7]
    v_max3_f32 v251, v251, v183, v184
    v_fma_f32 v185, v185, s20, -v217
    v_mfma_f32_16x16x32_bf16 v[52:55], a[164:167], v[208:211], v[52:55]
    v_fma_f32 v186, v186, s20, -v217
    ds_read_b64_tr_b16 a[160:161], v236 offset:24832
    v_mfma_f32_16x16x32_bf16 v[100:103], a[164:167], v[212:215], v[100:103]
    ds_read_b64_tr_b16 a[162:163], v236 offset:30976
    v_mfma_f32_16x16x32_bf16 v[8:11], a[168:171], v[204:207], v[8:11]
    v_max3_f32 v251, v251, v185, v186
    v_fma_f32 v187, v187, s20, -v217
    v_mfma_f32_16x16x32_bf16 v[56:59], a[168:171], v[208:211], v[56:59]
    v_fma_f32 v188, v188, s20, -v218
    ds_read_b64_tr_b16 a[164:165], v237 offset:24832
    v_mfma_f32_16x16x32_bf16 v[104:107], a[168:171], v[212:215], v[104:107]
    ds_read_b64_tr_b16 a[166:167], v237 offset:30976
    v_mfma_f32_16x16x32_bf16 v[12:15], a[172:175], v[204:207], v[12:15]
    ds_read_b64_tr_b16 a[168:169], v238 offset:24832
    v_mfma_f32_16x16x32_bf16 v[60:63], a[172:175], v[208:211], v[60:63]
    v_mfma_f32_16x16x32_bf16 v[108:111], a[172:175], v[212:215], v[108:111]
    ds_read_b64_tr_b16 a[170:171], v238 offset:30976
    s_waitcnt vmcnt(13)
    s_barrier
    s_waitcnt lgkmcnt(6)
    v_mfma_f32_16x16x32_bf16 v[16:19], a[144:147], v[204:207], v[16:19]
    ds_read_b64_tr_b16 a[172:173], v239 offset:24832
    ds_read_b64_tr_b16 a[174:175], v239 offset:30976
    v_mfma_f32_16x16x32_bf16 v[64:67], a[144:147], v[208:211], v[64:67]
    s_add_u32 m0, s21, 61440
    s_add_u32 s32, s23, 12288
    v_mfma_f32_16x16x32_bf16 v[112:115], a[144:147], v[212:215], v[112:115]
    buffer_load_dwordx4 v247, s[12:15], s32 offen offset:0 lds
    v_mfma_f32_16x16x32_bf16 v[20:23], a[148:151], v[204:207], v[20:23]
    v_max3_f32 v251, v251, v187, v188
    v_fma_f32 v189, v189, s20, -v218
    v_mfma_f32_16x16x32_bf16 v[68:71], a[148:151], v[208:211], v[68:71]
    v_fma_f32 v190, v190, s20, -v218
    v_max3_f32 v251, v251, v189, v190
    v_mfma_f32_16x16x32_bf16 v[116:119], a[148:151], v[212:215], v[116:119]
    ds_read_b128 a[144:147], v232 offset:0
    v_mfma_f32_16x16x32_bf16 v[24:27], a[152:155], v[204:207], v[24:27]
    v_fma_f32 v191, v191, s20, -v218
    v_fma_f32 v192, v192, s20, -v216
    v_mfma_f32_16x16x32_bf16 v[72:75], a[152:155], v[208:211], v[72:75]
    v_max3_f32 v251, v251, v191, v192
    v_fma_f32 v193, v193, s20, -v216
    v_fma_f32 v194, v194, s20, -v216
    v_mfma_f32_16x16x32_bf16 v[120:123], a[152:155], v[212:215], v[120:123]
    ds_read_b128 a[148:151], v232 offset:6144
    v_mfma_f32_16x16x32_bf16 v[28:31], a[156:159], v[204:207], v[28:31]
    v_max3_f32 v251, v251, v193, v194
    v_fma_f32 v195, v195, s20, -v216
    v_mfma_f32_16x16x32_bf16 v[76:79], a[156:159], v[208:211], v[76:79]
    v_fma_f32 v196, v196, s20, -v217
    v_max3_f32 v251, v251, v195, v196
    v_mfma_f32_16x16x32_bf16 v[124:127], a[156:159], v[212:215], v[124:127]
    ds_read_b128 a[152:155], v233 offset:0
    s_waitcnt lgkmcnt(3)
    v_mfma_f32_16x16x32_bf16 v[32:35], a[160:163], v[204:207], v[32:35]
    v_fma_f32 v197, v197, s20, -v217
    v_fma_f32 v198, v198, s20, -v217
    v_mfma_f32_16x16x32_bf16 v[80:83], a[160:163], v[208:211], v[80:83]
    ds_read_b128 a[156:159], v233 offset:6144
    v_mfma_f32_16x16x32_bf16 v[128:131], a[160:163], v[212:215], v[128:131]
    buffer_load_dwordx4 v248, s[12:15], s32 offen offset:1024 lds
    v_mfma_f32_16x16x32_bf16 v[36:39], a[164:167], v[204:207], v[36:39]
    v_max3_f32 v251, v251, v197, v198
    v_fma_f32 v199, v199, s20, -v217
    v_mfma_f32_16x16x32_bf16 v[84:87], a[164:167], v[208:211], v[84:87]
    v_fma_f32 v200, v200, s20, -v218
    v_max3_f32 v251, v251, v199, v200
    v_fma_f32 v201, v201, s20, -v218
    v_mfma_f32_16x16x32_bf16 v[132:135], a[164:167], v[212:215], v[132:135]
    ds_read_b128 a[160:163], v232 offset:128
    v_mfma_f32_16x16x32_bf16 v[40:43], a[168:171], v[204:207], v[40:43]
    v_fma_f32 v202, v202, s20, -v218
    v_max3_f32 v251, v251, v201, v202
    v_mfma_f32_16x16x32_bf16 v[88:91], a[168:171], v[208:211], v[88:91]
    v_fma_f32 v203, v203, s20, -v218
    v_max_f32 v251, v251, v203
    v_cmp_lt_f32 vcc, 0x41000000, v251
    v_mfma_f32_16x16x32_bf16 v[136:139], a[168:171], v[212:215], v[136:139]
    ds_read_b128 a[164:167], v232 offset:6272
    v_mfma_f32_16x16x32_bf16 v[44:47], a[172:175], v[204:207], v[44:47]
    v_mfma_f32_16x16x32_bf16 v[92:95], a[172:175], v[208:211], v[92:95]
    ds_read_b128 a[168:171], v233 offset:128
    v_mfma_f32_16x16x32_bf16 v[140:143], a[172:175], v[212:215], v[140:143]
    s_cbranch_vccnz L_rare14
L_back14:
    s_cmp_eq_u32 s30, 3
    s_cbranch_scc1 L_tail
    s_waitcnt vmcnt(12)
    s_waitcnt lgkmcnt(3)
    v_mfma_f32_16x16x32_bf16 v[156:159], a[144:147], a[72:75], 0
    v_exp_f32 v180, v180
    v_exp_f32 v181, v181
    v_mfma_f32_16x16x32_bf16 v[160:163], a[144:147], a[96:99], 0
    ds_read_b128 a[172:175], v233 offset:6272
    buffer_load_dwordx4 v249, s[12:15], s32 offen offset:2048 lds
    v_mfma_f32_16x16x32_bf16 v[164:167], a[144:147], a[120:123], 0
    v_accvgpr_mov_b32 a0, a72
    v_accvgpr_mov_b32 a1, a73
    v_accvgpr_mov_b32 a2, a74
    v_mfma_f32_16x16x32_bf16 v[168:171], a[148:151], a[72:75], 0
    v_exp_f32 v182, v182
    v_exp_f32 v183, v183
    v_cvt_pk_bf16_f32 v204, v180, v181
    v_mfma_f32_16x16x32_bf16 v[172:175], a[148:151], a[96:99], 0
    v_exp_f32 v192, v192
    v_exp_f32 v193, v193
    v_mfma_f32_16x16x32_bf16 v[176:179], a[148:151], a[120:123], 0
    ds_read_b128 a[144:147], v232 offset:256
    v_accvgpr_mov_b32 a3, a75
    v_accvgpr_mov_b32 a4, a76
    v_accvgpr_mov_b32 a5, a77
    v_mfma_f32_16x16x32_bf16 v[156:159], a[152:155], a[76:79], v[156:159]
    v_cvt_pk_bf16_f32 v205, v182, v183
    v_exp_f32 v194, v194
    v_exp_f32 v195, v195
    v_mfma_f32_16x16x32_bf16 v[160:163], a[152:155], a[100:103], v[160:163]
    v_cvt_pk_bf16_f32 v206, v192, v193
    v_exp_f32 v184, v184
    v_mfma_f32_16x16x32_bf16 v[164:167], a[152:155], a[124:127], v[164:167]
    ds_read_b128 a[148:151], v232 offset:6400
    v_accvgpr_mov_b32 a6, a78
    v_accvgpr_mov_b32 a7, a79
    v_accvgpr_mov_b32 a8, a80
    v_mfma_f32_16x16x32_bf16 v[168:171], a[156:159], a[76:79], v[168:171]
    v_exp_f32 v185, v185
    v_cvt_pk_bf16_f32 v207, v194, v195
    v_exp_f32 v186, v186
    v_mfma_f32_16x16x32_bf16 v[172:175], a[156:159], a[100:103], v[172:175]
    v_exp_f32 v187, v187
    ds_read_b128 a[152:155], v233 offset:256
    v_mfma_f32_16x16x32_bf16 v[176:179], a[156:159], a[124:127], v[176:179]
    v_accvgpr_mov_b32 a9, a81
    v_accvgpr_mov_b32 a10, a82
    v_accvgpr_mov_b32 a11, a83
    s_waitcnt lgkmcnt(3)
    v_mfma_f32_16x16x32_bf16 v[156:159], a[160:163], a[80:83], v[156:159]
    v_cvt_pk_bf16_f32 v208, v184, v185
    v_exp_f32 v196, v196
    ds_read_b128 a[156:159], v233 offset:6400
    v_mfma_f32_16x16x32_bf16 v[160:163], a[160:163], a[104:107], v[160:163]
    s_add_u32 m0, s21, 36864
    s_add_u32 s31, s23, 36864
    buffer_load_dwordx4 v244, s[8:11], s31 offen offset:0 nt lds
    v_mfma_f32_16x16x32_bf16 v[164:167], a[160:163], a[128:131], v[164:167]
    v_accvgpr_mov_b32 a12, a84
    v_accvgpr_mov_b32 a13, a85
    v_accvgpr_mov_b32 a14, a86
    v_mfma_f32_16x16x32_bf16 v[168:171], a[164:167], a[80:83], v[168:171]
    v_exp_f32 v197, v197
    v_cvt_pk_bf16_f32 v209, v186, v187
    v_exp_f32 v198, v198
    v_mfma_f32_16x16x32_bf16 v[172:175], a[164:167], a[104:107], v[172:175]
    ds_read_b64_tr_b16 a[160:161], v236 offset:36864
    ds_read_b64_tr_b16 a[162:163], v236 offset:43008
    v_mfma_f32_16x16x32_bf16 v[176:179], a[164:167], a[128:131], v[176:179]
    v_accvgpr_mov_b32 a15, a87
    v_accvgpr_mov_b32 a16, a88
    v_accvgpr_mov_b32 a17, a89
    v_mfma_f32_16x16x32_bf16 v[156:159], a[168:171], a[84:87], v[156:159]
    v_exp_f32 v199, v199
    v_cvt_pk_bf16_f32 v210, v196, v197
    v_exp_f32 v188, v188
    v_mfma_f32_16x16x32_bf16 v[160:163], a[168:171], a[108:111], v[160:163]
    v_exp_f32 v189, v189
    ds_read_b64_tr_b16 a[164:165], v237 offset:36864
    v_mfma_f32_16x16x32_bf16 v[164:167], a[168:171], a[132:135], v[164:167]
    ds_read_b64_tr_b16 a[166:167], v237 offset:43008
    v_accvgpr_mov_b32 a18, a90
    v_accvgpr_mov_b32 a19, a91
    v_accvgpr_mov_b32 a20, a92
    v_mfma_f32_16x16x32_bf16 v[168:171], a[172:175], a[84:87], v[168:171]
    v_cvt_pk_bf16_f32 v211, v198, v199
    v_exp_f32 v190, v190
    v_exp_f32 v191, v191
    v_mfma_f32_16x16x32_bf16 v[172:175], a[172:175], a[108:111], v[172:175]
    ds_read_b64_tr_b16 a[168:169], v238 offset:36864
    ds_read_b64_tr_b16 a[170:171], v238 offset:43008
    v_mfma_f32_16x16x32_bf16 v[176:179], a[172:175], a[132:135], v[176:179]
    v_accvgpr_mov_b32 a21, a93
    v_accvgpr_mov_b32 a22, a94
    v_accvgpr_mov_b32 a23, a95
    s_waitcnt lgkmcnt(6)
    v_mfma_f32_16x16x32_bf16 v[156:159], a[144:147], a[88:91], v[156:159]
    ds_read_b64_tr_b16 a[172:173], v239 offset:36864
    ds_read_b64_tr_b16 a[174:175], v239 offset:43008
    v_mfma_f32_16x16x32_bf16 v[160:163], a[144:147], a[112:115], v[160:163]
    buffer_load_dwordx4 v245, s[8:11], s31 offen offset:1024 nt lds
    s_add_u32 s33, s26, 4096
    v_mfma_f32_16x16x32_bf16 v[164:167], a[144:147], a[136:139], v[164:167]
    buffer_store_dwordx4 a[244:247], v243, s[16:19], s33 offen offset:0
    v_accvgpr_mov_b32 a24, a96
    v_accvgpr_mov_b32 a25, a97
    v_accvgpr_mov_b32 a26, a98
    v_mfma_f32_16x16x32_bf16 v[168:171], a[148:151], a[88:91], v[168:171]
    ds_read_b64_tr_b16 a[144:145], v236 offset:36992
    ds_read_b64_tr_b16 a[146:147], v236 offset:43136
    v_mfma_f32_16x16x32_bf16 v[172:175], a[148:151], a[112:115], v[172:175]
    s_add_u32 s33, s26, 4096
    buffer_store_dwordx4 a[248:251], v243, s[16:19], s33 offen offset:1024
    v_mfma_f32_16x16x32_bf16 v[176:179], a[148:151], a[136:139], v[176:179]
    v_accvgpr_mov_b32 a27, a99
    v_accvgpr_mov_b32 a28, a100
    v_accvgpr_mov_b32 a29, a101
    v_mfma_f32_16x16x32_bf16 v[156:159], a[152:155], a[92:95], v[156:159]
    v_cvt_pk_bf16_f32 v212, v188, v189
    v_exp_f32 v200, v200
    v_exp_f32 v201, v201
    v_mfma_f32_16x16x32_bf16 v[160:163], a[152:155], a[116:119], v[160:163]
    v_cvt_pk_bf16_f32 v213, v190, v191
    ds_read_b64_tr_b16 a[148:149], v237 offset:36992
    v_mfma_f32_16x16x32_bf16 v[164:167], a[152:155], a[140:143], v[164:167]
    ds_read_b64_tr_b16 a[150:151], v237 offset:43136
    v_accvgpr_mov_b32 a30, a102
    v_accvgpr_mov_b32 a31, a103
    v_accvgpr_mov_b32 a32, a104
    v_mfma_f32_16x16x32_bf16 v[168:171], a[156:159], a[92:95], v[168:171]
    v_exp_f32 v202, v202
    v_exp_f32 v203, v203
    v_mfma_f32_16x16x32_bf16 v[172:175], a[156:159], a[116:119], v[172:175]
    v_cvt_pk_bf16_f32 v214, v200, v201
    ds_read_b64_tr_b16 a[152:153], v238 offset:36992
    ds_read_b64_tr_b16 a[154:155], v238 offset:43136
    v_mfma_f32_16x16x32_bf16 v[176:179], a[156:159], a[140:143], v[176:179]
    v_accvgpr_mov_b32 a33, a105
    v_accvgpr_mov_b32 a34, a106
    v_accvgpr_mov_b32 a35, a107
    v_cvt_pk_bf16_f32 v215, v202, v203
    s_nop 0
    v_mfma_f32_16x16x32_bf16 v[144:147], a[176:179], v[204:207], v[144:147]
    v_mfma_f32_16x16x32_bf16 v[148:151], a[176:179], v[208:211], v[148:151]
    v_mfma_f32_16x16x32_bf16 v[152:155], a[176:179], v[212:215], v[152:155]
    s_waitcnt lgkmcnt(6)
    v_mfma_f32_16x16x32_bf16 v[0:3], a[160:163], v[204:207], v[0:3]
    v_max3_f32 v251, v156, v157, v158
    v_max3_f32 v253, v160, v161, v162
    ds_read_b64_tr_b16 a[156:157], v239 offset:36992
    v_mfma_f32_16x16x32_bf16 v[48:51], a[160:163], v[208:211], v[48:51]
    ds_read_b64_tr_b16 a[158:159], v239 offset:43136
    buffer_load_dwordx4 v246, s[8:11], s31 offen offset:2048 nt lds
    v_mfma_f32_16x16x32_bf16 v[96:99], a[160:163], v[212:215], v[96:99]
    v_accvgpr_mov_b32 a36, a108
    v_accvgpr_mov_b32 a37, a109
    v_accvgpr_mov_b32 a38, a110
    v_mfma_f32_16x16x32_bf16 v[4:7], a[164:167], v[204:207], v[4:7]
    v_max3_f32 v255, v164, v165, v166
    v_max3_f32 v251, v251, v159, v168
    v_max3_f32 v253, v253, v163, v172
    v_max3_f32 v255, v255, v167, v176
    v_mfma_f32_16x16x32_bf16 v[52:55], a[164:167], v[208:211], v[52:55]
    v_max3_f32 v251, v251, v169, v170
    ds_read_b64_tr_b16 a[160:161], v236 offset:37120
    ds_read_b64_tr_b16 a[162:163], v236 offset:43264
    v_mfma_f32_16x16x32_bf16 v[100:103], a[164:167], v[212:215], v[100:103]
    v_accvgpr_mov_b32 a39, a111
    v_accvgpr_mov_b32 a40, a112
    v_accvgpr_mov_b32 a41, a113
    v_mfma_f32_16x16x32_bf16 v[8:11], a[168:171], v[204:207], v[8:11]
    v_max3_f32 v253, v253, v173, v174
    v_max3_f32 v255, v255, v177, v178
    v_max_f32 v251, v251, v171
    v_max_f32 v253, v253, v175
    v_mfma_f32_16x16x32_bf16 v[56:59], a[168:171], v[208:211], v[56:59]
    v_max_f32 v255, v255, v179
    ds_read_b64_tr_b16 a[164:165], v237 offset:37120
    ds_read_b64_tr_b16 a[166:167], v237 offset:43264
    v_mfma_f32_16x16x32_bf16 v[104:107], a[168:171], v[212:215], v[104:107]
    v_accvgpr_mov_b32 a42, a114
    v_accvgpr_mov_b32 a43, a115
    v_accvgpr_mov_b32 a44, a116
    v_mfma_f32_16x16x32_bf16 v[12:15], a[172:175], v[204:207], v[12:15]
    v_mov_b32 v252, v251
    v_mov_b32 v254, v253
    ds_read_b64_tr_b16 a[168:169], v238 offset:37120
    v_mfma_f32_16x16x32_bf16 v[60:63], a[172:175], v[208:211], v[60:63]
    ds_read_b64_tr_b16 a[170:171], v238 offset:43264
    v_mfma_f32_16x16x32_bf16 v[108:111], a[172:175], v[212:215], v[108:111]
    v_accvgpr_mov_b32 a45, a117
    v_accvgpr_mov_b32 a46, a118
    v_accvgpr_mov_b32 a47, a119
    s_waitcnt vmcnt(13)
    s_barrier
    s_waitcnt lgkmcnt(6)
    v_mfma_f32_16x16x32_bf16 v[16:19], a[144:147], v[204:207], v[16:19]
    ds_read_b64_tr_b16 a[172:173], v239 offset:37120
    ds_read_b64_tr_b16 a[174:175], v239 offset:43264
    v_mfma_f32_16x16x32_bf16 v[64:67], a[144:147], v[208:211], v[64:67]
    s_add_u32 m0, s21, 73728
    s_add_u32 s32, s23, 24576
    buffer_load_dwordx4 v247, s[12:15], s32 offen offset:0 lds
    v_mfma_f32_16x16x32_bf16 v[112:115], a[144:147], v[212:215], v[112:115]
    v_accvgpr_mov_b32 a48, a120
    v_accvgpr_mov_b32 a49, a121
    v_accvgpr_mov_b32 a50, a122
    v_mfma_f32_16x16x32_bf16 v[20:23], a[148:151], v[204:207], v[20:23]
    v_mov_b32 v219, v255
    v_permlane32_swap_b32 v251, v252
    v_permlane32_swap_b32 v253, v254
    v_permlane32_swap_b32 v255, v219
    v_mfma_f32_16x16x32_bf16 v[68:71], a[148:151], v[208:211], v[68:71]
    v_max_f32 v251, v251, v252
    v_max_f32 v253, v253, v254
    v_max_f32 v255, v255, v219
    ds_read_b128 a[144:147], v232 offset:12288
    v_mfma_f32_16x16x32_bf16 v[116:119], a[148:151], v[212:215], v[116:119]
    v_accvgpr_mov_b32 a51, a123
    v_accvgpr_mov_b32 a52, a124
    v_accvgpr_mov_b32 a53, a125
    v_mfma_f32_16x16x32_bf16 v[24:27], a[152:155], v[204:207], v[24:27]
    v_mov_b32 v252, v251
    v_mov_b32 v254, v253
    v_mov_b32 v219, v255
    v_permlane16_swap_b32 v251, v252
    v_mfma_f32_16x16x32_bf16 v[72:75], a[152:155], v[208:211], v[72:75]
    v_permlane16_swap_b32 v253, v254
    v_permlane16_swap_b32 v255, v219
    v_max_f32 v251, v251, v252
    ds_read_b128 a[148:151], v232 offset:18432
    v_mfma_f32_16x16x32_bf16 v[120:123], a[152:155], v[212:215], v[120:123]
    v_accvgpr_mov_b32 a54, a126
    v_accvgpr_mov_b32 a55, a127
    v_accvgpr_mov_b32 a56, a128
    v_mfma_f32_16x16x32_bf16 v[28:31], a[156:159], v[204:207], v[28:31]
    v_max_f32 v253, v253, v254
    v_max_f32 v255, v255, v219
    v_mul_f32 v216, s20, v251
    v_mul_f32 v217, s20, v253
    v_mfma_f32_16x16x32_bf16 v[76:79], a[156:159], v[208:211], v[76:79]
    v_mul_f32 v218, s20, v255
    v_fma_f32 v156, v156, s20, -v216
    ds_read_b128 a[152:155], v233 offset:12288
    v_mfma_f32_16x16x32_bf16 v[124:127], a[156:159], v[212:215], v[124:127]
    v_accvgpr_mov_b32 a57, a129
    v_accvgpr_mov_b32 a58, a130
    v_accvgpr_mov_b32 a59, a131
    s_waitcnt lgkmcnt(3)
    v_mfma_f32_16x16x32_bf16 v[32:35], a[160:163], v[204:207], v[32:35]
    v_fma_f32 v157, v157, s20, -v216
    v_fma_f32 v158, v158, s20, -v216
    v_fma_f32 v159, v159, s20, -v216
    v_fma_f32 v160, v160, s20, -v217
    v_mfma_f32_16x16x32_bf16 v[80:83], a[160:163], v[208:211], v[80:83]
    ds_read_b128 a[156:159], v233 offset:18432
    buffer_load_dwordx4 v248, s[12:15], s32 offen offset:1024 lds
    v_mfma_f32_16x16x32_bf16 v[128:131], a[160:163], v[212:215], v[128:131]
    v_accvgpr_mov_b32 a60, a132
    v_accvgpr_mov_b32 a61, a133
    v_accvgpr_mov_b32 a62, a134
    v_mfma_f32_16x16x32_bf16 v[36:39], a[164:167], v[204:207], v[36:39]
    v_fma_f32 v161, v161, s20, -v217
    v_fma_f32 v162, v162, s20, -v217
    v_fma_f32 v163, v163, s20, -v217
    v_fma_f32 v164, v164, s20, -v218
    v_mfma_f32_16x16x32_bf16 v[84:87], a[164:167], v[208:211], v[84:87]
    v_fma_f32 v165, v165, s20, -v218
    v_fma_f32 v166, v166, s20, -v218
    v_fma_f32 v167, v167, s20, -v218
    ds_read_b128 a[160:163], v232 offset:12416
    v_mfma_f32_16x16x32_bf16 v[132:135], a[164:167], v[212:215], v[132:135]
    v_accvgpr_mov_b32 a63, a135
    v_accvgpr_mov_b32 a64, a136
    v_accvgpr_mov_b32 a65, a137
    v_mfma_f32_16x16x32_bf16 v[40:43], a[168:171], v[204:207], v[40:43]
    v_fma_f32 v168, v168, s20, -v216
    v_fma_f32 v169, v169, s20, -v216
    v_fma_f32 v170, v170, s20, -v216
    v_fma_f32 v171, v171, s20, -v216
    v_mfma_f32_16x16x32_bf16 v[88:91], a[168:171], v[208:211], v[88:91]
    v_fma_f32 v172, v172, s20, -v217
    v_fma_f32 v173, v173, s20, -v217
    v_fma_f32 v174, v174, s20, -v217
    ds_read_b128 a[164:167], v232 offset:18560
    v_mfma_f32_16x16x32_bf16 v[136:139], a[168:171], v[212:215], v[136:139]
    v_accvgpr_mov_b32 a66, a138
    v_accvgpr_mov_b32 a67, a139
    v_accvgpr_mov_b32 a68, a140
    v_mfma_f32_16x16x32_bf16 v[44:47], a[172:175], v[204:207], v[44:47]
    v_fma_f32 v175, v175, s20, -v217
    v_fma_f32 v176, v176, s20, -v218
    v_fma_f32 v177, v177, s20, -v218
    v_mfma_f32_16x16x32_bf16 v[92:95], a[172:175], v[208:211], v[92:95]
    v_fma_f32 v178, v178, s20, -v218
    v_fma_f32 v179, v179, s20, -v218
    ds_read_b128 a[168:171], v233 offset:12416
    v_mfma_f32_16x16x32_bf16 v[140:143], a[172:175], v[212:215], v[140:143]
    v_accvgpr_mov_b32 a69, a141
    v_accvgpr_mov_b32 a70, a142
    v_accvgpr_mov_b32 a71, a143
    s_mov_b32 s24, s50
    s_mov_b32 s50, s27
    s_mov_b32 s25, s51
    s_mov_b32 s51, s28
    s_mov_b32 s26, s52
    s_mov_b32 s52, s29
    s_add_u32 s30, s30, 1
    s_mov_b32 s22, s23
    s_add_u32 s54, s54, 18087936
    s_add_u32 s33, s22, 25165824
    s_cmp_lt_u32 s30, 3
    s_cselect_b32 s23, s33, 0x80000000
    s_cselect_b32 s27, s54, 0x80000000
    s_add_u32 s28, s27, 6144
    s_add_u32 s29, s27, 12288
    s_or_b32 s29, s29, s53
    s_branch L_unit
L_tail:
    s_waitcnt lgkmcnt(0)
    v_exp_f32 v180, v180
    v_exp_f32 v181, v181
    v_exp_f32 v182, v182
    v_exp_f32 v183, v183
    v_cvt_pk_bf16_f32 v204, v180, v181
    v_exp_f32 v192, v192
    v_exp_f32 v193, v193
    v_cvt_pk_bf16_f32 v205, v182, v183
    v_exp_f32 v194, v194
    v_exp_f32 v195, v195
    v_cvt_pk_bf16_f32 v206, v192, v193
    v_exp_f32 v184, v184
    v_exp_f32 v185, v185
    v_cvt_pk_bf16_f32 v207, v194, v195
    v_exp_f32 v186, v186
    v_exp_f32 v187, v187
    v_cvt_pk_bf16_f32 v208, v184, v185
    v_exp_f32 v196, v196
    v_exp_f32 v197, v197
    v_cvt_pk_bf16_f32 v209, v186, v187
    v_exp_f32 v198, v198
    v_exp_f32 v199, v199
    v_cvt_pk_bf16_f32 v210, v196, v197
    v_exp_f32 v188, v188
    v_exp_f32 v189, v189
    v_cvt_pk_bf16_f32 v211, v198, v199
    ds_read_b64_tr_b16 a[160:161], v236 offset:36864
    ds_read_b64_tr_b16 a[162:163], v236 offset:43008
    v_exp_f32 v190, v190
    v_exp_f32 v191, v191
    ds_read_b64_tr_b16 a[164:165], v237 offset:36864
    ds_read_b64_tr_b16 a[166:167], v237 offset:43008
    v_cvt_pk_bf16_f32 v212, v188, v189
    v_exp_f32 v200, v200
    v_exp_f32 v201, v201
    ds_read_b64_tr_b16 a[168:169], v238 offset:36864
    ds_read_b64_tr_b16 a[170:171], v238 offset:43008
    ds_read_b64_tr_b16 a[172:173], v239 offset:36864
    ds_read_b64_tr_b16 a[174:175], v239 offset:43008
    s_add_u32 s33, s26, 4096
    buffer_store_dwordx4 a[244:247], v243, s[16:19], s33 offen offset:0
    ds_read_b64_tr_b16 a[144:145], v236 offset:36992
    ds_read_b64_tr_b16 a[146:147], v236 offset:43136
    s_add_u32 s33, s26, 4096
    buffer_store_dwordx4 a[248:251], v243, s[16:19], s33 offen offset:1024
    v_cvt_pk_bf16_f32 v213, v190, v191
    v_exp_f32 v202, v202
    ds_read_b64_tr_b16 a[148:149], v237 offset:36992
    ds_read_b64_tr_b16 a[150:151], v237 offset:43136
    v_exp_f32 v203, v203
    v_cvt_pk_bf16_f32 v214, v200, v201
    ds_read_b64_tr_b16 a[152:153], v238 offset:36992
    ds_read_b64_tr_b16 a[154:155], v238 offset:43136
    v_cvt_pk_bf16_f32 v215, v202, v203
    s_nop 0
    v_mfma_f32_16x16x32_bf16 v[144:147], a[176:179], v[204:207], v[144:147]
    v_mfma_f32_16x16x32_bf16 v[148:151], a[176:179], v[208:211], v[148:151]
    v_mfma_f32_16x16x32_bf16 v[152:155], a[176:179], v[212:215], v[152:155]
    s_waitcnt lgkmcnt(6)
    v_mfma_f32_16x16x32_bf16 v[0:3], a[160:163], v[204:207], v[0:3]
    ds_read_b64_tr_b16 a[156:157], v239 offset:36992
    v_mfma_f32_16x16x32_bf16 v[48:51], a[160:163], v[208:211], v[48:51]
    v_mfma_f32_16x16x32_bf16 v[96:99], a[160:163], v[212:215], v[96:99]
    ds_read_b64_tr_b16 a[158:159], v239 offset:43136
    v_mfma_f32_16x16x32_bf16 v[4:7], a[164:167], v[204:207], v[4:7]
    ds_read_b64_tr_b16 a[160:161], v236 offset:37120
    v_mfma_f32_16x16x32_bf16 v[52:55], a[164:167], v[208:211], v[52:55]
    v_mfma_f32_16x16x32_bf16 v[100:103], a[164:167], v[212:215], v[100:103]
    ds_read_b64_tr_b16 a[162:163], v236 offset:43264
    v_mfma_f32_16x16x32_bf16 v[8:11], a[168:171], v[204:207], v[8:11]
    ds_read_b64_tr_b16 a[164:165], v237 offset:37120
    v_mfma_f32_16x16x32_bf16 v[56:59], a[168:171], v[208:211], v[56:59]
    v_mfma_f32_16x16x32_bf16 v[104:107], a[168:171], v[212:215], v[104:107]
    ds_read_b64_tr_b16 a[166:167], v237 offset:43264
    v_mfma_f32_16x16x32_bf16 v[12:15], a[172:175], v[204:207], v[12:15]
    ds_read_b64_tr_b16 a[168:169], v238 offset:37120
    v_mfma_f32_16x16x32_bf16 v[60:63], a[172:175], v[208:211], v[60:63]
    v_mfma_f32_16x16x32_bf16 v[108:111], a[172:175], v[212:215], v[108:111]
    ds_read_b64_tr_b16 a[170:171], v238 offset:43264
    s_waitcnt lgkmcnt(6)
    v_mfma_f32_16x16x32_bf16 v[16:19], a[144:147], v[204:207], v[16:19]
    ds_read_b64_tr_b16 a[172:173], v239 offset:37120
    v_mfma_f32_16x16x32_bf16 v[64:67], a[144:147], v[208:211], v[64:67]
    v_mfma_f32_16x16x32_bf16 v[112:115], a[144:147], v[212:215], v[112:115]
    ds_read_b64_tr_b16 a[174:175], v239 offset:43264
    v_mfma_f32_16x16x32_bf16 v[20:23], a[148:151], v[204:207], v[20:23]
    v_mfma_f32_16x16x32_bf16 v[68:71], a[148:151], v[208:211], v[68:71]
    v_mfma_f32_16x16x32_bf16 v[116:119], a[148:151], v[212:215], v[116:119]
    v_mfma_f32_16x16x32_bf16 v[24:27], a[152:155], v[204:207], v[24:27]
    v_mfma_f32_16x16x32_bf16 v[72:75], a[152:155], v[208:211], v[72:75]
    v_mfma_f32_16x16x32_bf16 v[120:123], a[152:155], v[212:215], v[120:123]
    v_mfma_f32_16x16x32_bf16 v[28:31], a[156:159], v[204:207], v[28:31]
    v_mfma_f32_16x16x32_bf16 v[76:79], a[156:159], v[208:211], v[76:79]
    v_mfma_f32_16x16x32_bf16 v[124:127], a[156:159], v[212:215], v[124:127]
    s_waitcnt lgkmcnt(0)
    v_mfma_f32_16x16x32_bf16 v[32:35], a[160:163], v[204:207], v[32:35]
    v_mfma_f32_16x16x32_bf16 v[80:83], a[160:163], v[208:211], v[80:83]
    v_mfma_f32_16x16x32_bf16 v[128:131], a[160:163], v[212:215], v[128:131]
    v_mfma_f32_16x16x32_bf16 v[36:39], a[164:167], v[204:207], v[36:39]
    v_mfma_f32_16x16x32_bf16 v[84:87], a[164:167], v[208:211], v[84:87]
    v_mfma_f32_16x16x32_bf16 v[132:135], a[164:167], v[212:215], v[132:135]
    v_mfma_f32_16x16x32_bf16 v[40:43], a[168:171], v[204:207], v[40:43]
    v_mfma_f32_16x16x32_bf16 v[88:91], a[168:171], v[208:211], v[88:91]
    v_mfma_f32_16x16x32_bf16 v[136:139], a[168:171], v[212:215], v[136:139]
    v_mfma_f32_16x16x32_bf16 v[44:47], a[172:175], v[204:207], v[44:47]
    v_mfma_f32_16x16x32_bf16 v[92:95], a[172:175], v[208:211], v[92:95]
    v_mfma_f32_16x16x32_bf16 v[140:143], a[172:175], v[212:215], v[140:143]
    s_nop 7
    v_rcp_f32 v228, v144
    v_rcp_f32 v230, v148
    v_rcp_f32 v252, v152
    s_nop 0
    v_pk_mul_f32 v[0:1], v[0:1], v[228:229] op_sel_hi:[1,0]
    v_pk_mul_f32 v[2:3], v[2:3], v[228:229] op_sel_hi:[1,0]
    v_pk_mul_f32 v[4:5], v[4:5], v[228:229] op_sel_hi:[1,0]
    v_pk_mul_f32 v[6:7], v[6:7], v[228:229] op_sel_hi:[1,0]
    v_cvt_pk_bf16_f32 v220, v0, v1
    v_cvt_pk_bf16_f32 v221, v2, v3
    v_cvt_pk_bf16_f32 v222, v4, v5
    v_cvt_pk_bf16_f32 v223, v6, v7
    ds_write_b64 v234, v[220:221] offset:0
    ds_write_b64 v235, v[222:223] offset:0
    v_pk_mul_f32 v[8:9], v[8:9], v[228:229] op_sel_hi:[1,0]
    v_pk_mul_f32 v[10:11], v[10:11], v[228:229] op_sel_hi:[1,0]
    v_pk_mul_f32 v[12:13], v[12:13], v[228:229] op_sel_hi:[1,0]
    v_pk_mul_f32 v[14:15], v[14:15], v[228:229] op_sel_hi:[1,0]
    v_cvt_pk_bf16_f32 v224, v8, v9
    v_cvt_pk_bf16_f32 v225, v10, v11
    v_cvt_pk_bf16_f32 v226, v12, v13
    v_cvt_pk_bf16_f32 v227, v14, v15
    ds_write_b64 v234, v[224:225] offset:64
    ds_write_b64 v235, v[226:227] offset:64
    v_pk_mul_f32 v[16:17], v[16:17], v[228:229] op_sel_hi:[1,0]
    v_pk_mul_f32 v[18:19], v[18:19], v[228:229] op_sel_hi:[1,0]
    v_pk_mul_f32 v[20:21], v[20:21], v[228:229] op_sel_hi:[1,0]
    v_pk_mul_f32 v[22:23], v[22:23], v[228:229] op_sel_hi:[1,0]
    v_cvt_pk_bf16_f32 v220, v16, v17
    v_cvt_pk_bf16_f32 v221, v18, v19
    v_cvt_pk_bf16_f32 v222, v20, v21
    v_cvt_pk_bf16_f32 v223, v22, v23
    ds_write_b64 v234, v[220:221] offset:128
    ds_write_b64 v235, v[222:223] offset:128
    v_pk_mul_f32 v[24:25], v[24:25], v[228:229] op_sel_hi:[1,0]
    v_pk_mul_f32 v[26:27], v[26:27], v[228:229] op_sel_hi:[1,0]
    v_pk_mul_f32 v[28:29], v[28:29], v[228:229] op_sel_hi:[1,0]
    v_pk_mul_f32 v[30:31], v[30:31], v[228:229] op_sel_hi:[1,0]
    v_cvt_pk_bf16_f32 v224, v24, v25
    v_cvt_pk_bf16_f32 v225, v26, v27
    v_cvt_pk_bf16_f32 v226, v28, v29
    v_cvt_pk_bf16_f32 v227, v30, v31
    ds_write_b64 v234, v[224:225] offset:192
    ds_write_b64 v235, v[226:227] offset:192
    v_pk_mul_f32 v[32:33], v[32:33], v[228:229] op_sel_hi:[1,0]
    v_pk_mul_f32 v[34:35], v[34:35], v[228:229] op_sel_hi:[1,0]
    v_pk_mul_f32 v[36:37], v[36:37], v[228:229] op_sel_hi:[1,0]
    v_pk_mul_f32 v[38:39], v[38:39], v[228:229] op_sel_hi:[1,0]
    v_cvt_pk_bf16_f32 v220, v32, v33
    v_cvt_pk_bf16_f32 v221, v34, v35
    v_cvt_pk_bf16_f32 v222, v36, v37
    v_cvt_pk_bf16_f32 v223, v38, v39
    ds_write_b64 v234, v[220:221] offset:256
    ds_write_b64 v235, v[222:223] offset:256
    v_pk_mul_f32 v[40:41], v[40:41], v[228:229] op_sel_hi:[1,0]
    v_pk_mul_f32 v[42:43], v[42:43], v[228:229] op_sel_hi:[1,0]
    v_pk_mul_f32 v[44:45], v[44:45], v[228:229] op_sel_hi:[1,0]
    v_pk_mul_f32 v[46:47], v[46:47], v[228:229] op_sel_hi:[1,0]
    v_cvt_pk_bf16_f32 v224, v40, v41
    v_cvt_pk_bf16_f32 v225, v42, v43
    v_cvt_pk_bf16_f32 v226, v44, v45
    v_cvt_pk_bf16_f32 v227, v46, v47
    ds_write_b64 v234, v[224:225] offset:320
    ds_write_b64 v235, v[226:227] offset:320
    ds_read_b128 a[180:183], v240 offset:0
    ds_read_b128 a[184:187], v241 offset:0
    ds_read_b128 a[188:191], v242 offset:0
    ds_read_b128 a[192:195], v240 offset:3200
    ds_read_b128 a[196:199], v241 offset:3200
    ds_read_b128 a[200:203], v242 offset:3200
    v_pk_mul_f32 v[48:49], v[48:49], v[230:231] op_sel_hi:[1,0]
    v_pk_mul_f32 v[50:51], v[50:51], v[230:231] op_sel_hi:[1,0]
    v_pk_mul_f32 v[52:53], v[52:53], v[230:231] op_sel_hi:[1,0]
    v_pk_mul_f32 v[54:55], v[54:55], v[230:231] op_sel_hi:[1,0]
    v_cvt_pk_bf16_f32 v220, v48, v49
    v_cvt_pk_bf16_f32 v221, v50, v51
    v_cvt_pk_bf16_f32 v222, v52, v53
    v_cvt_pk_bf16_f32 v223, v54, v55
    ds_write_b64 v234, v[220:221] offset:0
    ds_write_b64 v235, v[222:223] offset:0
    v_pk_mul_f32 v[56:57], v[56:57], v[230:231] op_sel_hi:[1,0]
    v_pk_mul_f32 v[58:59], v[58:59], v[230:231] op_sel_hi:[1,0]
    v_pk_mul_f32 v[60:61], v[60:61], v[230:231] op_sel_hi:[1,0]
    v_pk_mul_f32 v[62:63], v[62:63], v[230:231] op_sel_hi:[1,0]
    v_cvt_pk_bf16_f32 v224, v56, v57
    v_cvt_pk_bf16_f32 v225, v58, v59
    v_cvt_pk_bf16_f32 v226, v60, v61
    v_cvt_pk_bf16_f32 v227, v62, v63
    ds_write_b64 v234, v[224:225] offset:64
    ds_write_b64 v235, v[226:227] offset:64
    v_pk_mul_f32 v[64:65], v[64:65], v[230:231] op_sel_hi:[1,0]
    v_pk_mul_f32 v[66:67], v[66:67], v[230:231] op_sel_hi:[1,0]
    v_pk_mul_f32 v[68:69], v[68:69], v[230:231] op_sel_hi:[1,0]
    v_pk_mul_f32 v[70:71], v[70:71], v[230:231] op_sel_hi:[1,0]
    v_cvt_pk_bf16_f32 v220, v64, v65
    v_cvt_pk_bf16_f32 v221, v66, v67
    v_cvt_pk_bf16_f32 v222, v68, v69
    v_cvt_pk_bf16_f32 v223, v70, v71
    ds_write_b64 v234, v[220:221] offset:128
    ds_write_b64 v235, v[222:223] offset:128
    v_pk_mul_f32 v[72:73], v[72:73], v[230:231] op_sel_hi:[1,0]
    v_pk_mul_f32 v[74:75], v[74:75], v[230:231] op_sel_hi:[1,0]
    v_pk_mul_f32 v[76:77], v[76:77], v[230:231] op_sel_hi:[1,0]
    v_pk_mul_f32 v[78:79], v[78:79], v[230:231] op_sel_hi:[1,0]
    v_cvt_pk_bf16_f32 v224, v72, v73
    v_cvt_pk_bf16_f32 v225, v74, v75
    v_cvt_pk_bf16_f32 v226, v76, v77
    v_cvt_pk_bf16_f32 v227, v78, v79
    ds_write_b64 v234, v[224:225] offset:192
    ds_write_b64 v235, v[226:227] offset:192
    v_pk_mul_f32 v[80:81], v[80:81], v[230:231] op_sel_hi:[1,0]
    v_pk_mul_f32 v[82:83], v[82:83], v[230:231] op_sel_hi:[1,0]
    v_pk_mul_f32 v[84:85], v[84:85], v[230:231] op_sel_hi:[1,0]
    v_pk_mul_f32 v[86:87], v[86:87], v[230:231] op_sel_hi:[1,0]
    v_cvt_pk_bf16_f32 v220, v80, v81
    v_cvt_pk_bf16_f32 v221, v82, v83
    v_cvt_pk_bf16_f32 v222, v84, v85
    v_cvt_pk_bf16_f32 v223, v86, v87
    ds_write_b64 v234, v[220:221] offset:256
    ds_write_b64 v235, v[222:223] offset:256
    v_pk_mul_f32 v[88:89], v[88:89], v[230:231] op_sel_hi:[1,0]
    v_pk_mul_f32 v[90:91], v[90:91], v[230:231] op_sel_hi:[1,0]
    v_pk_mul_f32 v[92:93], v[92:93], v[230:231] op_sel_hi:[1,0]
    v_pk_mul_f32 v[94:95], v[94:95], v[230:231] op_sel_hi:[1,0]
    v_cvt_pk_bf16_f32 v224, v88, v89
    v_cvt_pk_bf16_f32 v225, v90, v91
    v_cvt_pk_bf16_f32 v226, v92, v93
    v_cvt_pk_bf16_f32 v227, v94, v95
    ds_write_b64 v234, v[224:225] offset:320
    ds_write_b64 v235, v[226:227] offset:320
    ds_read_b128 a[204:207], v240 offset:0
    ds_read_b128 a[208:211], v241 offset:0
    ds_read_b128 a[212:215], v242 offset:0
    ds_read_b128 a[216:219], v240 offset:3200
    ds_read_b128 a[220:223], v241 offset:3200
    ds_read_b128 a[224:227], v242 offset:3200
    s_waitcnt lgkmcnt(15)
    buffer_store_dwordx4 a[180:183], v243, s[16:19], s50 offen offset:0
    s_waitcnt lgkmcnt(15)
    buffer_store_dwordx4 a[184:187], v243, s[16:19], s50 offen offset:1024
    s_waitcnt lgkmcnt(15)
    buffer_store_dwordx4 a[188:191], v243, s[16:19], s50 offen offset:2048
    s_waitcnt lgkmcnt(15)
    buffer_store_dwordx4 a[192:195], v243, s[16:19], s50 offen offset:3072
    s_waitcnt lgkmcnt(15)
    s_add_u32 s33, s50, 4096
    buffer_store_dwordx4 a[196:199], v243, s[16:19], s33 offen offset:0
    s_waitcnt lgkmcnt(15)
    s_add_u32 s33, s50, 4096
    buffer_store_dwordx4 a[200:203], v243, s[16:19], s33 offen offset:1024
    v_pk_mul_f32 v[96:97], v[96:97], v[252:253] op_sel_hi:[1,0]
    v_pk_mul_f32 v[98:99], v[98:99], v[252:253] op_sel_hi:[1,0]
    v_pk_mul_f32 v[100:101], v[100:101], v[252:253] op_sel_hi:[1,0]
    v_pk_mul_f32 v[102:103], v[102:103], v[252:253] op_sel_hi:[1,0]
    v_cvt_pk_bf16_f32 v220, v96, v97
    v_cvt_pk_bf16_f32 v221, v98, v99
    v_cvt_pk_bf16_f32 v222, v100, v101
    v_cvt_pk_bf16_f32 v223, v102, v103
    ds_write_b64 v234, v[220:221] offset:0
    ds_write_b64 v235, v[222:223] offset:0
    v_pk_mul_f32 v[104:105], v[104:105], v[252:253] op_sel_hi:[1,0]
    v_pk_mul_f32 v[106:107], v[106:107], v[252:253] op_sel_hi:[1,0]
    v_pk_mul_f32 v[108:109], v[108:109], v[252:253] op_sel_hi:[1,0]
    v_pk_mul_f32 v[110:111], v[110:111], v[252:253] op_sel_hi:[1,0]
    v_cvt_pk_bf16_f32 v224, v104, v105
    v_cvt_pk_bf16_f32 v225, v106, v107
    v_cvt_pk_bf16_f32 v226, v108, v109
    v_cvt_pk_bf16_f32 v227, v110, v111
    ds_write_b64 v234, v[224:225] offset:64
    ds_write_b64 v235, v[226:227] offset:64
    v_pk_mul_f32 v[112:113], v[112:113], v[252:253] op_sel_hi:[1,0]
    v_pk_mul_f32 v[114:115], v[114:115], v[252:253] op_sel_hi:[1,0]
    v_pk_mul_f32 v[116:117], v[116:117], v[252:253] op_sel_hi:[1,0]
    v_pk_mul_f32 v[118:119], v[118:119], v[252:253] op_sel_hi:[1,0]
    v_cvt_pk_bf16_f32 v220, v112, v113
    v_cvt_pk_bf16_f32 v221, v114, v115
    v_cvt_pk_bf16_f32 v222, v116, v117
    v_cvt_pk_bf16_f32 v223, v118, v119
    ds_write_b64 v234, v[220:221] offset:128
    ds_write_b64 v235, v[222:223] offset:128
    v_pk_mul_f32 v[120:121], v[120:121], v[252:253] op_sel_hi:[1,0]
    v_pk_mul_f32 v[122:123], v[122:123], v[252:253] op_sel_hi:[1,0]
    v_pk_mul_f32 v[124:125], v[124:125], v[252:253] op_sel_hi:[1,0]
    v_pk_mul_f32 v[126:127], v[126:127], v[252:253] op_sel_hi:[1,0]
    v_cvt_pk_bf16_f32 v224, v120, v121
    v_cvt_pk_bf16_f32 v225, v122, v123
    v_cvt_pk_bf16_f32 v226, v124, v125
    v_cvt_pk_bf16_f32 v227, v126, v127
    ds_write_b64 v234, v[224:225] offset:192
    ds_write_b64 v235, v[226:227] offset:192
    v_pk_mul_f32 v[128:129], v[128:129], v[252:253] op_sel_hi:[1,0]
    v_pk_mul_f32 v[130:131], v[130:131], v[252:253] op_sel_hi:[1,0]
    v_pk_mul_f32 v[132:133], v[132:133], v[252:253] op_sel_hi:[1,0]
    v_pk_mul_f32 v[134:135], v[134:135], v[252:253] op_sel_hi:[1,0]
    v_cvt_pk_bf16_f32 v220, v128, v129
    v_cvt_pk_bf16_f32 v221, v130, v131
    v_cvt_pk_bf16_f32 v222, v132, v133
    v_cvt_pk_bf16_f32 v223, v134, v135
    ds_write_b64 v234, v[220:221] offset:256
    ds_write_b64 v235, v[222:223] offset:256
    v_pk_mul_f32 v[136:137], v[136:137], v[252:253] op_sel_hi:[1,0]
    v_pk_mul_f32 v[138:139], v[138:139], v[252:253] op_sel_hi:[1,0]
    v_pk_mul_f32 v[140:141], v[140:141], v[252:253] op_sel_hi:[1,0]
    v_pk_mul_f32 v[142:143], v[142:143], v[252:253] op_sel_hi:[1,0]
    v_cvt_pk_bf16_f32 v224, v136, v137
    v_cvt_pk_bf16_f32 v225, v138, v139
    v_cvt_pk_bf16_f32 v226, v140, v141
    v_cvt_pk_bf16_f32 v227, v142, v143
    ds_write_b64 v234, v[224:225] offset:320
    ds_write_b64 v235, v[226:227] offset:320
    ds_read_b128 a[228:231], v240 offset:0
    ds_read_b128 a[232:235], v241 offset:0
    ds_read_b128 a[236:239], v242 offset:0
    ds_read_b128 a[240:243], v240 offset:3200
    ds_read_b128 a[244:247], v241 offset:3200
    ds_read_b128 a[248:251], v242 offset:3200
    s_waitcnt lgkmcnt(15)
    buffer_store_dwordx4 a[204:207], v243, s[16:19], s51 offen offset:0
    s_waitcnt lgkmcnt(15)
    buffer_store_dwordx4 a[208:211], v243, s[16:19], s51 offen offset:1024
    s_waitcnt lgkmcnt(15)
    buffer_store_dwordx4 a[212:215], v243, s[16:19], s51 offen offset:2048
    s_waitcnt lgkmcnt(15)
    buffer_store_dwordx4 a[216:219], v243, s[16:19], s51 offen offset:3072
    s_waitcnt lgkmcnt(15)
    s_add_u32 s33, s51, 4096
    buffer_store_dwordx4 a[220:223], v243, s[16:19], s33 offen offset:0
    s_waitcnt lgkmcnt(15)
    s_add_u32 s33, s51, 4096
    buffer_store_dwordx4 a[224:227], v243, s[16:19], s33 offen offset:1024
    s_waitcnt lgkmcnt(5)
    buffer_store_dwordx4 a[228:231], v243, s[16:19], s52 offen offset:0
    s_waitcnt lgkmcnt(4)
    buffer_store_dwordx4 a[232:235], v243, s[16:19], s52 offen offset:1024
    s_waitcnt lgkmcnt(3)
    buffer_store_dwordx4 a[236:239], v243, s[16:19], s52 offen offset:2048
    s_waitcnt lgkmcnt(2)
    buffer_store_dwordx4 a[240:243], v243, s[16:19], s52 offen offset:3072
    s_waitcnt lgkmcnt(1)
    s_add_u32 s33, s52, 4096
    buffer_store_dwordx4 a[244:247], v243, s[16:19], s33 offen offset:0
    s_waitcnt lgkmcnt(0)
    s_add_u32 s33, s52, 4096
    buffer_store_dwordx4 a[248:251], v243, s[16:19], s33 offen offset:1024
L_exit:
    s_endpgm
L_rare0:
    s_nop 7
    v_max3_f32 v251, v180, v181, v182
    v_max3_f32 v251, v251, v183, v192
    v_max3_f32 v251, v251, v193, v194
    v_max_f32 v251, v251, v195
    v_mov_b32 v252, v251
    s_nop 1
    v_permlane32_swap_b32 v251, v252
    v_max_f32 v251, v251, v252
    v_mov_b32 v252, v251
    s_nop 1
    v_permlane16_swap_b32 v251, v252
    v_max_f32 v251, v251, v252
    v_max_f32 v251, 0, v251
    v_add_f32 v216, v216, v251
    v_exp_f32 v253, -v251
    v_sub_f32 v180, v180, v251
    v_sub_f32 v181, v181, v251
    v_sub_f32 v182, v182, v251
    v_sub_f32 v183, v183, v251
    v_sub_f32 v192, v192, v251
    v_sub_f32 v193, v193, v251
    v_sub_f32 v194, v194, v251
    v_sub_f32 v195, v195, v251
    v_mul_f32 v0, v0, v253
    v_mul_f32 v1, v1, v253
    v_mul_f32 v2, v2, v253
    v_mul_f32 v3, v3, v253
    v_mul_f32 v4, v4, v253
    v_mul_f32 v5, v5, v253
    v_mul_f32 v6, v6, v253
    v_mul_f32 v7, v7, v253
    v_mul_f32 v8, v8, v253
    v_mul_f32 v9, v9, v253
    v_mul_f32 v10, v10, v253
    v_mul_f32 v11, v11, v253
    v_mul_f32 v12, v12, v253
    v_mul_f32 v13, v13, v253
    v_mul_f32 v14, v14, v253
    v_mul_f32 v15, v15, v253
    v_mul_f32 v16, v16, v253
    v_mul_f32 v17, v17, v253
    v_mul_f32 v18, v18, v253
    v_mul_f32 v19, v19, v253
    v_mul_f32 v20, v20, v253
    v_mul_f32 v21, v21, v253
    v_mul_f32 v22, v22, v253
    v_mul_f32 v23, v23, v253
    v_mul_f32 v24, v24, v253
    v_mul_f32 v25, v25, v253
    v_mul_f32 v26, v26, v253
    v_mul_f32 v27, v27, v253
    v_mul_f32 v28, v28, v253
    v_mul_f32 v29, v29, v253
    v_mul_f32 v30, v30, v253
    v_mul_f32 v31, v31, v253
    v_mul_f32 v32, v32, v253
    v_mul_f32 v33, v33, v253
    v_mul_f32 v34, v34, v253
    v_mul_f32 v35, v35, v253
    v_mul_f32 v36, v36, v253
    v_mul_f32 v37, v37, v253
    v_mul_f32 v38, v38, v253
    v_mul_f32 v39, v39, v253
    v_mul_f32 v40, v40, v253
    v_mul_f32 v41, v41, v253
    v_mul_f32 v42, v42, v253
    v_mul_f32 v43, v43, v253
    v_mul_f32 v44, v44, v253
    v_mul_f32 v45, v45, v253
    v_mul_f32 v46, v46, v253
    v_mul_f32 v47, v47, v253
    v_mul_f32 v144, v144, v253
    v_mul_f32 v145, v145, v253
    v_mul_f32 v146, v146, v253
    v_mul_f32 v147, v147, v253
    v_max3_f32 v251, v184, v185, v186
    v_max3_f32 v251, v251, v187, v196
    v_max3_f32 v251, v251, v197, v198
    v_max_f32 v251, v251, v199
    v_mov_b32 v252, v251
    s_nop 1
    v_permlane32_swap_b32 v251, v252
    v_max_f32 v251, v251, v252
    v_mov_b32 v252, v251
    s_nop 1
    v_permlane16_swap_b32 v251, v252
    v_max_f32 v251, v251, v252
    v_max_f32 v251, 0, v251
    v_add_f32 v217, v217, v251
    v_exp_f32 v253, -v251
    v_sub_f32 v184, v184, v251
    v_sub_f32 v185, v185, v251
    v_sub_f32 v186, v186, v251
    v_sub_f32 v187, v187, v251
    v_sub_f32 v196, v196, v251
    v_sub_f32 v197, v197, v251
    v_sub_f32 v198, v198, v251
    v_sub_f32 v199, v199, v251
    v_mul_f32 v48, v48, v253
    v_mul_f32 v49, v49, v253
    v_mul_f32 v50, v50, v253
    v_mul_f32 v51, v51, v253
    v_mul_f32 v52, v52, v253
    v_mul_f32 v53, v53, v253
    v_mul_f32 v54, v54, v253
    v_mul_f32 v55, v55, v253
    v_mul_f32 v56, v56, v253
    v_mul_f32 v57, v57, v253
    v_mul_f32 v58, v58, v253
    v_mul_f32 v59, v59, v253
    v_mul_f32 v60, v60, v253
    v_mul_f32 v61, v61, v253
    v_mul_f32 v62, v62, v253
    v_mul_f32 v63, v63, v253
    v_mul_f32 v64, v64, v253
    v_mul_f32 v65, v65, v253
    v_mul_f32 v66, v66, v253
    v_mul_f32 v67, v67, v253
    v_mul_f32 v68, v68, v253
    v_mul_f32 v69, v69, v253
    v_mul_f32 v70, v70, v253
    v_mul_f32 v71, v71, v253
    v_mul_f32 v72, v72, v253
    v_mul_f32 v73, v73, v253
    v_mul_f32 v74, v74, v253
    v_mul_f32 v75, v75, v253
    v_mul_f32 v76, v76, v253
    v_mul_f32 v77, v77, v253
    v_mul_f32 v78, v78, v253
    v_mul_f32 v79, v79, v253
    v_mul_f32 v80, v80, v253
    v_mul_f32 v81, v81, v253
    v_mul_f32 v82, v82, v253
    v_mul_f32 v83, v83, v253
    v_mul_f32 v84, v84, v253
    v_mul_f32 v85, v85, v253
    v_mul_f32 v86, v86, v253
    v_mul_f32 v87, v87, v253
    v_mul_f32 v88, v88, v253
    v_mul_f32 v89, v89, v253
    v_mul_f32 v90, v90, v253
    v_mul_f32 v91, v91, v253
    v_mul_f32 v92, v92, v253
    v_mul_f32 v93, v93, v253
    v_mul_f32 v94, v94, v253
    v_mul_f32 v95, v95, v253
    v_mul_f32 v148, v148, v253
    v_mul_f32 v149, v149, v253
    v_mul_f32 v150, v150, v253
    v_mul_f32 v151, v151, v253
    v_max3_f32 v251, v188, v189, v190
    v_max3_f32 v251, v251, v191, v200
    v_max3_f32 v251, v251, v201, v202
    v_max_f32 v251, v251, v203
    v_mov_b32 v252, v251
    s_nop 1
    v_permlane32_swap_b32 v251, v252
    v_max_f32 v251, v251, v252
    v_mov_b32 v252, v251
    s_nop 1
    v_permlane16_swap_b32 v251, v252
    v_max_f32 v251, v251, v252
    v_max_f32 v251, 0, v251
    v_add_f32 v218, v218, v251
    v_exp_f32 v253, -v251
    v_sub_f32 v188, v188, v251
    v_sub_f32 v189, v189, v251
    v_sub_f32 v190, v190, v251
    v_sub_f32 v191, v191, v251
    v_sub_f32 v200, v200, v251
    v_sub_f32 v201, v201, v251
    v_sub_f32 v202, v202, v251
    v_sub_f32 v203, v203, v251
    v_mul_f32 v96, v96, v253
    v_mul_f32 v97, v97, v253
    v_mul_f32 v98, v98, v253
    v_mul_f32 v99, v99, v253
    v_mul_f32 v100, v100, v253
    v_mul_f32 v101, v101, v253
    v_mul_f32 v102, v102, v253
    v_mul_f32 v103, v103, v253
    v_mul_f32 v104, v104, v253
    v_mul_f32 v105, v105, v253
    v_mul_f32 v106, v106, v253
    v_mul_f32 v107, v107, v253
    v_mul_f32 v108, v108, v253
    v_mul_f32 v109, v109, v253
    v_mul_f32 v110, v110, v253
    v_mul_f32 v111, v111, v253
    v_mul_f32 v112, v112, v253
    v_mul_f32 v113, v113, v253
    v_mul_f32 v114, v114, v253
    v_mul_f32 v115, v115, v253
    v_mul_f32 v116, v116, v253
    v_mul_f32 v117, v117, v253
    v_mul_f32 v118, v118, v253
    v_mul_f32 v119, v119, v253
    v_mul_f32 v120, v120, v253
    v_mul_f32 v121, v121, v253
    v_mul_f32 v122, v122, v253
    v_mul_f32 v123, v123, v253
    v_mul_f32 v124, v124, v253
    v_mul_f32 v125, v125, v253
    v_mul_f32 v126, v126, v253
    v_mul_f32 v127, v127, v253
    v_mul_f32 v128, v128, v253
    v_mul_f32 v129, v129, v253
    v_mul_f32 v130, v130, v253
    v_mul_f32 v131, v131, v253
    v_mul_f32 v132, v132, v253
    v_mul_f32 v133, v133, v253
    v_mul_f32 v134, v134, v253
    v_mul_f32 v135, v135, v253
    v_mul_f32 v136, v136, v253
    v_mul_f32 v137, v137, v253
    v_mul_f32 v138, v138, v253
    v_mul_f32 v139, v139, v253
    v_mul_f32 v140, v140, v253
    v_mul_f32 v141, v141, v253
    v_mul_f32 v142, v142, v253
    v_mul_f32 v143, v143, v253
    v_mul_f32 v152, v152, v253
    v_mul_f32 v153, v153, v253
    v_mul_f32 v154, v154, v253
    v_mul_f32 v155, v155, v253
    s_nop 1
    s_branch L_back0
L_rare1:
    s_nop 7
    v_max3_f32 v251, v156, v157, v158
    v_max3_f32 v251, v251, v159, v168
    v_max3_f32 v251, v251, v169, v170
    v_max_f32 v251, v251, v171
    v_mov_b32 v252, v251
    s_nop 1
    v_permlane32_swap_b32 v251, v252
    v_max_f32 v251, v251, v252
    v_mov_b32 v252, v251
    s_nop 1
    v_permlane16_swap_b32 v251, v252
    v_max_f32 v251, v251, v252
    v_max_f32 v251, 0, v251
    v_add_f32 v216, v216, v251
    v_exp_f32 v253, -v251
    v_sub_f32 v156, v156, v251
    v_sub_f32 v157, v157, v251
    v_sub_f32 v158, v158, v251
    v_sub_f32 v159, v159, v251
    v_sub_f32 v168, v168, v251
    v_sub_f32 v169, v169, v251
    v_sub_f32 v170, v170, v251
    v_sub_f32 v171, v171, v251
    v_mul_f32 v0, v0, v253
    v_mul_f32 v1, v1, v253
    v_mul_f32 v2, v2, v253
    v_mul_f32 v3, v3, v253
    v_mul_f32 v4, v4, v253
    v_mul_f32 v5, v5, v253
    v_mul_f32 v6, v6, v253
    v_mul_f32 v7, v7, v253
    v_mul_f32 v8, v8, v253
    v_mul_f32 v9, v9, v253
    v_mul_f32 v10, v10, v253
    v_mul_f32 v11, v11, v253
    v_mul_f32 v12, v12, v253
    v_mul_f32 v13, v13, v253
    v_mul_f32 v14, v14, v253
    v_mul_f32 v15, v15, v253
    v_mul_f32 v16, v16, v253
    v_mul_f32 v17, v17, v253
    v_mul_f32 v18, v18, v253
    v_mul_f32 v19, v19, v253
    v_mul_f32 v20, v20, v253
    v_mul_f32 v21, v21, v253
    v_mul_f32 v22, v22, v253
    v_mul_f32 v23, v23, v253
    v_mul_f32 v24, v24, v253
    v_mul_f32 v25, v25, v253
    v_mul_f32 v26, v26, v253
    v_mul_f32 v27, v27, v253
    v_mul_f32 v28, v28, v253
    v_mul_f32 v29, v29, v253
    v_mul_f32 v30, v30, v253
    v_mul_f32 v31, v31, v253
    v_mul_f32 v32, v32, v253
    v_mul_f32 v33, v33, v253
    v_mul_f32 v34, v34, v253
    v_mul_f32 v35, v35, v253
    v_mul_f32 v36, v36, v253
    v_mul_f32 v37, v37, v253
    v_mul_f32 v38, v38, v253
    v_mul_f32 v39, v39, v253
    v_mul_f32 v40, v40, v253
    v_mul_f32 v41, v41, v253
    v_mul_f32 v42, v42, v253
    v_mul_f32 v43, v43, v253
    v_mul_f32 v44, v44, v253
    v_mul_f32 v45, v45, v253
    v_mul_f32 v46, v46, v253
    v_mul_f32 v47, v47, v253
    v_mul_f32 v144, v144, v253
    v_mul_f32 v145, v145, v253
    v_mul_f32 v146, v146, v253
    v_mul_f32 v147, v147, v253
    v_max3_f32 v251, v160, v161, v162
    v_max3_f32 v251, v251, v163, v172
    v_max3_f32 v251, v251, v173, v174
    v_max_f32 v251, v251, v175
    v_mov_b32 v252, v251
    s_nop 1
    v_permlane32_swap_b32 v251, v252
    v_max_f32 v251, v251, v252
    v_mov_b32 v252, v251
    s_nop 1
    v_permlane16_swap_b32 v251, v252
    v_max_f32 v251, v251, v252
    v_max_f32 v251, 0, v251
    v_add_f32 v217, v217, v251
    v_exp_f32 v253, -v251
    v_sub_f32 v160, v160, v251
    v_sub_f32 v161, v161, v251
    v_sub_f32 v162, v162, v251
    v_sub_f32 v163, v163, v251
    v_sub_f32 v172, v172, v251
    v_sub_f32 v173, v173, v251
    v_sub_f32 v174, v174, v251
    v_sub_f32 v175, v175, v251
    v_mul_f32 v48, v48, v253
    v_mul_f32 v49, v49, v253
    v_mul_f32 v50, v50, v253
    v_mul_f32 v51, v51, v253
    v_mul_f32 v52, v52, v253
    v_mul_f32 v53, v53, v253
    v_mul_f32 v54, v54, v253
    v_mul_f32 v55, v55, v253
    v_mul_f32 v56, v56, v253
    v_mul_f32 v57, v57, v253
    v_mul_f32 v58, v58, v253
    v_mul_f32 v59, v59, v253
    v_mul_f32 v60, v60, v253
    v_mul_f32 v61, v61, v253
    v_mul_f32 v62, v62, v253
    v_mul_f32 v63, v63, v253
    v_mul_f32 v64, v64, v253
    v_mul_f32 v65, v65, v253
    v_mul_f32 v66, v66, v253
    v_mul_f32 v67, v67, v253
    v_mul_f32 v68, v68, v253
    v_mul_f32 v69, v69, v253
    v_mul_f32 v70, v70, v253
    v_mul_f32 v71, v71, v253
    v_mul_f32 v72, v72, v253
    v_mul_f32 v73, v73, v253
    v_mul_f32 v74, v74, v253
    v_mul_f32 v75, v75, v253
    v_mul_f32 v76, v76, v253
    v_mul_f32 v77, v77, v253
    v_mul_f32 v78, v78, v253
    v_mul_f32 v79, v79, v253
    v_mul_f32 v80, v80, v253
    v_mul_f32 v81, v81, v253
    v_mul_f32 v82, v82, v253
    v_mul_f32 v83, v83, v253
    v_mul_f32 v84, v84, v253
    v_mul_f32 v85, v85, v253
    v_mul_f32 v86, v86, v253
    v_mul_f32 v87, v87, v253
    v_mul_f32 v88, v88, v253
    v_mul_f32 v89, v89, v253
    v_mul_f32 v90, v90, v253
    v_mul_f32 v91, v91, v253
    v_mul_f32 v92, v92, v253
    v_mul_f32 v93, v93, v253
    v_mul_f32 v94, v94, v253
    v_mul_f32 v95, v95, v253
    v_mul_f32 v148, v148, v253
    v_mul_f32 v149, v149, v253
    v_mul_f32 v150, v150, v253
    v_mul_f32 v151, v151, v253
    v_max3_f32 v251, v164, v165, v166
    v_max3_f32 v251, v251, v167, v176
    v_max3_f32 v251, v251, v177, v178
    v_max_f32 v251, v251, v179
    v_mov_b32 v252, v251
    s_nop 1
    v_permlane32_swap_b32 v251, v252
    v_max_f32 v251, v251, v252
    v_mov_b32 v252, v251
    s_nop 1
    v_permlane16_swap_b32 v251, v252
    v_max_f32 v251, v251, v252
    v_max_f32 v251, 0, v251
    v_add_f32 v218, v218, v251
    v_exp_f32 v253, -v251
    v_sub_f32 v164, v164, v251
    v_sub_f32 v165, v165, v251
    v_sub_f32 v166, v166, v251
    v_sub_f32 v167, v167, v251
    v_sub_f32 v176, v176, v251
    v_sub_f32 v177, v177, v251
    v_sub_f32 v178, v178, v251
    v_sub_f32 v179, v179, v251
    v_mul_f32 v96, v96, v253
    v_mul_f32 v97, v97, v253
    v_mul_f32 v98, v98, v253
    v_mul_f32 v99, v99, v253
    v_mul_f32 v100, v100, v253
    v_mul_f32 v101, v101, v253
    v_mul_f32 v102, v102, v253
    v_mul_f32 v103, v103, v253
    v_mul_f32 v104, v104, v253
    v_mul_f32 v105, v105, v253
    v_mul_f32 v106, v106, v253
    v_mul_f32 v107, v107, v253
    v_mul_f32 v108, v108, v253
    v_mul_f32 v109, v109, v253
    v_mul_f32 v110, v110, v253
    v_mul_f32 v111, v111, v253
    v_mul_f32 v112, v112, v253
    v_mul_f32 v113, v113, v253
    v_mul_f32 v114, v114, v253
    v_mul_f32 v115, v115, v253
    v_mul_f32 v116, v116, v253
    v_mul_f32 v117, v117, v253
    v_mul_f32 v118, v118, v253
    v_mul_f32 v119, v119, v253
    v_mul_f32 v120, v120, v253
    v_mul_f32 v121, v121, v253
    v_mul_f32 v122, v122, v253
    v_mul_f32 v123, v123, v253
    v_mul_f32 v124, v124, v253
    v_mul_f32 v125, v125, v253
    v_mul_f32 v126, v126, v253
    v_mul_f32 v127, v127, v253
    v_mul_f32 v128, v128, v253
    v_mul_f32 v129, v129, v253
    v_mul_f32 v130, v130, v253
    v_mul_f32 v131, v131, v253
    v_mul_f32 v132, v132, v253
    v_mul_f32 v133, v133, v253
    v_mul_f32 v134, v134, v253
    v_mul_f32 v135, v135, v253
    v_mul_f32 v136, v136, v253
    v_mul_f32 v137, v137, v253
    v_mul_f32 v138, v138, v253
    v_mul_f32 v139, v139, v253
    v_mul_f32 v140, v140, v253
    v_mul_f32 v141, v141, v253
    v_mul_f32 v142, v142, v253
    v_mul_f32 v143, v143, v253
    v_mul_f32 v152, v152, v253
    v_mul_f32 v153, v153, v253
    v_mul_f32 v154, v154, v253
    v_mul_f32 v155, v155, v253
    s_nop 1
    s_branch L_back1
L_rare2:
    s_nop 7
    v_max3_f32 v251, v180, v181, v182
    v_max3_f32 v251, v251, v183, v192
    v_max3_f32 v251, v251, v193, v194
    v_max_f32 v251, v251, v195
    v_mov_b32 v252, v251
    s_nop 1
    v_permlane32_swap_b32 v251, v252
    v_max_f32 v251, v251, v252
    v_mov_b32 v252, v251
    s_nop 1
    v_permlane16_swap_b32 v251, v252
    v_max_f32 v251, v251, v252
    v_max_f32 v251, 0, v251
    v_add_f32 v216, v216, v251
    v_exp_f32 v253, -v251
    v_sub_f32 v180, v180, v251
    v_sub_f32 v181, v181, v251
    v_sub_f32 v182, v182, v251
    v_sub_f32 v183, v183, v251
    v_sub_f32 v192, v192, v251
    v_sub_f32 v193, v193, v251
    v_sub_f32 v194, v194, v251
    v_sub_f32 v195, v195, v251
    v_mul_f32 v0, v0, v253
    v_mul_f32 v1, v1, v253
    v_mul_f32 v2, v2, v253
    v_mul_f32 v3, v3, v253
    v_mul_f32 v4, v4, v253
    v_mul_f32 v5, v5, v253
    v_mul_f32 v6, v6, v253
    v_mul_f32 v7, v7, v253
    v_mul_f32 v8, v8, v253
    v_mul_f32 v9, v9, v253
    v_mul_f32 v10, v10, v253
    v_mul_f32 v11, v11, v253
    v_mul_f32 v12, v12, v253
    v_mul_f32 v13, v13, v253
    v_mul_f32 v14, v14, v253
    v_mul_f32 v15, v15, v253
    v_mul_f32 v16, v16, v253
    v_mul_f32 v17, v17, v253
    v_mul_f32 v18, v18, v253
    v_mul_f32 v19, v19, v253
    v_mul_f32 v20, v20, v253
    v_mul_f32 v21, v21, v253
    v_mul_f32 v22, v22, v253
    v_mul_f32 v23, v23, v253
    v_mul_f32 v24, v24, v253
    v_mul_f32 v25, v25, v253
    v_mul_f32 v26, v26, v253
    v_mul_f32 v27, v27, v253
    v_mul_f32 v28, v28, v253
    v_mul_f32 v29, v29, v253
    v_mul_f32 v30, v30, v253
    v_mul_f32 v31, v31, v253
    v_mul_f32 v32, v32, v253
    v_mul_f32 v33, v33, v253
    v_mul_f32 v34, v34, v253
    v_mul_f32 v35, v35, v253
    v_mul_f32 v36, v36, v253
    v_mul_f32 v37, v37, v253
    v_mul_f32 v38, v38, v253
    v_mul_f32 v39, v39, v253
    v_mul_f32 v40, v40, v253
    v_mul_f32 v41, v41, v253
    v_mul_f32 v42, v42, v253
    v_mul_f32 v43, v43, v253
    v_mul_f32 v44, v44, v253
    v_mul_f32 v45, v45, v253
    v_mul_f32 v46, v46, v253
    v_mul_f32 v47, v47, v253
    v_mul_f32 v144, v144, v253
    v_mul_f32 v145, v145, v253
    v_mul_f32 v146, v146, v253
    v_mul_f32 v147, v147, v253
    v_max3_f32 v251, v184, v185, v186
    v_max3_f32 v251, v251, v187, v196
    v_max3_f32 v251, v251, v197, v198
    v_max_f32 v251, v251, v199
    v_mov_b32 v252, v251
    s_nop 1
    v_permlane32_swap_b32 v251, v252
    v_max_f32 v251, v251, v252
    v_mov_b32 v252, v251
    s_nop 1
    v_permlane16_swap_b32 v251, v252
    v_max_f32 v251, v251, v252
    v_max_f32 v251, 0, v251
    v_add_f32 v217, v217, v251
    v_exp_f32 v253, -v251
    v_sub_f32 v184, v184, v251
    v_sub_f32 v185, v185, v251
    v_sub_f32 v186, v186, v251
    v_sub_f32 v187, v187, v251
    v_sub_f32 v196, v196, v251
    v_sub_f32 v197, v197, v251
    v_sub_f32 v198, v198, v251
    v_sub_f32 v199, v199, v251
    v_mul_f32 v48, v48, v253
    v_mul_f32 v49, v49, v253
    v_mul_f32 v50, v50, v253
    v_mul_f32 v51, v51, v253
    v_mul_f32 v52, v52, v253
    v_mul_f32 v53, v53, v253
    v_mul_f32 v54, v54, v253
    v_mul_f32 v55, v55, v253
    v_mul_f32 v56, v56, v253
    v_mul_f32 v57, v57, v253
    v_mul_f32 v58, v58, v253
    v_mul_f32 v59, v59, v253
    v_mul_f32 v60, v60, v253
    v_mul_f32 v61, v61, v253
    v_mul_f32 v62, v62, v253
    v_mul_f32 v63, v63, v253
    v_mul_f32 v64, v64, v253
    v_mul_f32 v65, v65, v253
    v_mul_f32 v66, v66, v253
    v_mul_f32 v67, v67, v253
    v_mul_f32 v68, v68, v253
    v_mul_f32 v69, v69, v253
    v_mul_f32 v70, v70, v253
    v_mul_f32 v71, v71, v253
    v_mul_f32 v72, v72, v253
    v_mul_f32 v73, v73, v253
    v_mul_f32 v74, v74, v253
    v_mul_f32 v75, v75, v253
    v_mul_f32 v76, v76, v253
    v_mul_f32 v77, v77, v253
    v_mul_f32 v78, v78, v253
    v_mul_f32 v79, v79, v253
    v_mul_f32 v80, v80, v253
    v_mul_f32 v81, v81, v253
    v_mul_f32 v82, v82, v253
    v_mul_f32 v83, v83, v253
    v_mul_f32 v84, v84, v253
    v_mul_f32 v85, v85, v253
    v_mul_f32 v86, v86, v253
    v_mul_f32 v87, v87, v253
    v_mul_f32 v88, v88, v253
    v_mul_f32 v89, v89, v253
    v_mul_f32 v90, v90, v253
    v_mul_f32 v91, v91, v253
    v_mul_f32 v92, v92, v253
    v_mul_f32 v93, v93, v253
    v_mul_f32 v94, v94, v253
    v_mul_f32 v95, v95, v253
    v_mul_f32 v148, v148, v253
    v_mul_f32 v149, v149, v253
    v_mul_f32 v150, v150, v253
    v_mul_f32 v151, v151, v253
    v_max3_f32 v251, v188, v189, v190
    v_max3_f32 v251, v251, v191, v200
    v_max3_f32 v251, v251, v201, v202
    v_max_f32 v251, v251, v203
    v_mov_b32 v252, v251
    s_nop 1
    v_permlane32_swap_b32 v251, v252
    v_max_f32 v251, v251, v252
    v_mov_b32 v252, v251
    s_nop 1
    v_permlane16_swap_b32 v251, v252
    v_max_f32 v251, v251, v252
    v_max_f32 v251, 0, v251
    v_add_f32 v218, v218, v251
    v_exp_f32 v253, -v251
    v_sub_f32 v188, v188, v251
    v_sub_f32 v189, v189, v251
    v_sub_f32 v190, v190, v251
    v_sub_f32 v191, v191, v251
    v_sub_f32 v200, v200, v251
    v_sub_f32 v201, v201, v251
    v_sub_f32 v202, v202, v251
    v_sub_f32 v203, v203, v251
    v_mul_f32 v96, v96, v253
    v_mul_f32 v97, v97, v253
    v_mul_f32 v98, v98, v253
    v_mul_f32 v99, v99, v253
    v_mul_f32 v100, v100, v253
    v_mul_f32 v101, v101, v253
    v_mul_f32 v102, v102, v253
    v_mul_f32 v103, v103, v253
    v_mul_f32 v104, v104, v253
    v_mul_f32 v105, v105, v253
    v_mul_f32 v106, v106, v253
    v_mul_f32 v107, v107, v253
    v_mul_f32 v108, v108, v253
    v_mul_f32 v109, v109, v253
    v_mul_f32 v110, v110, v253
    v_mul_f32 v111, v111, v253
    v_mul_f32 v112, v112, v253
    v_mul_f32 v113, v113, v253
    v_mul_f32 v114, v114, v253
    v_mul_f32 v115, v115, v253
    v_mul_f32 v116, v116, v253
    v_mul_f32 v117, v117, v253
    v_mul_f32 v118, v118, v253
    v_mul_f32 v119, v119, v253
    v_mul_f32 v120, v120, v253
    v_mul_f32 v121, v121, v253
    v_mul_f32 v122, v122, v253
    v_mul_f32 v123, v123, v253
    v_mul_f32 v124, v124, v253
    v_mul_f32 v125, v125, v253
    v_mul_f32 v126, v126, v253
    v_mul_f32 v127, v127, v253
    v_mul_f32 v128, v128, v253
    v_mul_f32 v129, v129, v253
    v_mul_f32 v130, v130, v253
    v_mul_f32 v131, v131, v253
    v_mul_f32 v132, v132, v253
    v_mul_f32 v133, v133, v253
    v_mul_f32 v134, v134, v253
    v_mul_f32 v135, v135, v253
    v_mul_f32 v136, v136, v253
    v_mul_f32 v137, v137, v253
    v_mul_f32 v138, v138, v253
    v_mul_f32 v139, v139, v253
    v_mul_f32 v140, v140, v253
    v_mul_f32 v141, v141, v253
    v_mul_f32 v142, v142, v253
    v_mul_f32 v143, v143, v253
    v_mul_f32 v152, v152, v253
    v_mul_f32 v153, v153, v253
    v_mul_f32 v154, v154, v253
    v_mul_f32 v155, v155, v253
    s_nop 1
    s_branch L_back2
L_rare3:
    s_nop 7
    v_max3_f32 v251, v156, v157, v158
    v_max3_f32 v251, v251, v159, v168
    v_max3_f32 v251, v251, v169, v170
    v_max_f32 v251, v251, v171
    v_mov_b32 v252, v251
    s_nop 1
    v_permlane32_swap_b32 v251, v252
    v_max_f32 v251, v251, v252
    v_mov_b32 v252, v251
    s_nop 1
    v_permlane16_swap_b32 v251, v252
    v_max_f32 v251, v251, v252
    v_max_f32 v251, 0, v251
    v_add_f32 v216, v216, v251
    v_exp_f32 v253, -v251
    v_sub_f32 v156, v156, v251
    v_sub_f32 v157, v157, v251
    v_sub_f32 v158, v158, v251
    v_sub_f32 v159, v159, v251
    v_sub_f32 v168, v168, v251
    v_sub_f32 v169, v169, v251
    v_sub_f32 v170, v170, v251
    v_sub_f32 v171, v171, v251
    v_mul_f32 v0, v0, v253
    v_mul_f32 v1, v1, v253
    v_mul_f32 v2, v2, v253
    v_mul_f32 v3, v3, v253
    v_mul_f32 v4, v4, v253
    v_mul_f32 v5, v5, v253
    v_mul_f32 v6, v6, v253
    v_mul_f32 v7, v7, v253
    v_mul_f32 v8, v8, v253
    v_mul_f32 v9, v9, v253
    v_mul_f32 v10, v10, v253
    v_mul_f32 v11, v11, v253
    v_mul_f32 v12, v12, v253
    v_mul_f32 v13, v13, v253
    v_mul_f32 v14, v14, v253
    v_mul_f32 v15, v15, v253
    v_mul_f32 v16, v16, v253
    v_mul_f32 v17, v17, v253
    v_mul_f32 v18, v18, v253
    v_mul_f32 v19, v19, v253
    v_mul_f32 v20, v20, v253
    v_mul_f32 v21, v21, v253
    v_mul_f32 v22, v22, v253
    v_mul_f32 v23, v23, v253
    v_mul_f32 v24, v24, v253
    v_mul_f32 v25, v25, v253
    v_mul_f32 v26, v26, v253
    v_mul_f32 v27, v27, v253
    v_mul_f32 v28, v28, v253
    v_mul_f32 v29, v29, v253
    v_mul_f32 v30, v30, v253
    v_mul_f32 v31, v31, v253
    v_mul_f32 v32, v32, v253
    v_mul_f32 v33, v33, v253
    v_mul_f32 v34, v34, v253
    v_mul_f32 v35, v35, v253
    v_mul_f32 v36, v36, v253
    v_mul_f32 v37, v37, v253
    v_mul_f32 v38, v38, v253
    v_mul_f32 v39, v39, v253
    v_mul_f32 v40, v40, v253
    v_mul_f32 v41, v41, v253
    v_mul_f32 v42, v42, v253
    v_mul_f32 v43, v43, v253
    v_mul_f32 v44, v44, v253
    v_mul_f32 v45, v45, v253
    v_mul_f32 v46, v46, v253
    v_mul_f32 v47, v47, v253
    v_mul_f32 v144, v144, v253
    v_mul_f32 v145, v145, v253
    v_mul_f32 v146, v146, v253
    v_mul_f32 v147, v147, v253
    v_max3_f32 v251, v160, v161, v162
    v_max3_f32 v251, v251, v163, v172
    v_max3_f32 v251, v251, v173, v174
    v_max_f32 v251, v251, v175
    v_mov_b32 v252, v251
    s_nop 1
    v_permlane32_swap_b32 v251, v252
    v_max_f32 v251, v251, v252
    v_mov_b32 v252, v251
    s_nop 1
    v_permlane16_swap_b32 v251, v252
    v_max_f32 v251, v251, v252
    v_max_f32 v251, 0, v251
    v_add_f32 v217, v217, v251
    v_exp_f32 v253, -v251
    v_sub_f32 v160, v160, v251
    v_sub_f32 v161, v161, v251
    v_sub_f32 v162, v162, v251
    v_sub_f32 v163, v163, v251
    v_sub_f32 v172, v172, v251
    v_sub_f32 v173, v173, v251
    v_sub_f32 v174, v174, v251
    v_sub_f32 v175, v175, v251
    v_mul_f32 v48, v48, v253
    v_mul_f32 v49, v49, v253
    v_mul_f32 v50, v50, v253
    v_mul_f32 v51, v51, v253
    v_mul_f32 v52, v52, v253
    v_mul_f32 v53, v53, v253
    v_mul_f32 v54, v54, v253
    v_mul_f32 v55, v55, v253
    v_mul_f32 v56, v56, v253
    v_mul_f32 v57, v57, v253
    v_mul_f32 v58, v58, v253
    v_mul_f32 v59, v59, v253
    v_mul_f32 v60, v60, v253
    v_mul_f32 v61, v61, v253
    v_mul_f32 v62, v62, v253
    v_mul_f32 v63, v63, v253
    v_mul_f32 v64, v64, v253
    v_mul_f32 v65, v65, v253
    v_mul_f32 v66, v66, v253
    v_mul_f32 v67, v67, v253
    v_mul_f32 v68, v68, v253
    v_mul_f32 v69, v69, v253
    v_mul_f32 v70, v70, v253
    v_mul_f32 v71, v71, v253
    v_mul_f32 v72, v72, v253
    v_mul_f32 v73, v73, v253
    v_mul_f32 v74, v74, v253
    v_mul_f32 v75, v75, v253
    v_mul_f32 v76, v76, v253
    v_mul_f32 v77, v77, v253
    v_mul_f32 v78, v78, v253
    v_mul_f32 v79, v79, v253
    v_mul_f32 v80, v80, v253
    v_mul_f32 v81, v81, v253
    v_mul_f32 v82, v82, v253
    v_mul_f32 v83, v83, v253
    v_mul_f32 v84, v84, v253
    v_mul_f32 v85, v85, v253
    v_mul_f32 v86, v86, v253
    v_mul_f32 v87, v87, v253
    v_mul_f32 v88, v88, v253
    v_mul_f32 v89, v89, v253
    v_mul_f32 v90, v90, v253
    v_mul_f32 v91, v91, v253
    v_mul_f32 v92, v92, v253
    v_mul_f32 v93, v93, v253
    v_mul_f32 v94, v94, v253
    v_mul_f32 v95, v95, v253
    v_mul_f32 v148, v148, v253
    v_mul_f32 v149, v149, v253
    v_mul_f32 v150, v150, v253
    v_mul_f32 v151, v151, v253
    v_max3_f32 v251, v164, v165, v166
    v_max3_f32 v251, v251, v167, v176
    v_max3_f32 v251, v251, v177, v178
    v_max_f32 v251, v251, v179
    v_mov_b32 v252, v251
    s_nop 1
    v_permlane32_swap_b32 v251, v252
    v_max_f32 v251, v251, v252
    v_mov_b32 v252, v251
    s_nop 1
    v_permlane16_swap_b32 v251, v252
    v_max_f32 v251, v251, v252
    v_max_f32 v251, 0, v251
    v_add_f32 v218, v218, v251
    v_exp_f32 v253, -v251
    v_sub_f32 v164, v164, v251
    v_sub_f32 v165, v165, v251
    v_sub_f32 v166, v166, v251
    v_sub_f32 v167, v167, v251
    v_sub_f32 v176, v176, v251
    v_sub_f32 v177, v177, v251
    v_sub_f32 v178, v178, v251
    v_sub_f32 v179, v179, v251
    v_mul_f32 v96, v96, v253
    v_mul_f32 v97, v97, v253
    v_mul_f32 v98, v98, v253
    v_mul_f32 v99, v99, v253
    v_mul_f32 v100, v100, v253
    v_mul_f32 v101, v101, v253
    v_mul_f32 v102, v102, v253
    v_mul_f32 v103, v103, v253
    v_mul_f32 v104, v104, v253
    v_mul_f32 v105, v105, v253
    v_mul_f32 v106, v106, v253
    v_mul_f32 v107, v107, v253
    v_mul_f32 v108, v108, v253
    v_mul_f32 v109, v109, v253
    v_mul_f32 v110, v110, v253
    v_mul_f32 v111, v111, v253
    v_mul_f32 v112, v112, v253
    v_mul_f32 v113, v113, v253
    v_mul_f32 v114, v114, v253
    v_mul_f32 v115, v115, v253
    v_mul_f32 v116, v116, v253
    v_mul_f32 v117, v117, v253
    v_mul_f32 v118, v118, v253
    v_mul_f32 v119, v119, v253
    v_mul_f32 v120, v120, v253
    v_mul_f32 v121, v121, v253
    v_mul_f32 v122, v122, v253
    v_mul_f32 v123, v123, v253
    v_mul_f32 v124, v124, v253
    v_mul_f32 v125, v125, v253
    v_mul_f32 v126, v126, v253
    v_mul_f32 v127, v127, v253
    v_mul_f32 v128, v128, v253
    v_mul_f32 v129, v129, v253
    v_mul_f32 v130, v130, v253
    v_mul_f32 v131, v131, v253
    v_mul_f32 v132, v132, v253
    v_mul_f32 v133, v133, v253
    v_mul_f32 v134, v134, v253
    v_mul_f32 v135, v135, v253
    v_mul_f32 v136, v136, v253
    v_mul_f32 v137, v137, v253
    v_mul_f32 v138, v138, v253
    v_mul_f32 v139, v139, v253
    v_mul_f32 v140, v140, v253
    v_mul_f32 v141, v141, v253
    v_mul_f32 v142, v142, v253
    v_mul_f32 v143, v143, v253
    v_mul_f32 v152, v152, v253
    v_mul_f32 v153, v153, v253
    v_mul_f32 v154, v154, v253
    v_mul_f32 v155, v155, v253
    s_nop 1
    s_branch L_back3
L_rare4:
    s_nop 7
    v_max3_f32 v251, v180, v181, v182
    v_max3_f32 v251, v251, v183, v192
    v_max3_f32 v251, v251, v193, v194
    v_max_f32 v251, v251, v195
    v_mov_b32 v252, v251
    s_nop 1
    v_permlane32_swap_b32 v251, v252
    v_max_f32 v251, v251, v252
    v_mov_b32 v252, v251
    s_nop 1
    v_permlane16_swap_b32 v251, v252
    v_max_f32 v251, v251, v252
    v_max_f32 v251, 0, v251
    v_add_f32 v216, v216, v251
    v_exp_f32 v253, -v251
    v_sub_f32 v180, v180, v251
    v_sub_f32 v181, v181, v251
    v_sub_f32 v182, v182, v251
    v_sub_f32 v183, v183, v251
    v_sub_f32 v192, v192, v251
    v_sub_f32 v193, v193, v251
    v_sub_f32 v194, v194, v251
    v_sub_f32 v195, v195, v251
    v_mul_f32 v0, v0, v253
    v_mul_f32 v1, v1, v253
    v_mul_f32 v2, v2, v253
    v_mul_f32 v3, v3, v253
    v_mul_f32 v4, v4, v253
    v_mul_f32 v5, v5, v253
    v_mul_f32 v6, v6, v253
    v_mul_f32 v7, v7, v253
    v_mul_f32 v8, v8, v253
    v_mul_f32 v9, v9, v253
    v_mul_f32 v10, v10, v253
    v_mul_f32 v11, v11, v253
    v_mul_f32 v12, v12, v253
    v_mul_f32 v13, v13, v253
    v_mul_f32 v14, v14, v253
    v_mul_f32 v15, v15, v253
    v_mul_f32 v16, v16, v253
    v_mul_f32 v17, v17, v253
    v_mul_f32 v18, v18, v253
    v_mul_f32 v19, v19, v253
    v_mul_f32 v20, v20, v253
    v_mul_f32 v21, v21, v253
    v_mul_f32 v22, v22, v253
    v_mul_f32 v23, v23, v253
    v_mul_f32 v24, v24, v253
    v_mul_f32 v25, v25, v253
    v_mul_f32 v26, v26, v253
    v_mul_f32 v27, v27, v253
    v_mul_f32 v28, v28, v253
    v_mul_f32 v29, v29, v253
    v_mul_f32 v30, v30, v253
    v_mul_f32 v31, v31, v253
    v_mul_f32 v32, v32, v253
    v_mul_f32 v33, v33, v253
    v_mul_f32 v34, v34, v253
    v_mul_f32 v35, v35, v253
    v_mul_f32 v36, v36, v253
    v_mul_f32 v37, v37, v253
    v_mul_f32 v38, v38, v253
    v_mul_f32 v39, v39, v253
    v_mul_f32 v40, v40, v253
    v_mul_f32 v41, v41, v253
    v_mul_f32 v42, v42, v253
    v_mul_f32 v43, v43, v253
    v_mul_f32 v44, v44, v253
    v_mul_f32 v45, v45, v253
    v_mul_f32 v46, v46, v253
    v_mul_f32 v47, v47, v253
    v_mul_f32 v144, v144, v253
    v_mul_f32 v145, v145, v253
    v_mul_f32 v146, v146, v253
    v_mul_f32 v147, v147, v253
    v_max3_f32 v251, v184, v185, v186
    v_max3_f32 v251, v251, v187, v196
    v_max3_f32 v251, v251, v197, v198
    v_max_f32 v251, v251, v199
    v_mov_b32 v252, v251
    s_nop 1
    v_permlane32_swap_b32 v251, v252
    v_max_f32 v251, v251, v252
    v_mov_b32 v252, v251
    s_nop 1
    v_permlane16_swap_b32 v251, v252
    v_max_f32 v251, v251, v252
    v_max_f32 v251, 0, v251
    v_add_f32 v217, v217, v251
    v_exp_f32 v253, -v251
    v_sub_f32 v184, v184, v251
    v_sub_f32 v185, v185, v251
    v_sub_f32 v186, v186, v251
    v_sub_f32 v187, v187, v251
    v_sub_f32 v196, v196, v251
    v_sub_f32 v197, v197, v251
    v_sub_f32 v198, v198, v251
    v_sub_f32 v199, v199, v251
    v_mul_f32 v48, v48, v253
    v_mul_f32 v49, v49, v253
    v_mul_f32 v50, v50, v253
    v_mul_f32 v51, v51, v253
    v_mul_f32 v52, v52, v253
    v_mul_f32 v53, v53, v253
    v_mul_f32 v54, v54, v253
    v_mul_f32 v55, v55, v253
    v_mul_f32 v56, v56, v253
    v_mul_f32 v57, v57, v253
    v_mul_f32 v58, v58, v253
    v_mul_f32 v59, v59, v253
    v_mul_f32 v60, v60, v253
    v_mul_f32 v61, v61, v253
    v_mul_f32 v62, v62, v253
    v_mul_f32 v63, v63, v253
    v_mul_f32 v64, v64, v253
    v_mul_f32 v65, v65, v253
    v_mul_f32 v66, v66, v253
    v_mul_f32 v67, v67, v253
    v_mul_f32 v68, v68, v253
    v_mul_f32 v69, v69, v253
    v_mul_f32 v70, v70, v253
    v_mul_f32 v71, v71, v253
    v_mul_f32 v72, v72, v253
    v_mul_f32 v73, v73, v253
    v_mul_f32 v74, v74, v253
    v_mul_f32 v75, v75, v253
    v_mul_f32 v76, v76, v253
    v_mul_f32 v77, v77, v253
    v_mul_f32 v78, v78, v253
    v_mul_f32 v79, v79, v253
    v_mul_f32 v80, v80, v253
    v_mul_f32 v81, v81, v253
    v_mul_f32 v82, v82, v253
    v_mul_f32 v83, v83, v253
    v_mul_f32 v84, v84, v253
    v_mul_f32 v85, v85, v253
    v_mul_f32 v86, v86, v253
    v_mul_f32 v87, v87, v253
    v_mul_f32 v88, v88, v253
    v_mul_f32 v89, v89, v253
    v_mul_f32 v90, v90, v253
    v_mul_f32 v91, v91, v253
    v_mul_f32 v92, v92, v253
    v_mul_f32 v93, v93, v253
    v_mul_f32 v94, v94, v253
    v_mul_f32 v95, v95, v253
    v_mul_f32 v148, v148, v253
    v_mul_f32 v149, v149, v253
    v_mul_f32 v150, v150, v253
    v_mul_f32 v151, v151, v253
    v_max3_f32 v251, v188, v189, v190
    v_max3_f32 v251, v251, v191, v200
    v_max3_f32 v251, v251, v201, v202
    v_max_f32 v251, v251, v203
    v_mov_b32 v252, v251
    s_nop 1
    v_permlane32_swap_b32 v251, v252
    v_max_f32 v251, v251, v252
    v_mov_b32 v252, v251
    s_nop 1
    v_permlane16_swap_b32 v251, v252
    v_max_f32 v251, v251, v252
    v_max_f32 v251, 0, v251
    v_add_f32 v218, v218, v251
    v_exp_f32 v253, -v251
    v_sub_f32 v188, v188, v251
    v_sub_f32 v189, v189, v251
    v_sub_f32 v190, v190, v251
    v_sub_f32 v191, v191, v251
    v_sub_f32 v200, v200, v251
    v_sub_f32 v201, v201, v251
    v_sub_f32 v202, v202, v251
    v_sub_f32 v203, v203, v251
    v_mul_f32 v96, v96, v253
    v_mul_f32 v97, v97, v253
    v_mul_f32 v98, v98, v253
    v_mul_f32 v99, v99, v253
    v_mul_f32 v100, v100, v253
    v_mul_f32 v101, v101, v253
    v_mul_f32 v102, v102, v253
    v_mul_f32 v103, v103, v253
    v_mul_f32 v104, v104, v253
    v_mul_f32 v105, v105, v253
    v_mul_f32 v106, v106, v253
    v_mul_f32 v107, v107, v253
    v_mul_f32 v108, v108, v253
    v_mul_f32 v109, v109, v253
    v_mul_f32 v110, v110, v253
    v_mul_f32 v111, v111, v253
    v_mul_f32 v112, v112, v253
    v_mul_f32 v113, v113, v253
    v_mul_f32 v114, v114, v253
    v_mul_f32 v115, v115, v253
    v_mul_f32 v116, v116, v253
    v_mul_f32 v117, v117, v253
    v_mul_f32 v118, v118, v253
    v_mul_f32 v119, v119, v253
    v_mul_f32 v120, v120, v253
    v_mul_f32 v121, v121, v253
    v_mul_f32 v122, v122, v253
    v_mul_f32 v123, v123, v253
    v_mul_f32 v124, v124, v253
    v_mul_f32 v125, v125, v253
    v_mul_f32 v126, v126, v253
    v_mul_f32 v127, v127, v253
    v_mul_f32 v128, v128, v253
    v_mul_f32 v129, v129, v253
    v_mul_f32 v130, v130, v253
    v_mul_f32 v131, v131, v253
    v_mul_f32 v132, v132, v253
    v_mul_f32 v133, v133, v253
    v_mul_f32 v134, v134, v253
    v_mul_f32 v135, v135, v253
    v_mul_f32 v136, v136, v253
    v_mul_f32 v137, v137, v253
    v_mul_f32 v138, v138, v253
    v_mul_f32 v139, v139, v253
    v_mul_f32 v140, v140, v253
    v_mul_f32 v141, v141, v253
    v_mul_f32 v142, v142, v253
    v_mul_f32 v143, v143, v253
    v_mul_f32 v152, v152, v253
    v_mul_f32 v153, v153, v253
    v_mul_f32 v154, v154, v253
    v_mul_f32 v155, v155, v253
    s_nop 1
    s_branch L_back4
L_rare5:
    s_nop 7
    v_max3_f32 v251, v156, v157, v158
    v_max3_f32 v251, v251, v159, v168
    v_max3_f32 v251, v251, v169, v170
    v_max_f32 v251, v251, v171
    v_mov_b32 v252, v251
    s_nop 1
    v_permlane32_swap_b32 v251, v252
    v_max_f32 v251, v251, v252
    v_mov_b32 v252, v251
    s_nop 1
    v_permlane16_swap_b32 v251, v252
    v_max_f32 v251, v251, v252
    v_max_f32 v251, 0, v251
    v_add_f32 v216, v216, v251
    v_exp_f32 v253, -v251
    v_sub_f32 v156, v156, v251
    v_sub_f32 v157, v157, v251
    v_sub_f32 v158, v158, v251
    v_sub_f32 v159, v159, v251
    v_sub_f32 v168, v168, v251
    v_sub_f32 v169, v169, v251
    v_sub_f32 v170, v170, v251
    v_sub_f32 v171, v171, v251
    v_mul_f32 v0, v0, v253
    v_mul_f32 v1, v1, v253
    v_mul_f32 v2, v2, v253
    v_mul_f32 v3, v3, v253
    v_mul_f32 v4, v4, v253
    v_mul_f32 v5, v5, v253
    v_mul_f32 v6, v6, v253
    v_mul_f32 v7, v7, v253
    v_mul_f32 v8, v8, v253
    v_mul_f32 v9, v9, v253
    v_mul_f32 v10, v10, v253
    v_mul_f32 v11, v11, v253
    v_mul_f32 v12, v12, v253
    v_mul_f32 v13, v13, v253
    v_mul_f32 v14, v14, v253
    v_mul_f32 v15, v15, v253
    v_mul_f32 v16, v16, v253
    v_mul_f32 v17, v17, v253
    v_mul_f32 v18, v18, v253
    v_mul_f32 v19, v19, v253
    v_mul_f32 v20, v20, v253
    v_mul_f32 v21, v21, v253
    v_mul_f32 v22, v22, v253
    v_mul_f32 v23, v23, v253
    v_mul_f32 v24, v24, v253
    v_mul_f32 v25, v25, v253
    v_mul_f32 v26, v26, v253
    v_mul_f32 v27, v27, v253
    v_mul_f32 v28, v28, v253
    v_mul_f32 v29, v29, v253
    v_mul_f32 v30, v30, v253
    v_mul_f32 v31, v31, v253
    v_mul_f32 v32, v32, v253
    v_mul_f32 v33, v33, v253
    v_mul_f32 v34, v34, v253
    v_mul_f32 v35, v35, v253
    v_mul_f32 v36, v36, v253
    v_mul_f32 v37, v37, v253
    v_mul_f32 v38, v38, v253
    v_mul_f32 v39, v39, v253
    v_mul_f32 v40, v40, v253
    v_mul_f32 v41, v41, v253
    v_mul_f32 v42, v42, v253
    v_mul_f32 v43, v43, v253
    v_mul_f32 v44, v44, v253
    v_mul_f32 v45, v45, v253
    v_mul_f32 v46, v46, v253
    v_mul_f32 v47, v47, v253
    v_mul_f32 v144, v144, v253
    v_mul_f32 v145, v145, v253
    v_mul_f32 v146, v146, v253
    v_mul_f32 v147, v147, v253
    v_max3_f32 v251, v160, v161, v162
    v_max3_f32 v251, v251, v163, v172
    v_max3_f32 v251, v251, v173, v174
    v_max_f32 v251, v251, v175
    v_mov_b32 v252, v251
    s_nop 1
    v_permlane32_swap_b32 v251, v252
    v_max_f32 v251, v251, v252
    v_mov_b32 v252, v251
    s_nop 1
    v_permlane16_swap_b32 v251, v252
    v_max_f32 v251, v251, v252
    v_max_f32 v251, 0, v251
    v_add_f32 v217, v217, v251
    v_exp_f32 v253, -v251
    v_sub_f32 v160, v160, v251
    v_sub_f32 v161, v161, v251
    v_sub_f32 v162, v162, v251
    v_sub_f32 v163, v163, v251
    v_sub_f32 v172, v172, v251
    v_sub_f32 v173, v173, v251
    v_sub_f32 v174, v174, v251
    v_sub_f32 v175, v175, v251
    v_mul_f32 v48, v48, v253
    v_mul_f32 v49, v49, v253
    v_mul_f32 v50, v50, v253
    v_mul_f32 v51, v51, v253
    v_mul_f32 v52, v52, v253
    v_mul_f32 v53, v53, v253
    v_mul_f32 v54, v54, v253
    v_mul_f32 v55, v55, v253
    v_mul_f32 v56, v56, v253
    v_mul_f32 v57, v57, v253
    v_mul_f32 v58, v58, v253
    v_mul_f32 v59, v59, v253
    v_mul_f32 v60, v60, v253
    v_mul_f32 v61, v61, v253
    v_mul_f32 v62, v62, v253
    v_mul_f32 v63, v63, v253
    v_mul_f32 v64, v64, v253
    v_mul_f32 v65, v65, v253
    v_mul_f32 v66, v66, v253
    v_mul_f32 v67, v67, v253
    v_mul_f32 v68, v68, v253
    v_mul_f32 v69, v69, v253
    v_mul_f32 v70, v70, v253
    v_mul_f32 v71, v71, v253
    v_mul_f32 v72, v72, v253
    v_mul_f32 v73, v73, v253
    v_mul_f32 v74, v74, v253
    v_mul_f32 v75, v75, v253
    v_mul_f32 v76, v76, v253
    v_mul_f32 v77, v77, v253
    v_mul_f32 v78, v78, v253
    v_mul_f32 v79, v79, v253
    v_mul_f32 v80, v80, v253
    v_mul_f32 v81, v81, v253
    v_mul_f32 v82, v82, v253
    v_mul_f32 v83, v83, v253
    v_mul_f32 v84, v84, v253
    v_mul_f32 v85, v85, v253
    v_mul_f32 v86, v86, v253
    v_mul_f32 v87, v87, v253
    v_mul_f32 v88, v88, v253
    v_mul_f32 v89, v89, v253
    v_mul_f32 v90, v90, v253
    v_mul_f32 v91, v91, v253
    v_mul_f32 v92, v92, v253
    v_mul_f32 v93, v93, v253
    v_mul_f32 v94, v94, v253
    v_mul_f32 v95, v95, v253
    v_mul_f32 v148, v148, v253
    v_mul_f32 v149, v149, v253
    v_mul_f32 v150, v150, v253
    v_mul_f32 v151, v151, v253
    v_max3_f32 v251, v164, v165, v166
    v_max3_f32 v251, v251, v167, v176
    v_max3_f32 v251, v251, v177, v178
    v_max_f32 v251, v251, v179
    v_mov_b32 v252, v251
    s_nop 1
    v_permlane32_swap_b32 v251, v252
    v_max_f32 v251, v251, v252
    v_mov_b32 v252, v251
    s_nop 1
    v_permlane16_swap_b32 v251, v252
    v_max_f32 v251, v251, v252
    v_max_f32 v251, 0, v251
    v_add_f32 v218, v218, v251
    v_exp_f32 v253, -v251
    v_sub_f32 v164, v164, v251
    v_sub_f32 v165, v165, v251
    v_sub_f32 v166, v166, v251
    v_sub_f32 v167, v167, v251
    v_sub_f32 v176, v176, v251
    v_sub_f32 v177, v177, v251
    v_sub_f32 v178, v178, v251
    v_sub_f32 v179, v179, v251
    v_mul_f32 v96, v96, v253
    v_mul_f32 v97, v97, v253
    v_mul_f32 v98, v98, v253
    v_mul_f32 v99, v99, v253
    v_mul_f32 v100, v100, v253
    v_mul_f32 v101, v101, v253
    v_mul_f32 v102, v102, v253
    v_mul_f32 v103, v103, v253
    v_mul_f32 v104, v104, v253
    v_mul_f32 v105, v105, v253
    v_mul_f32 v106, v106, v253
    v_mul_f32 v107, v107, v253
    v_mul_f32 v108, v108, v253
    v_mul_f32 v109, v109, v253
    v_mul_f32 v110, v110, v253
    v_mul_f32 v111, v111, v253
    v_mul_f32 v112, v112, v253
    v_mul_f32 v113, v113, v253
    v_mul_f32 v114, v114, v253
    v_mul_f32 v115, v115, v253
    v_mul_f32 v116, v116, v253
    v_mul_f32 v117, v117, v253
    v_mul_f32 v118, v118, v253
    v_mul_f32 v119, v119, v253
    v_mul_f32 v120, v120, v253
    v_mul_f32 v121, v121, v253
    v_mul_f32 v122, v122, v253
    v_mul_f32 v123, v123, v253
    v_mul_f32 v124, v124, v253
    v_mul_f32 v125, v125, v253
    v_mul_f32 v126, v126, v253
    v_mul_f32 v127, v127, v253
    v_mul_f32 v128, v128, v253
    v_mul_f32 v129, v129, v253
    v_mul_f32 v130, v130, v253
    v_mul_f32 v131, v131, v253
    v_mul_f32 v132, v132, v253
    v_mul_f32 v133, v133, v253
    v_mul_f32 v134, v134, v253
    v_mul_f32 v135, v135, v253
    v_mul_f32 v136, v136, v253
    v_mul_f32 v137, v137, v253
    v_mul_f32 v138, v138, v253
    v_mul_f32 v139, v139, v253
    v_mul_f32 v140, v140, v253
    v_mul_f32 v141, v141, v253
    v_mul_f32 v142, v142, v253
    v_mul_f32 v143, v143, v253
    v_mul_f32 v152, v152, v253
    v_mul_f32 v153, v153, v253
    v_mul_f32 v154, v154, v253
    v_mul_f32 v155, v155, v253
    s_nop 1
    s_branch L_back5
L_rare6:
    s_nop 7
    v_max3_f32 v251, v180, v181, v182
    v_max3_f32 v251, v251, v183, v192
    v_max3_f32 v251, v251, v193, v194
    v_max_f32 v251, v251, v195
    v_mov_b32 v252, v251
    s_nop 1
    v_permlane32_swap_b32 v251, v252
    v_max_f32 v251, v251, v252
    v_mov_b32 v252, v251
    s_nop 1
    v_permlane16_swap_b32 v251, v252
    v_max_f32 v251, v251, v252
    v_max_f32 v251, 0, v251
    v_add_f32 v216, v216, v251
    v_exp_f32 v253, -v251
    v_sub_f32 v180, v180, v251
    v_sub_f32 v181, v181, v251
    v_sub_f32 v182, v182, v251
    v_sub_f32 v183, v183, v251
    v_sub_f32 v192, v192, v251
    v_sub_f32 v193, v193, v251
    v_sub_f32 v194, v194, v251
    v_sub_f32 v195, v195, v251
    v_mul_f32 v0, v0, v253
    v_mul_f32 v1, v1, v253
    v_mul_f32 v2, v2, v253
    v_mul_f32 v3, v3, v253
    v_mul_f32 v4, v4, v253
    v_mul_f32 v5, v5, v253
    v_mul_f32 v6, v6, v253
    v_mul_f32 v7, v7, v253
    v_mul_f32 v8, v8, v253
    v_mul_f32 v9, v9, v253
    v_mul_f32 v10, v10, v253
    v_mul_f32 v11, v11, v253
    v_mul_f32 v12, v12, v253
    v_mul_f32 v13, v13, v253
    v_mul_f32 v14, v14, v253
    v_mul_f32 v15, v15, v253
    v_mul_f32 v16, v16, v253
    v_mul_f32 v17, v17, v253
    v_mul_f32 v18, v18, v253
    v_mul_f32 v19, v19, v253
    v_mul_f32 v20, v20, v253
    v_mul_f32 v21, v21, v253
    v_mul_f32 v22, v22, v253
    v_mul_f32 v23, v23, v253
    v_mul_f32 v24, v24, v253
    v_mul_f32 v25, v25, v253
    v_mul_f32 v26, v26, v253
    v_mul_f32 v27, v27, v253
    v_mul_f32 v28, v28, v253
    v_mul_f32 v29, v29, v253
    v_mul_f32 v30, v30, v253
    v_mul_f32 v31, v31, v253
    v_mul_f32 v32, v32, v253
    v_mul_f32 v33, v33, v253
    v_mul_f32 v34, v34, v253
    v_mul_f32 v35, v35, v253
    v_mul_f32 v36, v36, v253
    v_mul_f32 v37, v37, v253
    v_mul_f32 v38, v38, v253
    v_mul_f32 v39, v39, v253
    v_mul_f32 v40, v40, v253
    v_mul_f32 v41, v41, v253
    v_mul_f32 v42, v42, v253
    v_mul_f32 v43, v43, v253
    v_mul_f32 v44, v44, v253
    v_mul_f32 v45, v45, v253
    v_mul_f32 v46, v46, v253
    v_mul_f32 v47, v47, v253
    v_mul_f32 v144, v144, v253
    v_mul_f32 v145, v145, v253
    v_mul_f32 v146, v146, v253
    v_mul_f32 v147, v147, v253
    v_max3_f32 v251, v184, v185, v186
    v_max3_f32 v251, v251, v187, v196
    v_max3_f32 v251, v251, v197, v198
    v_max_f32 v251, v251, v199
    v_mov_b32 v252, v251
    s_nop 1
    v_permlane32_swap_b32 v251, v252
    v_max_f32 v251, v251, v252
    v_mov_b32 v252, v251
    s_nop 1
    v_permlane16_swap_b32 v251, v252
    v_max_f32 v251, v251, v252
    v_max_f32 v251, 0, v251
    v_add_f32 v217, v217, v251
    v_exp_f32 v253, -v251
    v_sub_f32 v184, v184, v251
    v_sub_f32 v185, v185, v251
    v_sub_f32 v186, v186, v251
    v_sub_f32 v187, v187, v251
    v_sub_f32 v196, v196, v251
    v_sub_f32 v197, v197, v251
    v_sub_f32 v198, v198, v251
    v_sub_f32 v199, v199, v251
    v_mul_f32 v48, v48, v253
    v_mul_f32 v49, v49, v253
    v_mul_f32 v50, v50, v253
    v_mul_f32 v51, v51, v253
    v_mul_f32 v52, v52, v253
    v_mul_f32 v53, v53, v253
    v_mul_f32 v54, v54, v253
    v_mul_f32 v55, v55, v253
    v_mul_f32 v56, v56, v253
    v_mul_f32 v57, v57, v253
    v_mul_f32 v58, v58, v253
    v_mul_f32 v59, v59, v253
    v_mul_f32 v60, v60, v253
    v_mul_f32 v61, v61, v253
    v_mul_f32 v62, v62, v253
    v_mul_f32 v63, v63, v253
    v_mul_f32 v64, v64, v253
    v_mul_f32 v65, v65, v253
    v_mul_f32 v66, v66, v253
    v_mul_f32 v67, v67, v253
    v_mul_f32 v68, v68, v253
    v_mul_f32 v69, v69, v253
    v_mul_f32 v70, v70, v253
    v_mul_f32 v71, v71, v253
    v_mul_f32 v72, v72, v253
    v_mul_f32 v73, v73, v253
    v_mul_f32 v74, v74, v253
    v_mul_f32 v75, v75, v253
    v_mul_f32 v76, v76, v253
    v_mul_f32 v77, v77, v253
    v_mul_f32 v78, v78, v253
    v_mul_f32 v79, v79, v253
    v_mul_f32 v80, v80, v253
    v_mul_f32 v81, v81, v253
    v_mul_f32 v82, v82, v253
    v_mul_f32 v83, v83, v253
    v_mul_f32 v84, v84, v253
    v_mul_f32 v85, v85, v253
    v_mul_f32 v86, v86, v253
    v_mul_f32 v87, v87, v253
    v_mul_f32 v88, v88, v253
    v_mul_f32 v89, v89, v253
    v_mul_f32 v90, v90, v253
    v_mul_f32 v91, v91, v253
    v_mul_f32 v92, v92, v253
    v_mul_f32 v93, v93, v253
    v_mul_f32 v94, v94, v253
    v_mul_f32 v95, v95, v253
    v_mul_f32 v148, v148, v253
    v_mul_f32 v149, v149, v253
    v_mul_f32 v150, v150, v253
    v_mul_f32 v151, v151, v253
    v_max3_f32 v251, v188, v189, v190
    v_max3_f32 v251, v251, v191, v200
    v_max3_f32 v251, v251, v201, v202
    v_max_f32 v251, v251, v203
    v_mov_b32 v252, v251
    s_nop 1
    v_permlane32_swap_b32 v251, v252
    v_max_f32 v251, v251, v252
    v_mov_b32 v252, v251
    s_nop 1
    v_permlane16_swap_b32 v251, v252
    v_max_f32 v251, v251, v252
    v_max_f32 v251, 0, v251
    v_add_f32 v218, v218, v251
    v_exp_f32 v253, -v251
    v_sub_f32 v188, v188, v251
    v_sub_f32 v189, v189, v251
    v_sub_f32 v190, v190, v251
    v_sub_f32 v191, v191, v251
    v_sub_f32 v200, v200, v251
    v_sub_f32 v201, v201, v251
    v_sub_f32 v202, v202, v251
    v_sub_f32 v203, v203, v251
    v_mul_f32 v96, v96, v253
    v_mul_f32 v97, v97, v253
    v_mul_f32 v98, v98, v253
    v_mul_f32 v99, v99, v253
    v_mul_f32 v100, v100, v253
    v_mul_f32 v101, v101, v253
    v_mul_f32 v102, v102, v253
    v_mul_f32 v103, v103, v253
    v_mul_f32 v104, v104, v253
    v_mul_f32 v105, v105, v253
    v_mul_f32 v106, v106, v253
    v_mul_f32 v107, v107, v253
    v_mul_f32 v108, v108, v253
    v_mul_f32 v109, v109, v253
    v_mul_f32 v110, v110, v253
    v_mul_f32 v111, v111, v253
    v_mul_f32 v112, v112, v253
    v_mul_f32 v113, v113, v253
    v_mul_f32 v114, v114, v253
    v_mul_f32 v115, v115, v253
    v_mul_f32 v116, v116, v253
    v_mul_f32 v117, v117, v253
    v_mul_f32 v118, v118, v253
    v_mul_f32 v119, v119, v253
    v_mul_f32 v120, v120, v253
    v_mul_f32 v121, v121, v253
    v_mul_f32 v122, v122, v253
    v_mul_f32 v123, v123, v253
    v_mul_f32 v124, v124, v253
    v_mul_f32 v125, v125, v253
    v_mul_f32 v126, v126, v253
    v_mul_f32 v127, v127, v253
    v_mul_f32 v128, v128, v253
    v_mul_f32 v129, v129, v253
    v_mul_f32 v130, v130, v253
    v_mul_f32 v131, v131, v253
    v_mul_f32 v132, v132, v253
    v_mul_f32 v133, v133, v253
    v_mul_f32 v134, v134, v253
    v_mul_f32 v135, v135, v253
    v_mul_f32 v136, v136, v253
    v_mul_f32 v137, v137, v253
    v_mul_f32 v138, v138, v253
    v_mul_f32 v139, v139, v253
    v_mul_f32 v140, v140, v253
    v_mul_f32 v141, v141, v253
    v_mul_f32 v142, v142, v253
    v_mul_f32 v143, v143, v253
    v_mul_f32 v152, v152, v253
    v_mul_f32 v153, v153, v253
    v_mul_f32 v154, v154, v253
    v_mul_f32 v155, v155, v253
    s_nop 1
    s_branch L_back6
L_rare7:
    s_nop 7
    v_max3_f32 v251, v156, v157, v158
    v_max3_f32 v251, v251, v159, v168
    v_max3_f32 v251, v251, v169, v170
    v_max_f32 v251, v251, v171
    v_mov_b32 v252, v251
    s_nop 1
    v_permlane32_swap_b32 v251, v252
    v_max_f32 v251, v251, v252
    v_mov_b32 v252, v251
    s_nop 1
    v_permlane16_swap_b32 v251, v252
    v_max_f32 v251, v251, v252
    v_max_f32 v251, 0, v251
    v_add_f32 v216, v216, v251
    v_exp_f32 v253, -v251
    v_sub_f32 v156, v156, v251
    v_sub_f32 v157, v157, v251
    v_sub_f32 v158, v158, v251
    v_sub_f32 v159, v159, v251
    v_sub_f32 v168, v168, v251
    v_sub_f32 v169, v169, v251
    v_sub_f32 v170, v170, v251
    v_sub_f32 v171, v171, v251
    v_mul_f32 v0, v0, v253
    v_mul_f32 v1, v1, v253
    v_mul_f32 v2, v2, v253
    v_mul_f32 v3, v3, v253
    v_mul_f32 v4, v4, v253
    v_mul_f32 v5, v5, v253
    v_mul_f32 v6, v6, v253
    v_mul_f32 v7, v7, v253
    v_mul_f32 v8, v8, v253
    v_mul_f32 v9, v9, v253
    v_mul_f32 v10, v10, v253
    v_mul_f32 v11, v11, v253
    v_mul_f32 v12, v12, v253
    v_mul_f32 v13, v13, v253
    v_mul_f32 v14, v14, v253
    v_mul_f32 v15, v15, v253
    v_mul_f32 v16, v16, v253
    v_mul_f32 v17, v17, v253
    v_mul_f32 v18, v18, v253
    v_mul_f32 v19, v19, v253
    v_mul_f32 v20, v20, v253
    v_mul_f32 v21, v21, v253
    v_mul_f32 v22, v22, v253
    v_mul_f32 v23, v23, v253
    v_mul_f32 v24, v24, v253
    v_mul_f32 v25, v25, v253
    v_mul_f32 v26, v26, v253
    v_mul_f32 v27, v27, v253
    v_mul_f32 v28, v28, v253
    v_mul_f32 v29, v29, v253
    v_mul_f32 v30, v30, v253
    v_mul_f32 v31, v31, v253
    v_mul_f32 v32, v32, v253
    v_mul_f32 v33, v33, v253
    v_mul_f32 v34, v34, v253
    v_mul_f32 v35, v35, v253
    v_mul_f32 v36, v36, v253
    v_mul_f32 v37, v37, v253
    v_mul_f32 v38, v38, v253
    v_mul_f32 v39, v39, v253
    v_mul_f32 v40, v40, v253
    v_mul_f32 v41, v41, v253
    v_mul_f32 v42, v42, v253
    v_mul_f32 v43, v43, v253
    v_mul_f32 v44, v44, v253
    v_mul_f32 v45, v45, v253
    v_mul_f32 v46, v46, v253
    v_mul_f32 v47, v47, v253
    v_mul_f32 v144, v144, v253
    v_mul_f32 v145, v145, v253
    v_mul_f32 v146, v146, v253
    v_mul_f32 v147, v147, v253
    v_max3_f32 v251, v160, v161, v162
    v_max3_f32 v251, v251, v163, v172
    v_max3_f32 v251, v251, v173, v174
    v_max_f32 v251, v251, v175
    v_mov_b32 v252, v251
    s_nop 1
    v_permlane32_swap_b32 v251, v252
    v_max_f32 v251, v251, v252
    v_mov_b32 v252, v251
    s_nop 1
    v_permlane16_swap_b32 v251, v252
    v_max_f32 v251, v251, v252
    v_max_f32 v251, 0, v251
    v_add_f32 v217, v217, v251
    v_exp_f32 v253, -v251
    v_sub_f32 v160, v160, v251
    v_sub_f32 v161, v161, v251
    v_sub_f32 v162, v162, v251
    v_sub_f32 v163, v163, v251
    v_sub_f32 v172, v172, v251
    v_sub_f32 v173, v173, v251
    v_sub_f32 v174, v174, v251
    v_sub_f32 v175, v175, v251
    v_mul_f32 v48, v48, v253
    v_mul_f32 v49, v49, v253
    v_mul_f32 v50, v50, v253
    v_mul_f32 v51, v51, v253
    v_mul_f32 v52, v52, v253
    v_mul_f32 v53, v53, v253
    v_mul_f32 v54, v54, v253
    v_mul_f32 v55, v55, v253
    v_mul_f32 v56, v56, v253
    v_mul_f32 v57, v57, v253
    v_mul_f32 v58, v58, v253
    v_mul_f32 v59, v59, v253
    v_mul_f32 v60, v60, v253
    v_mul_f32 v61, v61, v253
    v_mul_f32 v62, v62, v253
    v_mul_f32 v63, v63, v253
    v_mul_f32 v64, v64, v253
    v_mul_f32 v65, v65, v253
    v_mul_f32 v66, v66, v253
    v_mul_f32 v67, v67, v253
    v_mul_f32 v68, v68, v253
    v_mul_f32 v69, v69, v253
    v_mul_f32 v70, v70, v253
    v_mul_f32 v71, v71, v253
    v_mul_f32 v72, v72, v253
    v_mul_f32 v73, v73, v253
    v_mul_f32 v74, v74, v253
    v_mul_f32 v75, v75, v253
    v_mul_f32 v76, v76, v253
    v_mul_f32 v77, v77, v253
    v_mul_f32 v78, v78, v253
    v_mul_f32 v79, v79, v253
    v_mul_f32 v80, v80, v253
    v_mul_f32 v81, v81, v253
    v_mul_f32 v82, v82, v253
    v_mul_f32 v83, v83, v253
    v_mul_f32 v84, v84, v253
    v_mul_f32 v85, v85, v253
    v_mul_f32 v86, v86, v253
    v_mul_f32 v87, v87, v253
    v_mul_f32 v88, v88, v253
    v_mul_f32 v89, v89, v253
    v_mul_f32 v90, v90, v253
    v_mul_f32 v91, v91, v253
    v_mul_f32 v92, v92, v253
    v_mul_f32 v93, v93, v253
    v_mul_f32 v94, v94, v253
    v_mul_f32 v95, v95, v253
    v_mul_f32 v148, v148, v253
    v_mul_f32 v149, v149, v253
    v_mul_f32 v150, v150, v253
    v_mul_f32 v151, v151, v253
    v_max3_f32 v251, v164, v165, v166
    v_max3_f32 v251, v251, v167, v176
    v_max3_f32 v251, v251, v177, v178
    v_max_f32 v251, v251, v179
    v_mov_b32 v252, v251
    s_nop 1
    v_permlane32_swap_b32 v251, v252
    v_max_f32 v251, v251, v252
    v_mov_b32 v252, v251
    s_nop 1
    v_permlane16_swap_b32 v251, v252
    v_max_f32 v251, v251, v252
    v_max_f32 v251, 0, v251
    v_add_f32 v218, v218, v251
    v_exp_f32 v253, -v251
    v_sub_f32 v164, v164, v251
    v_sub_f32 v165, v165, v251
    v_sub_f32 v166, v166, v251
    v_sub_f32 v167, v167, v251
    v_sub_f32 v176, v176, v251
    v_sub_f32 v177, v177, v251
    v_sub_f32 v178, v178, v251
    v_sub_f32 v179, v179, v251
    v_mul_f32 v96, v96, v253
    v_mul_f32 v97, v97, v253
    v_mul_f32 v98, v98, v253
    v_mul_f32 v99, v99, v253
    v_mul_f32 v100, v100, v253
    v_mul_f32 v101, v101, v253
    v_mul_f32 v102, v102, v253
    v_mul_f32 v103, v103, v253
    v_mul_f32 v104, v104, v253
    v_mul_f32 v105, v105, v253
    v_mul_f32 v106, v106, v253
    v_mul_f32 v107, v107, v253
    v_mul_f32 v108, v108, v253
    v_mul_f32 v109, v109, v253
    v_mul_f32 v110, v110, v253
    v_mul_f32 v111, v111, v253
    v_mul_f32 v112, v112, v253
    v_mul_f32 v113, v113, v253
    v_mul_f32 v114, v114, v253
    v_mul_f32 v115, v115, v253
    v_mul_f32 v116, v116, v253
    v_mul_f32 v117, v117, v253
    v_mul_f32 v118, v118, v253
    v_mul_f32 v119, v119, v253
    v_mul_f32 v120, v120, v253
    v_mul_f32 v121, v121, v253
    v_mul_f32 v122, v122, v253
    v_mul_f32 v123, v123, v253
    v_mul_f32 v124, v124, v253
    v_mul_f32 v125, v125, v253
    v_mul_f32 v126, v126, v253
    v_mul_f32 v127, v127, v253
    v_mul_f32 v128, v128, v253
    v_mul_f32 v129, v129, v253
    v_mul_f32 v130, v130, v253
    v_mul_f32 v131, v131, v253
    v_mul_f32 v132, v132, v253
    v_mul_f32 v133, v133, v253
    v_mul_f32 v134, v134, v253
    v_mul_f32 v135, v135, v253
    v_mul_f32 v136, v136, v253
    v_mul_f32 v137, v137, v253
    v_mul_f32 v138, v138, v253
    v_mul_f32 v139, v139, v253
    v_mul_f32 v140, v140, v253
    v_mul_f32 v141, v141, v253
    v_mul_f32 v142, v142, v253
    v_mul_f32 v143, v143, v253
    v_mul_f32 v152, v152, v253
    v_mul_f32 v153, v153, v253
    v_mul_f32 v154, v154, v253
    v_mul_f32 v155, v155, v253
    s_nop 1
    s_branch L_back7
L_rare8:
    s_nop 7
    v_max3_f32 v251, v180, v181, v182
    v_max3_f32 v251, v251, v183, v192
    v_max3_f32 v251, v251, v193, v194
    v_max_f32 v251, v251, v195
    v_mov_b32 v252, v251
    s_nop 1
    v_permlane32_swap_b32 v251, v252
    v_max_f32 v251, v251, v252
    v_mov_b32 v252, v251
    s_nop 1
    v_permlane16_swap_b32 v251, v252
    v_max_f32 v251, v251, v252
    v_max_f32 v251, 0, v251
    v_add_f32 v216, v216, v251
    v_exp_f32 v253, -v251
    v_sub_f32 v180, v180, v251
    v_sub_f32 v181, v181, v251
    v_sub_f32 v182, v182, v251
    v_sub_f32 v183, v183, v251
    v_sub_f32 v192, v192, v251
    v_sub_f32 v193, v193, v251
    v_sub_f32 v194, v194, v251
    v_sub_f32 v195, v195, v251
    v_mul_f32 v0, v0, v253
    v_mul_f32 v1, v1, v253
    v_mul_f32 v2, v2, v253
    v_mul_f32 v3, v3, v253
    v_mul_f32 v4, v4, v253
    v_mul_f32 v5, v5, v253
    v_mul_f32 v6, v6, v253
    v_mul_f32 v7, v7, v253
    v_mul_f32 v8, v8, v253
    v_mul_f32 v9, v9, v253
    v_mul_f32 v10, v10, v253
    v_mul_f32 v11, v11, v253
    v_mul_f32 v12, v12, v253
    v_mul_f32 v13, v13, v253
    v_mul_f32 v14, v14, v253
    v_mul_f32 v15, v15, v253
    v_mul_f32 v16, v16, v253
    v_mul_f32 v17, v17, v253
    v_mul_f32 v18, v18, v253
    v_mul_f32 v19, v19, v253
    v_mul_f32 v20, v20, v253
    v_mul_f32 v21, v21, v253
    v_mul_f32 v22, v22, v253
    v_mul_f32 v23, v23, v253
    v_mul_f32 v24, v24, v253
    v_mul_f32 v25, v25, v253
    v_mul_f32 v26, v26, v253
    v_mul_f32 v27, v27, v253
    v_mul_f32 v28, v28, v253
    v_mul_f32 v29, v29, v253
    v_mul_f32 v30, v30, v253
    v_mul_f32 v31, v31, v253
    v_mul_f32 v32, v32, v253
    v_mul_f32 v33, v33, v253
    v_mul_f32 v34, v34, v253
    v_mul_f32 v35, v35, v253
    v_mul_f32 v36, v36, v253
    v_mul_f32 v37, v37, v253
    v_mul_f32 v38, v38, v253
    v_mul_f32 v39, v39, v253
    v_mul_f32 v40, v40, v253
    v_mul_f32 v41, v41, v253
    v_mul_f32 v42, v42, v253
    v_mul_f32 v43, v43, v253
    v_mul_f32 v44, v44, v253
    v_mul_f32 v45, v45, v253
    v_mul_f32 v46, v46, v253
    v_mul_f32 v47, v47, v253
    v_mul_f32 v144, v144, v253
    v_mul_f32 v145, v145, v253
    v_mul_f32 v146, v146, v253
    v_mul_f32 v147, v147, v253
    v_max3_f32 v251, v184, v185, v186
    v_max3_f32 v251, v251, v187, v196
    v_max3_f32 v251, v251, v197, v198
    v_max_f32 v251, v251, v199
    v_mov_b32 v252, v251
    s_nop 1
    v_permlane32_swap_b32 v251, v252
    v_max_f32 v251, v251, v252
    v_mov_b32 v252, v251
    s_nop 1
    v_permlane16_swap_b32 v251, v252
    v_max_f32 v251, v251, v252
    v_max_f32 v251, 0, v251
    v_add_f32 v217, v217, v251
    v_exp_f32 v253, -v251
    v_sub_f32 v184, v184, v251
    v_sub_f32 v185, v185, v251
    v_sub_f32 v186, v186, v251
    v_sub_f32 v187, v187, v251
    v_sub_f32 v196, v196, v251
    v_sub_f32 v197, v197, v251
    v_sub_f32 v198, v198, v251
    v_sub_f32 v199, v199, v251
    v_mul_f32 v48, v48, v253
    v_mul_f32 v49, v49, v253
    v_mul_f32 v50, v50, v253
    v_mul_f32 v51, v51, v253
    v_mul_f32 v52, v52, v253
    v_mul_f32 v53, v53, v253
    v_mul_f32 v54, v54, v253
    v_mul_f32 v55, v55, v253
    v_mul_f32 v56, v56, v253
    v_mul_f32 v57, v57, v253
    v_mul_f32 v58, v58, v253
    v_mul_f32 v59, v59, v253
    v_mul_f32 v60, v60, v253
    v_mul_f32 v61, v61, v253
    v_mul_f32 v62, v62, v253
    v_mul_f32 v63, v63, v253
    v_mul_f32 v64, v64, v253
    v_mul_f32 v65, v65, v253
    v_mul_f32 v66, v66, v253
    v_mul_f32 v67, v67, v253
    v_mul_f32 v68, v68, v253
    v_mul_f32 v69, v69, v253
    v_mul_f32 v70, v70, v253
    v_mul_f32 v71, v71, v253
    v_mul_f32 v72, v72, v253
    v_mul_f32 v73, v73, v253
    v_mul_f32 v74, v74, v253
    v_mul_f32 v75, v75, v253
    v_mul_f32 v76, v76, v253
    v_mul_f32 v77, v77, v253
    v_mul_f32 v78, v78, v253
    v_mul_f32 v79, v79, v253
    v_mul_f32 v80, v80, v253
    v_mul_f32 v81, v81, v253
    v_mul_f32 v82, v82, v253
    v_mul_f32 v83, v83, v253
    v_mul_f32 v84, v84, v253
    v_mul_f32 v85, v85, v253
    v_mul_f32 v86, v86, v253
    v_mul_f32 v87, v87, v253
    v_mul_f32 v88, v88, v253
    v_mul_f32 v89, v89, v253
    v_mul_f32 v90, v90, v253
    v_mul_f32 v91, v91, v253
    v_mul_f32 v92, v92, v253
    v_mul_f32 v93, v93, v253
    v_mul_f32 v94, v94, v253
    v_mul_f32 v95, v95, v253
    v_mul_f32 v148, v148, v253
    v_mul_f32 v149, v149, v253
    v_mul_f32 v150, v150, v253
    v_mul_f32 v151, v151, v253
    v_max3_f32 v251, v188, v189, v190
    v_max3_f32 v251, v251, v191, v200
    v_max3_f32 v251, v251, v201, v202
    v_max_f32 v251, v251, v203
    v_mov_b32 v252, v251
    s_nop 1
    v_permlane32_swap_b32 v251, v252
    v_max_f32 v251, v251, v252
    v_mov_b32 v252, v251
    s_nop 1
    v_permlane16_swap_b32 v251, v252
    v_max_f32 v251, v251, v252
    v_max_f32 v251, 0, v251
    v_add_f32 v218, v218, v251
    v_exp_f32 v253, -v251
    v_sub_f32 v188, v188, v251
    v_sub_f32 v189, v189, v251
    v_sub_f32 v190, v190, v251
    v_sub_f32 v191, v191, v251
    v_sub_f32 v200, v200, v251
    v_sub_f32 v201, v201, v251
    v_sub_f32 v202, v202, v251
    v_sub_f32 v203, v203, v251
    v_mul_f32 v96, v96, v253
    v_mul_f32 v97, v97, v253
    v_mul_f32 v98, v98, v253
    v_mul_f32 v99, v99, v253
    v_mul_f32 v100, v100, v253
    v_mul_f32 v101, v101, v253
    v_mul_f32 v102, v102, v253
    v_mul_f32 v103, v103, v253
    v_mul_f32 v104, v104, v253
    v_mul_f32 v105, v105, v253
    v_mul_f32 v106, v106, v253
    v_mul_f32 v107, v107, v253
    v_mul_f32 v108, v108, v253
    v_mul_f32 v109, v109, v253
    v_mul_f32 v110, v110, v253
    v_mul_f32 v111, v111, v253
    v_mul_f32 v112, v112, v253
    v_mul_f32 v113, v113, v253
    v_mul_f32 v114, v114, v253
    v_mul_f32 v115, v115, v253
    v_mul_f32 v116, v116, v253
    v_mul_f32 v117, v117, v253
    v_mul_f32 v118, v118, v253
    v_mul_f32 v119, v119, v253
    v_mul_f32 v120, v120, v253
    v_mul_f32 v121, v121, v253
    v_mul_f32 v122, v122, v253
    v_mul_f32 v123, v123, v253
    v_mul_f32 v124, v124, v253
    v_mul_f32 v125, v125, v253
    v_mul_f32 v126, v126, v253
    v_mul_f32 v127, v127, v253
    v_mul_f32 v128, v128, v253
    v_mul_f32 v129, v129, v253
    v_mul_f32 v130, v130, v253
    v_mul_f32 v131, v131, v253
    v_mul_f32 v132, v132, v253
    v_mul_f32 v133, v133, v253
    v_mul_f32 v134, v134, v253
    v_mul_f32 v135, v135, v253
    v_mul_f32 v136, v136, v253
    v_mul_f32 v137, v137, v253
    v_mul_f32 v138, v138, v253
    v_mul_f32 v139, v139, v253
    v_mul_f32 v140, v140, v253
    v_mul_f32 v141, v141, v253
    v_mul_f32 v142, v142, v253
    v_mul_f32 v143, v143, v253
    v_mul_f32 v152, v152, v253
    v_mul_f32 v153, v153, v253
    v_mul_f32 v154, v154, v253
    v_mul_f32 v155, v155, v253
    s_nop 1
    s_branch L_back8
L_rare9:
    s_nop 7
    v_max3_f32 v251, v156, v157, v158
    v_max3_f32 v251, v251, v159, v168
    v_max3_f32 v251, v251, v169, v170
    v_max_f32 v251, v251, v171
    v_mov_b32 v252, v251
    s_nop 1
    v_permlane32_swap_b32 v251, v252
    v_max_f32 v251, v251, v252
    v_mov_b32 v252, v251
    s_nop 1
    v_permlane16_swap_b32 v251, v252
    v_max_f32 v251, v251, v252
    v_max_f32 v251, 0, v251
    v_add_f32 v216, v216, v251
    v_exp_f32 v253, -v251
    v_sub_f32 v156, v156, v251
    v_sub_f32 v157, v157, v251
    v_sub_f32 v158, v158, v251
    v_sub_f32 v159, v159, v251
    v_sub_f32 v168, v168, v251
    v_sub_f32 v169, v169, v251
    v_sub_f32 v170, v170, v251
    v_sub_f32 v171, v171, v251
    v_mul_f32 v0, v0, v253
    v_mul_f32 v1, v1, v253
    v_mul_f32 v2, v2, v253
    v_mul_f32 v3, v3, v253
    v_mul_f32 v4, v4, v253
    v_mul_f32 v5, v5, v253
    v_mul_f32 v6, v6, v253
    v_mul_f32 v7, v7, v253
    v_mul_f32 v8, v8, v253
    v_mul_f32 v9, v9, v253
    v_mul_f32 v10, v10, v253
    v_mul_f32 v11, v11, v253
    v_mul_f32 v12, v12, v253
    v_mul_f32 v13, v13, v253
    v_mul_f32 v14, v14, v253
    v_mul_f32 v15, v15, v253
    v_mul_f32 v16, v16, v253
    v_mul_f32 v17, v17, v253
    v_mul_f32 v18, v18, v253
    v_mul_f32 v19, v19, v253
    v_mul_f32 v20, v20, v253
    v_mul_f32 v21, v21, v253
    v_mul_f32 v22, v22, v253
    v_mul_f32 v23, v23, v253
    v_mul_f32 v24, v24, v253
    v_mul_f32 v25, v25, v253
    v_mul_f32 v26, v26, v253
    v_mul_f32 v27, v27, v253
    v_mul_f32 v28, v28, v253
    v_mul_f32 v29, v29, v253
    v_mul_f32 v30, v30, v253
    v_mul_f32 v31, v31, v253
    v_mul_f32 v32, v32, v253
    v_mul_f32 v33, v33, v253
    v_mul_f32 v34, v34, v253
    v_mul_f32 v35, v35, v253
    v_mul_f32 v36, v36, v253
    v_mul_f32 v37, v37, v253
    v_mul_f32 v38, v38, v253
    v_mul_f32 v39, v39, v253
    v_mul_f32 v40, v40, v253
    v_mul_f32 v41, v41, v253
    v_mul_f32 v42, v42, v253
    v_mul_f32 v43, v43, v253
    v_mul_f32 v44, v44, v253
    v_mul_f32 v45, v45, v253
    v_mul_f32 v46, v46, v253
    v_mul_f32 v47, v47, v253
    v_mul_f32 v144, v144, v253
    v_mul_f32 v145, v145, v253
    v_mul_f32 v146, v146, v253
    v_mul_f32 v147, v147, v253
    v_max3_f32 v251, v160, v161, v162
    v_max3_f32 v251, v251, v163, v172
    v_max3_f32 v251, v251, v173, v174
    v_max_f32 v251, v251, v175
    v_mov_b32 v252, v251
    s_nop 1
    v_permlane32_swap_b32 v251, v252
    v_max_f32 v251, v251, v252
    v_mov_b32 v252, v251
    s_nop 1
    v_permlane16_swap_b32 v251, v252
    v_max_f32 v251, v251, v252
    v_max_f32 v251, 0, v251
    v_add_f32 v217, v217, v251
    v_exp_f32 v253, -v251
    v_sub_f32 v160, v160, v251
    v_sub_f32 v161, v161, v251
    v_sub_f32 v162, v162, v251
    v_sub_f32 v163, v163, v251
    v_sub_f32 v172, v172, v251
    v_sub_f32 v173, v173, v251
    v_sub_f32 v174, v174, v251
    v_sub_f32 v175, v175, v251
    v_mul_f32 v48, v48, v253
    v_mul_f32 v49, v49, v253
    v_mul_f32 v50, v50, v253
    v_mul_f32 v51, v51, v253
    v_mul_f32 v52, v52, v253
    v_mul_f32 v53, v53, v253
    v_mul_f32 v54, v54, v253
    v_mul_f32 v55, v55, v253
    v_mul_f32 v56, v56, v253
    v_mul_f32 v57, v57, v253
    v_mul_f32 v58, v58, v253
    v_mul_f32 v59, v59, v253
    v_mul_f32 v60, v60, v253
    v_mul_f32 v61, v61, v253
    v_mul_f32 v62, v62, v253
    v_mul_f32 v63, v63, v253
    v_mul_f32 v64, v64, v253
    v_mul_f32 v65, v65, v253
    v_mul_f32 v66, v66, v253
    v_mul_f32 v67, v67, v253
    v_mul_f32 v68, v68, v253
    v_mul_f32 v69, v69, v253
    v_mul_f32 v70, v70, v253
    v_mul_f32 v71, v71, v253
    v_mul_f32 v72, v72, v253
    v_mul_f32 v73, v73, v253
    v_mul_f32 v74, v74, v253
    v_mul_f32 v75, v75, v253
    v_mul_f32 v76, v76, v253
    v_mul_f32 v77, v77, v253
    v_mul_f32 v78, v78, v253
    v_mul_f32 v79, v79, v253
    v_mul_f32 v80, v80, v253
    v_mul_f32 v81, v81, v253
    v_mul_f32 v82, v82, v253
    v_mul_f32 v83, v83, v253
    v_mul_f32 v84, v84, v253
    v_mul_f32 v85, v85, v253
    v_mul_f32 v86, v86, v253
    v_mul_f32 v87, v87, v253
    v_mul_f32 v88, v88, v253
    v_mul_f32 v89, v89, v253
    v_mul_f32 v90, v90, v253
    v_mul_f32 v91, v91, v253
    v_mul_f32 v92, v92, v253
    v_mul_f32 v93, v93, v253
    v_mul_f32 v94, v94, v253
    v_mul_f32 v95, v95, v253
    v_mul_f32 v148, v148, v253
    v_mul_f32 v149, v149, v253
    v_mul_f32 v150, v150, v253
    v_mul_f32 v151, v151, v253
    v_max3_f32 v251, v164, v165, v166
    v_max3_f32 v251, v251, v167, v176
    v_max3_f32 v251, v251, v177, v178
    v_max_f32 v251, v251, v179
    v_mov_b32 v252, v251
    s_nop 1
    v_permlane32_swap_b32 v251, v252
    v_max_f32 v251, v251, v252
    v_mov_b32 v252, v251
    s_nop 1
    v_permlane16_swap_b32 v251, v252
    v_max_f32 v251, v251, v252
    v_max_f32 v251, 0, v251
    v_add_f32 v218, v218, v251
    v_exp_f32 v253, -v251
    v_sub_f32 v164, v164, v251
    v_sub_f32 v165, v165, v251
    v_sub_f32 v166, v166, v251
    v_sub_f32 v167, v167, v251
    v_sub_f32 v176, v176, v251
    v_sub_f32 v177, v177, v251
    v_sub_f32 v178, v178, v251
    v_sub_f32 v179, v179, v251
    v_mul_f32 v96, v96, v253
    v_mul_f32 v97, v97, v253
    v_mul_f32 v98, v98, v253
    v_mul_f32 v99, v99, v253
    v_mul_f32 v100, v100, v253
    v_mul_f32 v101, v101, v253
    v_mul_f32 v102, v102, v253
    v_mul_f32 v103, v103, v253
    v_mul_f32 v104, v104, v253
    v_mul_f32 v105, v105, v253
    v_mul_f32 v106, v106, v253
    v_mul_f32 v107, v107, v253
    v_mul_f32 v108, v108, v253
    v_mul_f32 v109, v109, v253
    v_mul_f32 v110, v110, v253
    v_mul_f32 v111, v111, v253
    v_mul_f32 v112, v112, v253
    v_mul_f32 v113, v113, v253
    v_mul_f32 v114, v114, v253
    v_mul_f32 v115, v115, v253
    v_mul_f32 v116, v116, v253
    v_mul_f32 v117, v117, v253
    v_mul_f32 v118, v118, v253
    v_mul_f32 v119, v119, v253
    v_mul_f32 v120, v120, v253
    v_mul_f32 v121, v121, v253
    v_mul_f32 v122, v122, v253
    v_mul_f32 v123, v123, v253
    v_mul_f32 v124, v124, v253
    v_mul_f32 v125, v125, v253
    v_mul_f32 v126, v126, v253
    v_mul_f32 v127, v127, v253
    v_mul_f32 v128, v128, v253
    v_mul_f32 v129, v129, v253
    v_mul_f32 v130, v130, v253
    v_mul_f32 v131, v131, v253
    v_mul_f32 v132, v132, v253
    v_mul_f32 v133, v133, v253
    v_mul_f32 v134, v134, v253
    v_mul_f32 v135, v135, v253
    v_mul_f32 v136, v136, v253
    v_mul_f32 v137, v137, v253
    v_mul_f32 v138, v138, v253
    v_mul_f32 v139, v139, v253
    v_mul_f32 v140, v140, v253
    v_mul_f32 v141, v141, v253
    v_mul_f32 v142, v142, v253
    v_mul_f32 v143, v143, v253
    v_mul_f32 v152, v152, v253
    v_mul_f32 v153, v153, v253
    v_mul_f32 v154, v154, v253
    v_mul_f32 v155, v155, v253
    s_nop 1
    s_branch L_back9
L_rare10:
    s_nop 7
    v_max3_f32 v251, v180, v181, v182
    v_max3_f32 v251, v251, v183, v192
    v_max3_f32 v251, v251, v193, v194
    v_max_f32 v251, v251, v195
    v_mov_b32 v252, v251
    s_nop 1
    v_permlane32_swap_b32 v251, v252
    v_max_f32 v251, v251, v252
    v_mov_b32 v252, v251
    s_nop 1
    v_permlane16_swap_b32 v251, v252
    v_max_f32 v251, v251, v252
    v_max_f32 v251, 0, v251
    v_add_f32 v216, v216, v251
    v_exp_f32 v253, -v251
    v_sub_f32 v180, v180, v251
    v_sub_f32 v181, v181, v251
    v_sub_f32 v182, v182, v251
    v_sub_f32 v183, v183, v251
    v_sub_f32 v192, v192, v251
    v_sub_f32 v193, v193, v251
    v_sub_f32 v194, v194, v251
    v_sub_f32 v195, v195, v251
    v_mul_f32 v0, v0, v253
    v_mul_f32 v1, v1, v253
    v_mul_f32 v2, v2, v253
    v_mul_f32 v3, v3, v253
    v_mul_f32 v4, v4, v253
    v_mul_f32 v5, v5, v253
    v_mul_f32 v6, v6, v253
    v_mul_f32 v7, v7, v253
    v_mul_f32 v8, v8, v253
    v_mul_f32 v9, v9, v253
    v_mul_f32 v10, v10, v253
    v_mul_f32 v11, v11, v253
    v_mul_f32 v12, v12, v253
    v_mul_f32 v13, v13, v253
    v_mul_f32 v14, v14, v253
    v_mul_f32 v15, v15, v253
    v_mul_f32 v16, v16, v253
    v_mul_f32 v17, v17, v253
    v_mul_f32 v18, v18, v253
    v_mul_f32 v19, v19, v253
    v_mul_f32 v20, v20, v253
    v_mul_f32 v21, v21, v253
    v_mul_f32 v22, v22, v253
    v_mul_f32 v23, v23, v253
    v_mul_f32 v24, v24, v253
    v_mul_f32 v25, v25, v253
    v_mul_f32 v26, v26, v253
    v_mul_f32 v27, v27, v253
    v_mul_f32 v28, v28, v253
    v_mul_f32 v29, v29, v253
    v_mul_f32 v30, v30, v253
    v_mul_f32 v31, v31, v253
    v_mul_f32 v32, v32, v253
    v_mul_f32 v33, v33, v253
    v_mul_f32 v34, v34, v253
    v_mul_f32 v35, v35, v253
    v_mul_f32 v36, v36, v253
    v_mul_f32 v37, v37, v253
    v_mul_f32 v38, v38, v253
    v_mul_f32 v39, v39, v253
    v_mul_f32 v40, v40, v253
    v_mul_f32 v41, v41, v253
    v_mul_f32 v42, v42, v253
    v_mul_f32 v43, v43, v253
    v_mul_f32 v44, v44, v253
    v_mul_f32 v45, v45, v253
    v_mul_f32 v46, v46, v253
    v_mul_f32 v47, v47, v253
    v_mul_f32 v144, v144, v253
    v_mul_f32 v145, v145, v253
    v_mul_f32 v146, v146, v253
    v_mul_f32 v147, v147, v253
    v_max3_f32 v251, v184, v185, v186
    v_max3_f32 v251, v251, v187, v196
    v_max3_f32 v251, v251, v197, v198
    v_max_f32 v251, v251, v199
    v_mov_b32 v252, v251
    s_nop 1
    v_permlane32_swap_b32 v251, v252
    v_max_f32 v251, v251, v252
    v_mov_b32 v252, v251
    s_nop 1
    v_permlane16_swap_b32 v251, v252
    v_max_f32 v251, v251, v252
    v_max_f32 v251, 0, v251
    v_add_f32 v217, v217, v251
    v_exp_f32 v253, -v251
    v_sub_f32 v184, v184, v251
    v_sub_f32 v185, v185, v251
    v_sub_f32 v186, v186, v251
    v_sub_f32 v187, v187, v251
    v_sub_f32 v196, v196, v251
    v_sub_f32 v197, v197, v251
    v_sub_f32 v198, v198, v251
    v_sub_f32 v199, v199, v251
    v_mul_f32 v48, v48, v253
    v_mul_f32 v49, v49, v253
    v_mul_f32 v50, v50, v253
    v_mul_f32 v51, v51, v253
    v_mul_f32 v52, v52, v253
    v_mul_f32 v53, v53, v253
    v_mul_f32 v54, v54, v253
    v_mul_f32 v55, v55, v253
    v_mul_f32 v56, v56, v253
    v_mul_f32 v57, v57, v253
    v_mul_f32 v58, v58, v253
    v_mul_f32 v59, v59, v253
    v_mul_f32 v60, v60, v253
    v_mul_f32 v61, v61, v253
    v_mul_f32 v62, v62, v253
    v_mul_f32 v63, v63, v253
    v_mul_f32 v64, v64, v253
    v_mul_f32 v65, v65, v253
    v_mul_f32 v66, v66, v253
    v_mul_f32 v67, v67, v253
    v_mul_f32 v68, v68, v253
    v_mul_f32 v69, v69, v253
    v_mul_f32 v70, v70, v253
    v_mul_f32 v71, v71, v253
    v_mul_f32 v72, v72, v253
    v_mul_f32 v73, v73, v253
    v_mul_f32 v74, v74, v253
    v_mul_f32 v75, v75, v253
    v_mul_f32 v76, v76, v253
    v_mul_f32 v77, v77, v253
    v_mul_f32 v78, v78, v253
    v_mul_f32 v79, v79, v253
    v_mul_f32 v80, v80, v253
    v_mul_f32 v81, v81, v253
    v_mul_f32 v82, v82, v253
    v_mul_f32 v83, v83, v253
    v_mul_f32 v84, v84, v253
    v_mul_f32 v85, v85, v253
    v_mul_f32 v86, v86, v253
    v_mul_f32 v87, v87, v253
    v_mul_f32 v88, v88, v253
    v_mul_f32 v89, v89, v253
    v_mul_f32 v90, v90, v253
    v_mul_f32 v91, v91, v253
    v_mul_f32 v92, v92, v253
    v_mul_f32 v93, v93, v253
    v_mul_f32 v94, v94, v253
    v_mul_f32 v95, v95, v253
    v_mul_f32 v148, v148, v253
    v_mul_f32 v149, v149, v253
    v_mul_f32 v150, v150, v253
    v_mul_f32 v151, v151, v253
    v_max3_f32 v251, v188, v189, v190
    v_max3_f32 v251, v251, v191, v200
    v_max3_f32 v251, v251, v201, v202
    v_max_f32 v251, v251, v203
    v_mov_b32 v252, v251
    s_nop 1
    v_permlane32_swap_b32 v251, v252
    v_max_f32 v251, v251, v252
    v_mov_b32 v252, v251
    s_nop 1
    v_permlane16_swap_b32 v251, v252
    v_max_f32 v251, v251, v252
    v_max_f32 v251, 0, v251
    v_add_f32 v218, v218, v251
    v_exp_f32 v253, -v251
    v_sub_f32 v188, v188, v251
    v_sub_f32 v189, v189, v251
    v_sub_f32 v190, v190, v251
    v_sub_f32 v191, v191, v251
    v_sub_f32 v200, v200, v251
    v_sub_f32 v201, v201, v251
    v_sub_f32 v202, v202, v251
    v_sub_f32 v203, v203, v251
    v_mul_f32 v96, v96, v253
    v_mul_f32 v97, v97, v253
    v_mul_f32 v98, v98, v253
    v_mul_f32 v99, v99, v253
    v_mul_f32 v100, v100, v253
    v_mul_f32 v101, v101, v253
    v_mul_f32 v102, v102, v253
    v_mul_f32 v103, v103, v253
    v_mul_f32 v104, v104, v253
    v_mul_f32 v105, v105, v253
    v_mul_f32 v106, v106, v253
    v_mul_f32 v107, v107, v253
    v_mul_f32 v108, v108, v253
    v_mul_f32 v109, v109, v253
    v_mul_f32 v110, v110, v253
    v_mul_f32 v111, v111, v253
    v_mul_f32 v112, v112, v253
    v_mul_f32 v113, v113, v253
    v_mul_f32 v114, v114, v253
    v_mul_f32 v115, v115, v253
    v_mul_f32 v116, v116, v253
    v_mul_f32 v117, v117, v253
    v_mul_f32 v118, v118, v253
    v_mul_f32 v119, v119, v253
    v_mul_f32 v120, v120, v253
    v_mul_f32 v121, v121, v253
    v_mul_f32 v122, v122, v253
    v_mul_f32 v123, v123, v253
    v_mul_f32 v124, v124, v253
    v_mul_f32 v125, v125, v253
    v_mul_f32 v126, v126, v253
    v_mul_f32 v127, v127, v253
    v_mul_f32 v128, v128, v253
    v_mul_f32 v129, v129, v253
    v_mul_f32 v130, v130, v253
    v_mul_f32 v131, v131, v253
    v_mul_f32 v132, v132, v253
    v_mul_f32 v133, v133, v253
    v_mul_f32 v134, v134, v253
    v_mul_f32 v135, v135, v253
    v_mul_f32 v136, v136, v253
    v_mul_f32 v137, v137, v253
    v_mul_f32 v138, v138, v253
    v_mul_f32 v139, v139, v253
    v_mul_f32 v140, v140, v253
    v_mul_f32 v141, v141, v253
    v_mul_f32 v142, v142, v253
    v_mul_f32 v143, v143, v253
    v_mul_f32 v152, v152, v253
    v_mul_f32 v153, v153, v253
    v_mul_f32 v154, v154, v253
    v_mul_f32 v155, v155, v253
    s_nop 1
    s_branch L_back10
L_rare11:
    s_nop 7
    v_max3_f32 v251, v156, v157, v158
    v_max3_f32 v251, v251, v159, v168
    v_max3_f32 v251, v251, v169, v170
    v_max_f32 v251, v251, v171
    v_mov_b32 v252, v251
    s_nop 1
    v_permlane32_swap_b32 v251, v252
    v_max_f32 v251, v251, v252
    v_mov_b32 v252, v251
    s_nop 1
    v_permlane16_swap_b32 v251, v252
    v_max_f32 v251, v251, v252
    v_max_f32 v251, 0, v251
    v_add_f32 v216, v216, v251
    v_exp_f32 v253, -v251
    v_sub_f32 v156, v156, v251
    v_sub_f32 v157, v157, v251
    v_sub_f32 v158, v158, v251
    v_sub_f32 v159, v159, v251
    v_sub_f32 v168, v168, v251
    v_sub_f32 v169, v169, v251
    v_sub_f32 v170, v170, v251
    v_sub_f32 v171, v171, v251
    v_mul_f32 v0, v0, v253
    v_mul_f32 v1, v1, v253
    v_mul_f32 v2, v2, v253
    v_mul_f32 v3, v3, v253
    v_mul_f32 v4, v4, v253
    v_mul_f32 v5, v5, v253
    v_mul_f32 v6, v6, v253
    v_mul_f32 v7, v7, v253
    v_mul_f32 v8, v8, v253
    v_mul_f32 v9, v9, v253
    v_mul_f32 v10, v10, v253
    v_mul_f32 v11, v11, v253
    v_mul_f32 v12, v12, v253
    v_mul_f32 v13, v13, v253
    v_mul_f32 v14, v14, v253
    v_mul_f32 v15, v15, v253
    v_mul_f32 v16, v16, v253
    v_mul_f32 v17, v17, v253
    v_mul_f32 v18, v18, v253
    v_mul_f32 v19, v19, v253
    v_mul_f32 v20, v20, v253
    v_mul_f32 v21, v21, v253
    v_mul_f32 v22, v22, v253
    v_mul_f32 v23, v23, v253
    v_mul_f32 v24, v24, v253
    v_mul_f32 v25, v25, v253
    v_mul_f32 v26, v26, v253
    v_mul_f32 v27, v27, v253
    v_mul_f32 v28, v28, v253
    v_mul_f32 v29, v29, v253
    v_mul_f32 v30, v30, v253
    v_mul_f32 v31, v31, v253
    v_mul_f32 v32, v32, v253
    v_mul_f32 v33, v33, v253
    v_mul_f32 v34, v34, v253
    v_mul_f32 v35, v35, v253
    v_mul_f32 v36, v36, v253
    v_mul_f32 v37, v37, v253
    v_mul_f32 v38, v38, v253
    v_mul_f32 v39, v39, v253
    v_mul_f32 v40, v40, v253
    v_mul_f32 v41, v41, v253
    v_mul_f32 v42, v42, v253
    v_mul_f32 v43, v43, v253
    v_mul_f32 v44, v44, v253
    v_mul_f32 v45, v45, v253
    v_mul_f32 v46, v46, v253
    v_mul_f32 v47, v47, v253
    v_mul_f32 v144, v144, v253
    v_mul_f32 v145, v145, v253
    v_mul_f32 v146, v146, v253
    v_mul_f32 v147, v147, v253
    v_max3_f32 v251, v160, v161, v162
    v_max3_f32 v251, v251, v163, v172
    v_max3_f32 v251, v251, v173, v174
    v_max_f32 v251, v251, v175
    v_mov_b32 v252, v251
    s_nop 1
    v_permlane32_swap_b32 v251, v252
    v_max_f32 v251, v251, v252
    v_mov_b32 v252, v251
    s_nop 1
    v_permlane16_swap_b32 v251, v252
    v_max_f32 v251, v251, v252
    v_max_f32 v251, 0, v251
    v_add_f32 v217, v217, v251
    v_exp_f32 v253, -v251
    v_sub_f32 v160, v160, v251
    v_sub_f32 v161, v161, v251
    v_sub_f32 v162, v162, v251
    v_sub_f32 v163, v163, v251
    v_sub_f32 v172, v172, v251
    v_sub_f32 v173, v173, v251
    v_sub_f32 v174, v174, v251
    v_sub_f32 v175, v175, v251
    v_mul_f32 v48, v48, v253
    v_mul_f32 v49, v49, v253
    v_mul_f32 v50, v50, v253
    v_mul_f32 v51, v51, v253
    v_mul_f32 v52, v52, v253
    v_mul_f32 v53, v53, v253
    v_mul_f32 v54, v54, v253
    v_mul_f32 v55, v55, v253
    v_mul_f32 v56, v56, v253
    v_mul_f32 v57, v57, v253
    v_mul_f32 v58, v58, v253
    v_mul_f32 v59, v59, v253
    v_mul_f32 v60, v60, v253
    v_mul_f32 v61, v61, v253
    v_mul_f32 v62, v62, v253
    v_mul_f32 v63, v63, v253
    v_mul_f32 v64, v64, v253
    v_mul_f32 v65, v65, v253
    v_mul_f32 v66, v66, v253
    v_mul_f32 v67, v67, v253
    v_mul_f32 v68, v68, v253
    v_mul_f32 v69, v69, v253
    v_mul_f32 v70, v70, v253
    v_mul_f32 v71, v71, v253
    v_mul_f32 v72, v72, v253
    v_mul_f32 v73, v73, v253
    v_mul_f32 v74, v74, v253
    v_mul_f32 v75, v75, v253
    v_mul_f32 v76, v76, v253
    v_mul_f32 v77, v77, v253
    v_mul_f32 v78, v78, v253
    v_mul_f32 v79, v79, v253
    v_mul_f32 v80, v80, v253
    v_mul_f32 v81, v81, v253
    v_mul_f32 v82, v82, v253
    v_mul_f32 v83, v83, v253
    v_mul_f32 v84, v84, v253
    v_mul_f32 v85, v85, v253
    v_mul_f32 v86, v86, v253
    v_mul_f32 v87, v87, v253
    v_mul_f32 v88, v88, v253
    v_mul_f32 v89, v89, v253
    v_mul_f32 v90, v90, v253
    v_mul_f32 v91, v91, v253
    v_mul_f32 v92, v92, v253
    v_mul_f32 v93, v93, v253
    v_mul_f32 v94, v94, v253
    v_mul_f32 v95, v95, v253
    v_mul_f32 v148, v148, v253
    v_mul_f32 v149, v149, v253
    v_mul_f32 v150, v150, v253
    v_mul_f32 v151, v151, v253
    v_max3_f32 v251, v164, v165, v166
    v_max3_f32 v251, v251, v167, v176
    v_max3_f32 v251, v251, v177, v178
    v_max_f32 v251, v251, v179
    v_mov_b32 v252, v251
    s_nop 1
    v_permlane32_swap_b32 v251, v252
    v_max_f32 v251, v251, v252
    v_mov_b32 v252, v251
    s_nop 1
    v_permlane16_swap_b32 v251, v252
    v_max_f32 v251, v251, v252
    v_max_f32 v251, 0, v251
    v_add_f32 v218, v218, v251
    v_exp_f32 v253, -v251
    v_sub_f32 v164, v164, v251
    v_sub_f32 v165, v165, v251
    v_sub_f32 v166, v166, v251
    v_sub_f32 v167, v167, v251
    v_sub_f32 v176, v176, v251
    v_sub_f32 v177, v177, v251
    v_sub_f32 v178, v178, v251
    v_sub_f32 v179, v179, v251
    v_mul_f32 v96, v96, v253
    v_mul_f32 v97, v97, v253
    v_mul_f32 v98, v98, v253
    v_mul_f32 v99, v99, v253
    v_mul_f32 v100, v100, v253
    v_mul_f32 v101, v101, v253
    v_mul_f32 v102, v102, v253
    v_mul_f32 v103, v103, v253
    v_mul_f32 v104, v104, v253
    v_mul_f32 v105, v105, v253
    v_mul_f32 v106, v106, v253
    v_mul_f32 v107, v107, v253
    v_mul_f32 v108, v108, v253
    v_mul_f32 v109, v109, v253
    v_mul_f32 v110, v110, v253
    v_mul_f32 v111, v111, v253
    v_mul_f32 v112, v112, v253
    v_mul_f32 v113, v113, v253
    v_mul_f32 v114, v114, v253
    v_mul_f32 v115, v115, v253
    v_mul_f32 v116, v116, v253
    v_mul_f32 v117, v117, v253
    v_mul_f32 v118, v118, v253
    v_mul_f32 v119, v119, v253
    v_mul_f32 v120, v120, v253
    v_mul_f32 v121, v121, v253
    v_mul_f32 v122, v122, v253
    v_mul_f32 v123, v123, v253
    v_mul_f32 v124, v124, v253
    v_mul_f32 v125, v125, v253
    v_mul_f32 v126, v126, v253
    v_mul_f32 v127, v127, v253
    v_mul_f32 v128, v128, v253
    v_mul_f32 v129, v129, v253
    v_mul_f32 v130, v130, v253
    v_mul_f32 v131, v131, v253
    v_mul_f32 v132, v132, v253
    v_mul_f32 v133, v133, v253
    v_mul_f32 v134, v134, v253
    v_mul_f32 v135, v135, v253
    v_mul_f32 v136, v136, v253
    v_mul_f32 v137, v137, v253
    v_mul_f32 v138, v138, v253
    v_mul_f32 v139, v139, v253
    v_mul_f32 v140, v140, v253
    v_mul_f32 v141, v141, v253
    v_mul_f32 v142, v142, v253
    v_mul_f32 v143, v143, v253
    v_mul_f32 v152, v152, v253
    v_mul_f32 v153, v153, v253
    v_mul_f32 v154, v154, v253
    v_mul_f32 v155, v155, v253
    s_nop 1
    s_branch L_back11
L_rare12:
    s_nop 7
    v_max3_f32 v251, v180, v181, v182
    v_max3_f32 v251, v251, v183, v192
    v_max3_f32 v251, v251, v193, v194
    v_max_f32 v251, v251, v195
    v_mov_b32 v252, v251
    s_nop 1
    v_permlane32_swap_b32 v251, v252
    v_max_f32 v251, v251, v252
    v_mov_b32 v252, v251
    s_nop 1
    v_permlane16_swap_b32 v251, v252
    v_max_f32 v251, v251, v252
    v_max_f32 v251, 0, v251
    v_add_f32 v216, v216, v251
    v_exp_f32 v253, -v251
    v_sub_f32 v180, v180, v251
    v_sub_f32 v181, v181, v251
    v_sub_f32 v182, v182, v251
    v_sub_f32 v183, v183, v251
    v_sub_f32 v192, v192, v251
    v_sub_f32 v193, v193, v251
    v_sub_f32 v194, v194, v251
    v_sub_f32 v195, v195, v251
    v_mul_f32 v0, v0, v253
    v_mul_f32 v1, v1, v253
    v_mul_f32 v2, v2, v253
    v_mul_f32 v3, v3, v253
    v_mul_f32 v4, v4, v253
    v_mul_f32 v5, v5, v253
    v_mul_f32 v6, v6, v253
    v_mul_f32 v7, v7, v253
    v_mul_f32 v8, v8, v253
    v_mul_f32 v9, v9, v253
    v_mul_f32 v10, v10, v253
    v_mul_f32 v11, v11, v253
    v_mul_f32 v12, v12, v253
    v_mul_f32 v13, v13, v253
    v_mul_f32 v14, v14, v253
    v_mul_f32 v15, v15, v253
    v_mul_f32 v16, v16, v253
    v_mul_f32 v17, v17, v253
    v_mul_f32 v18, v18, v253
    v_mul_f32 v19, v19, v253
    v_mul_f32 v20, v20, v253
    v_mul_f32 v21, v21, v253
    v_mul_f32 v22, v22, v253
    v_mul_f32 v23, v23, v253
    v_mul_f32 v24, v24, v253
    v_mul_f32 v25, v25, v253
    v_mul_f32 v26, v26, v253
    v_mul_f32 v27, v27, v253
    v_mul_f32 v28, v28, v253
    v_mul_f32 v29, v29, v253
    v_mul_f32 v30, v30, v253
    v_mul_f32 v31, v31, v253
    v_mul_f32 v32, v32, v253
    v_mul_f32 v33, v33, v253
    v_mul_f32 v34, v34, v253
    v_mul_f32 v35, v35, v253
    v_mul_f32 v36, v36, v253
    v_mul_f32 v37, v37, v253
    v_mul_f32 v38, v38, v253
    v_mul_f32 v39, v39, v253
    v_mul_f32 v40, v40, v253
    v_mul_f32 v41, v41, v253
    v_mul_f32 v42, v42, v253
    v_mul_f32 v43, v43, v253
    v_mul_f32 v44, v44, v253
    v_mul_f32 v45, v45, v253
    v_mul_f32 v46, v46, v253
    v_mul_f32 v47, v47, v253
    v_mul_f32 v144, v144, v253
    v_mul_f32 v145, v145, v253
    v_mul_f32 v146, v146, v253
    v_mul_f32 v147, v147, v253
    v_max3_f32 v251, v184, v185, v186
    v_max3_f32 v251, v251, v187, v196
    v_max3_f32 v251, v251, v197, v198
    v_max_f32 v251, v251, v199
    v_mov_b32 v252, v251
    s_nop 1
    v_permlane32_swap_b32 v251, v252
    v_max_f32 v251, v251, v252
    v_mov_b32 v252, v251
    s_nop 1
    v_permlane16_swap_b32 v251, v252
    v_max_f32 v251, v251, v252
    v_max_f32 v251, 0, v251
    v_add_f32 v217, v217, v251
    v_exp_f32 v253, -v251
    v_sub_f32 v184, v184, v251
    v_sub_f32 v185, v185, v251
    v_sub_f32 v186, v186, v251
    v_sub_f32 v187, v187, v251
    v_sub_f32 v196, v196, v251
    v_sub_f32 v197, v197, v251
    v_sub_f32 v198, v198, v251
    v_sub_f32 v199, v199, v251
    v_mul_f32 v48, v48, v253
    v_mul_f32 v49, v49, v253
    v_mul_f32 v50, v50, v253
    v_mul_f32 v51, v51, v253
    v_mul_f32 v52, v52, v253
    v_mul_f32 v53, v53, v253
    v_mul_f32 v54, v54, v253
    v_mul_f32 v55, v55, v253
    v_mul_f32 v56, v56, v253
    v_mul_f32 v57, v57, v253
    v_mul_f32 v58, v58, v253
    v_mul_f32 v59, v59, v253
    v_mul_f32 v60, v60, v253
    v_mul_f32 v61, v61, v253
    v_mul_f32 v62, v62, v253
    v_mul_f32 v63, v63, v253
    v_mul_f32 v64, v64, v253
    v_mul_f32 v65, v65, v253
    v_mul_f32 v66, v66, v253
    v_mul_f32 v67, v67, v253
    v_mul_f32 v68, v68, v253
    v_mul_f32 v69, v69, v253
    v_mul_f32 v70, v70, v253
    v_mul_f32 v71, v71, v253
    v_mul_f32 v72, v72, v253
    v_mul_f32 v73, v73, v253
    v_mul_f32 v74, v74, v253
    v_mul_f32 v75, v75, v253
    v_mul_f32 v76, v76, v253
    v_mul_f32 v77, v77, v253
    v_mul_f32 v78, v78, v253
    v_mul_f32 v79, v79, v253
    v_mul_f32 v80, v80, v253
    v_mul_f32 v81, v81, v253
    v_mul_f32 v82, v82, v253
    v_mul_f32 v83, v83, v253
    v_mul_f32 v84, v84, v253
    v_mul_f32 v85, v85, v253
    v_mul_f32 v86, v86, v253
    v_mul_f32 v87, v87, v253
    v_mul_f32 v88, v88, v253
    v_mul_f32 v89, v89, v253
    v_mul_f32 v90, v90, v253
    v_mul_f32 v91, v91, v253
    v_mul_f32 v92, v92, v253
    v_mul_f32 v93, v93, v253
    v_mul_f32 v94, v94, v253
    v_mul_f32 v95, v95, v253
    v_mul_f32 v148, v148, v253
    v_mul_f32 v149, v149, v253
    v_mul_f32 v150, v150, v253
    v_mul_f32 v151, v151, v253
    v_max3_f32 v251, v188, v189, v190
    v_max3_f32 v251, v251, v191, v200
    v_max3_f32 v251, v251, v201, v202
    v_max_f32 v251, v251, v203
    v_mov_b32 v252, v251
    s_nop 1
    v_permlane32_swap_b32 v251, v252
    v_max_f32 v251, v251, v252
    v_mov_b32 v252, v251
    s_nop 1
    v_permlane16_swap_b32 v251, v252
    v_max_f32 v251, v251, v252
    v_max_f32 v251, 0, v251
    v_add_f32 v218, v218, v251
    v_exp_f32 v253, -v251
    v_sub_f32 v188, v188, v251
    v_sub_f32 v189, v189, v251
    v_sub_f32 v190, v190, v251
    v_sub_f32 v191, v191, v251
    v_sub_f32 v200, v200, v251
    v_sub_f32 v201, v201, v251
    v_sub_f32 v202, v202, v251
    v_sub_f32 v203, v203, v251
    v_mul_f32 v96, v96, v253
    v_mul_f32 v97, v97, v253
    v_mul_f32 v98, v98, v253
    v_mul_f32 v99, v99, v253
    v_mul_f32 v100, v100, v253
    v_mul_f32 v101, v101, v253
    v_mul_f32 v102, v102, v253
    v_mul_f32 v103, v103, v253
    v_mul_f32 v104, v104, v253
    v_mul_f32 v105, v105, v253
    v_mul_f32 v106, v106, v253
    v_mul_f32 v107, v107, v253
    v_mul_f32 v108, v108, v253
    v_mul_f32 v109, v109, v253
    v_mul_f32 v110, v110, v253
    v_mul_f32 v111, v111, v253
    v_mul_f32 v112, v112, v253
    v_mul_f32 v113, v113, v253
    v_mul_f32 v114, v114, v253
    v_mul_f32 v115, v115, v253
    v_mul_f32 v116, v116, v253
    v_mul_f32 v117, v117, v253
    v_mul_f32 v118, v118, v253
    v_mul_f32 v119, v119, v253
    v_mul_f32 v120, v120, v253
    v_mul_f32 v121, v121, v253
    v_mul_f32 v122, v122, v253
    v_mul_f32 v123, v123, v253
    v_mul_f32 v124, v124, v253
    v_mul_f32 v125, v125, v253
    v_mul_f32 v126, v126, v253
    v_mul_f32 v127, v127, v253
    v_mul_f32 v128, v128, v253
    v_mul_f32 v129, v129, v253
    v_mul_f32 v130, v130, v253
    v_mul_f32 v131, v131, v253
    v_mul_f32 v132, v132, v253
    v_mul_f32 v133, v133, v253
    v_mul_f32 v134, v134, v253
    v_mul_f32 v135, v135, v253
    v_mul_f32 v136, v136, v253
    v_mul_f32 v137, v137, v253
    v_mul_f32 v138, v138, v253
    v_mul_f32 v139, v139, v253
    v_mul_f32 v140, v140, v253
    v_mul_f32 v141, v141, v253
    v_mul_f32 v142, v142, v253
    v_mul_f32 v143, v143, v253
    v_mul_f32 v152, v152, v253
    v_mul_f32 v153, v153, v253
    v_mul_f32 v154, v154, v253
    v_mul_f32 v155, v155, v253
    s_nop 1
    s_branch L_back12
L_rare13:
    s_nop 7
    v_max3_f32 v251, v156, v157, v158
    v_max3_f32 v251, v251, v159, v168
    v_max3_f32 v251, v251, v169, v170
    v_max_f32 v251, v251, v171
    v_mov_b32 v252, v251
    s_nop 1
    v_permlane32_swap_b32 v251, v252
    v_max_f32 v251, v251, v252
    v_mov_b32 v252, v251
    s_nop 1
    v_permlane16_swap_b32 v251, v252
    v_max_f32 v251, v251, v252
    v_max_f32 v251, 0, v251
    v_add_f32 v216, v216, v251
    v_exp_f32 v253, -v251
    v_sub_f32 v156, v156, v251
    v_sub_f32 v157, v157, v251
    v_sub_f32 v158, v158, v251
    v_sub_f32 v159, v159, v251
    v_sub_f32 v168, v168, v251
    v_sub_f32 v169, v169, v251
    v_sub_f32 v170, v170, v251
    v_sub_f32 v171, v171, v251
    v_mul_f32 v0, v0, v253
    v_mul_f32 v1, v1, v253
    v_mul_f32 v2, v2, v253
    v_mul_f32 v3, v3, v253
    v_mul_f32 v4, v4, v253
    v_mul_f32 v5, v5, v253
    v_mul_f32 v6, v6, v253
    v_mul_f32 v7, v7, v253
    v_mul_f32 v8, v8, v253
    v_mul_f32 v9, v9, v253
    v_mul_f32 v10, v10, v253
    v_mul_f32 v11, v11, v253
    v_mul_f32 v12, v12, v253
    v_mul_f32 v13, v13, v253
    v_mul_f32 v14, v14, v253
    v_mul_f32 v15, v15, v253
    v_mul_f32 v16, v16, v253
    v_mul_f32 v17, v17, v253
    v_mul_f32 v18, v18, v253
    v_mul_f32 v19, v19, v253
    v_mul_f32 v20, v20, v253
    v_mul_f32 v21, v21, v253
    v_mul_f32 v22, v22, v253
    v_mul_f32 v23, v23, v253
    v_mul_f32 v24, v24, v253
    v_mul_f32 v25, v25, v253
    v_mul_f32 v26, v26, v253
    v_mul_f32 v27, v27, v253
    v_mul_f32 v28, v28, v253
    v_mul_f32 v29, v29, v253
    v_mul_f32 v30, v30, v253
    v_mul_f32 v31, v31, v253
    v_mul_f32 v32, v32, v253
    v_mul_f32 v33, v33, v253
    v_mul_f32 v34, v34, v253
    v_mul_f32 v35, v35, v253
    v_mul_f32 v36, v36, v253
    v_mul_f32 v37, v37, v253
    v_mul_f32 v38, v38, v253
    v_mul_f32 v39, v39, v253
    v_mul_f32 v40, v40, v253
    v_mul_f32 v41, v41, v253
    v_mul_f32 v42, v42, v253
    v_mul_f32 v43, v43, v253
    v_mul_f32 v44, v44, v253
    v_mul_f32 v45, v45, v253
    v_mul_f32 v46, v46, v253
    v_mul_f32 v47, v47, v253
    v_mul_f32 v144, v144, v253
    v_mul_f32 v145, v145, v253
    v_mul_f32 v146, v146, v253
    v_mul_f32 v147, v147, v253
    v_max3_f32 v251, v160, v161, v162
    v_max3_f32 v251, v251, v163, v172
    v_max3_f32 v251, v251, v173, v174
    v_max_f32 v251, v251, v175
    v_mov_b32 v252, v251
    s_nop 1
    v_permlane32_swap_b32 v251, v252
    v_max_f32 v251, v251, v252
    v_mov_b32 v252, v251
    s_nop 1
    v_permlane16_swap_b32 v251, v252
    v_max_f32 v251, v251, v252
    v_max_f32 v251, 0, v251
    v_add_f32 v217, v217, v251
    v_exp_f32 v253, -v251
    v_sub_f32 v160, v160, v251
    v_sub_f32 v161, v161, v251
    v_sub_f32 v162, v162, v251
    v_sub_f32 v163, v163, v251
    v_sub_f32 v172, v172, v251
    v_sub_f32 v173, v173, v251
    v_sub_f32 v174, v174, v251
    v_sub_f32 v175, v175, v251
    v_mul_f32 v48, v48, v253
    v_mul_f32 v49, v49, v253
    v_mul_f32 v50, v50, v253
    v_mul_f32 v51, v51, v253
    v_mul_f32 v52, v52, v253
    v_mul_f32 v53, v53, v253
    v_mul_f32 v54, v54, v253
    v_mul_f32 v55, v55, v253
    v_mul_f32 v56, v56, v253
    v_mul_f32 v57, v57, v253
    v_mul_f32 v58, v58, v253
    v_mul_f32 v59, v59, v253
    v_mul_f32 v60, v60, v253
    v_mul_f32 v61, v61, v253
    v_mul_f32 v62, v62, v253
    v_mul_f32 v63, v63, v253
    v_mul_f32 v64, v64, v253
    v_mul_f32 v65, v65, v253
    v_mul_f32 v66, v66, v253
    v_mul_f32 v67, v67, v253
    v_mul_f32 v68, v68, v253
    v_mul_f32 v69, v69, v253
    v_mul_f32 v70, v70, v253
    v_mul_f32 v71, v71, v253
    v_mul_f32 v72, v72, v253
    v_mul_f32 v73, v73, v253
    v_mul_f32 v74, v74, v253
    v_mul_f32 v75, v75, v253
    v_mul_f32 v76, v76, v253
    v_mul_f32 v77, v77, v253
    v_mul_f32 v78, v78, v253
    v_mul_f32 v79, v79, v253
    v_mul_f32 v80, v80, v253
    v_mul_f32 v81, v81, v253
    v_mul_f32 v82, v82, v253
    v_mul_f32 v83, v83, v253
    v_mul_f32 v84, v84, v253
    v_mul_f32 v85, v85, v253
    v_mul_f32 v86, v86, v253
    v_mul_f32 v87, v87, v253
    v_mul_f32 v88, v88, v253
    v_mul_f32 v89, v89, v253
    v_mul_f32 v90, v90, v253
    v_mul_f32 v91, v91, v253
    v_mul_f32 v92, v92, v253
    v_mul_f32 v93, v93, v253
    v_mul_f32 v94, v94, v253
    v_mul_f32 v95, v95, v253
    v_mul_f32 v148, v148, v253
    v_mul_f32 v149, v149, v253
    v_mul_f32 v150, v150, v253
    v_mul_f32 v151, v151, v253
    v_max3_f32 v251, v164, v165, v166
    v_max3_f32 v251, v251, v167, v176
    v_max3_f32 v251, v251, v177, v178
    v_max_f32 v251, v251, v179
    v_mov_b32 v252, v251
    s_nop 1
    v_permlane32_swap_b32 v251, v252
    v_max_f32 v251, v251, v252
    v_mov_b32 v252, v251
    s_nop 1
    v_permlane16_swap_b32 v251, v252
    v_max_f32 v251, v251, v252
    v_max_f32 v251, 0, v251
    v_add_f32 v218, v218, v251
    v_exp_f32 v253, -v251
    v_sub_f32 v164, v164, v251
    v_sub_f32 v165, v165, v251
    v_sub_f32 v166, v166, v251
    v_sub_f32 v167, v167, v251
    v_sub_f32 v176, v176, v251
    v_sub_f32 v177, v177, v251
    v_sub_f32 v178, v178, v251
    v_sub_f32 v179, v179, v251
    v_mul_f32 v96, v96, v253
    v_mul_f32 v97, v97, v253
    v_mul_f32 v98, v98, v253
    v_mul_f32 v99, v99, v253
    v_mul_f32 v100, v100, v253
    v_mul_f32 v101, v101, v253
    v_mul_f32 v102, v102, v253
    v_mul_f32 v103, v103, v253
    v_mul_f32 v104, v104, v253
    v_mul_f32 v105, v105, v253
    v_mul_f32 v106, v106, v253
    v_mul_f32 v107, v107, v253
    v_mul_f32 v108, v108, v253
    v_mul_f32 v109, v109, v253
    v_mul_f32 v110, v110, v253
    v_mul_f32 v111, v111, v253
    v_mul_f32 v112, v112, v253
    v_mul_f32 v113, v113, v253
    v_mul_f32 v114, v114, v253
    v_mul_f32 v115, v115, v253
    v_mul_f32 v116, v116, v253
    v_mul_f32 v117, v117, v253
    v_mul_f32 v118, v118, v253
    v_mul_f32 v119, v119, v253
    v_mul_f32 v120, v120, v253
    v_mul_f32 v121, v121, v253
    v_mul_f32 v122, v122, v253
    v_mul_f32 v123, v123, v253
    v_mul_f32 v124, v124, v253
    v_mul_f32 v125, v125, v253
    v_mul_f32 v126, v126, v253
    v_mul_f32 v127, v127, v253
    v_mul_f32 v128, v128, v253
    v_mul_f32 v129, v129, v253
    v_mul_f32 v130, v130, v253
    v_mul_f32 v131, v131, v253
    v_mul_f32 v132, v132, v253
    v_mul_f32 v133, v133, v253
    v_mul_f32 v134, v134, v253
    v_mul_f32 v135, v135, v253
    v_mul_f32 v136, v136, v253
    v_mul_f32 v137, v137, v253
    v_mul_f32 v138, v138, v253
    v_mul_f32 v139, v139, v253
    v_mul_f32 v140, v140, v253
    v_mul_f32 v141, v141, v253
    v_mul_f32 v142, v142, v253
    v_mul_f32 v143, v143, v253
    v_mul_f32 v152, v152, v253
    v_mul_f32 v153, v153, v253
    v_mul_f32 v154, v154, v253
    v_mul_f32 v155, v155, v253
    s_nop 1
    s_branch L_back13
L_rare14:
    s_nop 7
    v_max3_f32 v251, v180, v181, v182
    v_max3_f32 v251, v251, v183, v192
    v_max3_f32 v251, v251, v193, v194
    v_max_f32 v251, v251, v195
    v_mov_b32 v252, v251
    s_nop 1
    v_permlane32_swap_b32 v251, v252
    v_max_f32 v251, v251, v252
    v_mov_b32 v252, v251
    s_nop 1
    v_permlane16_swap_b32 v251, v252
    v_max_f32 v251, v251, v252
    v_max_f32 v251, 0, v251
    v_add_f32 v216, v216, v251
    v_exp_f32 v253, -v251
    v_sub_f32 v180, v180, v251
    v_sub_f32 v181, v181, v251
    v_sub_f32 v182, v182, v251
    v_sub_f32 v183, v183, v251
    v_sub_f32 v192, v192, v251
    v_sub_f32 v193, v193, v251
    v_sub_f32 v194, v194, v251
    v_sub_f32 v195, v195, v251
    v_mul_f32 v0, v0, v253
    v_mul_f32 v1, v1, v253
    v_mul_f32 v2, v2, v253
    v_mul_f32 v3, v3, v253
    v_mul_f32 v4, v4, v253
    v_mul_f32 v5, v5, v253
    v_mul_f32 v6, v6, v253
    v_mul_f32 v7, v7, v253
    v_mul_f32 v8, v8, v253
    v_mul_f32 v9, v9, v253
    v_mul_f32 v10, v10, v253
    v_mul_f32 v11, v11, v253
    v_mul_f32 v12, v12, v253
    v_mul_f32 v13, v13, v253
    v_mul_f32 v14, v14, v253
    v_mul_f32 v15, v15, v253
    v_mul_f32 v16, v16, v253
    v_mul_f32 v17, v17, v253
    v_mul_f32 v18, v18, v253
    v_mul_f32 v19, v19, v253
    v_mul_f32 v20, v20, v253
    v_mul_f32 v21, v21, v253
    v_mul_f32 v22, v22, v253
    v_mul_f32 v23, v23, v253
    v_mul_f32 v24, v24, v253
    v_mul_f32 v25, v25, v253
    v_mul_f32 v26, v26, v253
    v_mul_f32 v27, v27, v253
    v_mul_f32 v28, v28, v253
    v_mul_f32 v29, v29, v253
    v_mul_f32 v30, v30, v253
    v_mul_f32 v31, v31, v253
    v_mul_f32 v32, v32, v253
    v_mul_f32 v33, v33, v253
    v_mul_f32 v34, v34, v253
    v_mul_f32 v35, v35, v253
    v_mul_f32 v36, v36, v253
    v_mul_f32 v37, v37, v253
    v_mul_f32 v38, v38, v253
    v_mul_f32 v39, v39, v253
    v_mul_f32 v40, v40, v253
    v_mul_f32 v41, v41, v253
    v_mul_f32 v42, v42, v253
    v_mul_f32 v43, v43, v253
    v_mul_f32 v44, v44, v253
    v_mul_f32 v45, v45, v253
    v_mul_f32 v46, v46, v253
    v_mul_f32 v47, v47, v253
    v_mul_f32 v144, v144, v253
    v_mul_f32 v145, v145, v253
    v_mul_f32 v146, v146, v253
    v_mul_f32 v147, v147, v253
    v_max3_f32 v251, v184, v185, v186
    v_max3_f32 v251, v251, v187, v196
    v_max3_f32 v251, v251, v197, v198
    v_max_f32 v251, v251, v199
    v_mov_b32 v252, v251
    s_nop 1
    v_permlane32_swap_b32 v251, v252
    v_max_f32 v251, v251, v252
    v_mov_b32 v252, v251
    s_nop 1
    v_permlane16_swap_b32 v251, v252
    v_max_f32 v251, v251, v252
    v_max_f32 v251, 0, v251
    v_add_f32 v217, v217, v251
    v_exp_f32 v253, -v251
    v_sub_f32 v184, v184, v251
    v_sub_f32 v185, v185, v251
    v_sub_f32 v186, v186, v251
    v_sub_f32 v187, v187, v251
    v_sub_f32 v196, v196, v251
    v_sub_f32 v197, v197, v251
    v_sub_f32 v198, v198, v251
    v_sub_f32 v199, v199, v251
    v_mul_f32 v48, v48, v253
    v_mul_f32 v49, v49, v253
    v_mul_f32 v50, v50, v253
    v_mul_f32 v51, v51, v253
    v_mul_f32 v52, v52, v253
    v_mul_f32 v53, v53, v253
    v_mul_f32 v54, v54, v253
    v_mul_f32 v55, v55, v253
    v_mul_f32 v56, v56, v253
    v_mul_f32 v57, v57, v253
    v_mul_f32 v58, v58, v253
    v_mul_f32 v59, v59, v253
    v_mul_f32 v60, v60, v253
    v_mul_f32 v61, v61, v253
    v_mul_f32 v62, v62, v253
    v_mul_f32 v63, v63, v253
    v_mul_f32 v64, v64, v253
    v_mul_f32 v65, v65, v253
    v_mul_f32 v66, v66, v253
    v_mul_f32 v67, v67, v253
    v_mul_f32 v68, v68, v253
    v_mul_f32 v69, v69, v253
    v_mul_f32 v70, v70, v253
    v_mul_f32 v71, v71, v253
    v_mul_f32 v72, v72, v253
    v_mul_f32 v73, v73, v253
    v_mul_f32 v74, v74, v253
    v_mul_f32 v75, v75, v253
    v_mul_f32 v76, v76, v253
    v_mul_f32 v77, v77, v253
    v_mul_f32 v78, v78, v253
    v_mul_f32 v79, v79, v253
    v_mul_f32 v80, v80, v253
    v_mul_f32 v81, v81, v253
    v_mul_f32 v82, v82, v253
    v_mul_f32 v83, v83, v253
    v_mul_f32 v84, v84, v253
    v_mul_f32 v85, v85, v253
    v_mul_f32 v86, v86, v253
    v_mul_f32 v87, v87, v253
    v_mul_f32 v88, v88, v253
    v_mul_f32 v89, v89, v253
    v_mul_f32 v90, v90, v253
    v_mul_f32 v91, v91, v253
    v_mul_f32 v92, v92, v253
    v_mul_f32 v93, v93, v253
    v_mul_f32 v94, v94, v253
    v_mul_f32 v95, v95, v253
    v_mul_f32 v148, v148, v253
    v_mul_f32 v149, v149, v253
    v_mul_f32 v150, v150, v253
    v_mul_f32 v151, v151, v253
    v_max3_f32 v251, v188, v189, v190
    v_max3_f32 v251, v251, v191, v200
    v_max3_f32 v251, v251, v201, v202
    v_max_f32 v251, v251, v203
    v_mov_b32 v252, v251
    s_nop 1
    v_permlane32_swap_b32 v251, v252
    v_max_f32 v251, v251, v252
    v_mov_b32 v252, v251
    s_nop 1
    v_permlane16_swap_b32 v251, v252
    v_max_f32 v251, v251, v252
    v_max_f32 v251, 0, v251
    v_add_f32 v218, v218, v251
    v_exp_f32 v253, -v251
    v_sub_f32 v188, v188, v251
    v_sub_f32 v189, v189, v251
    v_sub_f32 v190, v190, v251
    v_sub_f32 v191, v191, v251
    v_sub_f32 v200, v200, v251
    v_sub_f32 v201, v201, v251
    v_sub_f32 v202, v202, v251
    v_sub_f32 v203, v203, v251
    v_mul_f32 v96, v96, v253
    v_mul_f32 v97, v97, v253
    v_mul_f32 v98, v98, v253
    v_mul_f32 v99, v99, v253
    v_mul_f32 v100, v100, v253
    v_mul_f32 v101, v101, v253
    v_mul_f32 v102, v102, v253
    v_mul_f32 v103, v103, v253
    v_mul_f32 v104, v104, v253
    v_mul_f32 v105, v105, v253
    v_mul_f32 v106, v106, v253
    v_mul_f32 v107, v107, v253
    v_mul_f32 v108, v108, v253
    v_mul_f32 v109, v109, v253
    v_mul_f32 v110, v110, v253
    v_mul_f32 v111, v111, v253
    v_mul_f32 v112, v112, v253
    v_mul_f32 v113, v113, v253
    v_mul_f32 v114, v114, v253
    v_mul_f32 v115, v115, v253
    v_mul_f32 v116, v116, v253
    v_mul_f32 v117, v117, v253
    v_mul_f32 v118, v118, v253
    v_mul_f32 v119, v119, v253
    v_mul_f32 v120, v120, v253
    v_mul_f32 v121, v121, v253
    v_mul_f32 v122, v122, v253
    v_mul_f32 v123, v123, v253
    v_mul_f32 v124, v124, v253
    v_mul_f32 v125, v125, v253
    v_mul_f32 v126, v126, v253
    v_mul_f32 v127, v127, v253
    v_mul_f32 v128, v128, v253
    v_mul_f32 v129, v129, v253
    v_mul_f32 v130, v130, v253
    v_mul_f32 v131, v131, v253
    v_mul_f32 v132, v132, v253
    v_mul_f32 v133, v133, v253
    v_mul_f32 v134, v134, v253
    v_mul_f32 v135, v135, v253
    v_mul_f32 v136, v136, v253
    v_mul_f32 v137, v137, v253
    v_mul_f32 v138, v138, v253
    v_mul_f32 v139, v139, v253
    v_mul_f32 v140, v140, v253
    v_mul_f32 v141, v141, v253
    v_mul_f32 v142, v142, v253
    v_mul_f32 v143, v143, v253
    v_mul_f32 v152, v152, v253
    v_mul_f32 v153, v153, v253
    v_mul_f32 v154, v154, v253
    v_mul_f32 v155, v155, v253
    s_nop 1
    s_branch L_back14

.section .rodata,"a"
.p2align 6
.amdhsa_kernel standalone__gqa_softmax__near_ridge_kernel
  .amdhsa_next_free_vgpr 512
  .amdhsa_next_free_sgpr 102
  .amdhsa_accum_offset 256
  .amdhsa_group_segment_fixed_size 0
  .amdhsa_kernarg_size 48
  .amdhsa_user_sgpr_count 2
  .amdhsa_user_sgpr_kernarg_segment_ptr 1
  .amdhsa_system_sgpr_workgroup_id_x 1
.end_amdhsa_kernel
```
